```python
import torch

def _softmax(x, axis=-1):
    return torch.softmax(x, dim=axis)
def _gelu(x):
    return torch.nn.functional.gelu(x, approximate="tanh")
def _silu(x):
    return torch.nn.functional.silu(x)
def _sigmoid(x):
    return torch.sigmoid(x)
def _layernorm(x, axis=-1, eps=1e-5):
    m = x.mean(dim=axis, keepdim=True)
    v = x.var(dim=axis, keepdim=True, unbiased=False)
    return (x - m) / torch.sqrt(v + eps)
def _scatter_add(tgt, idx, src, axis=0):
    return tgt.clone().index_add_(axis, idx, src)
def _segment_sum(src, seg, n):
    out = torch.zeros((n,) + src.shape[1:], dtype=src.dtype)
    return out.index_add_(0, seg, src)
def _pad(x, pw):
    flat = tuple(v for pair in reversed(pw) for v in pair)
    return torch.nn.functional.pad(x, flat)

kernel_name = 'gated_mix__linear_kernel_hedgehog__dense_activation_mish__prompt'

def setup_inputs():

    _w = (lambda a: (lambda t: t.to(torch.bfloat16) if t.is_floating_point() else t)(torch.as_tensor(a)))
    def _A_setup():
        B, S, D, H = 1, 2048, 512, 32
        Dh = D // H
        return {
            "x": _w((lambda *s: torch.randn(*s, dtype=torch.bfloat16) * 0.05)(B, S, D)),
            "wqkv": _w((lambda *s: torch.randn(*s, dtype=torch.bfloat16) * 0.8)(D, 3 * D)),
            "w_phi": _w((lambda *s: torch.randn(*s, dtype=torch.bfloat16) * 0.8)(H, Dh, Dh) * (Dh ** -0.5)),
            "wo": _w((lambda *s: torch.randn(*s, dtype=torch.bfloat16) * 0.05)(D, D)),
        }
    _A_in = _A_setup()

    def _B_setup():
        B, S, D, F = 1, 2048, 512, 1792
        return {
            "x": _w((lambda *s: torch.randn(*s, dtype=torch.bfloat16) * 0.05)(B, S, D)),
            "w1": _w((lambda *s: torch.randn(*s, dtype=torch.bfloat16) * 6.4)(D, F) * (D ** -0.5)),
            "b1": _w((lambda *s: torch.randn(*s, dtype=torch.bfloat16) * 0.1)(F)),
            "w2": _w((lambda *s: torch.randn(*s, dtype=torch.bfloat16) * 0.1)(F, D) * (F ** -0.5)),
        }
    _B_in = _B_setup()

    return {
        "A_x": _A_in["x"],
        "A_wqkv": _A_in["wqkv"],
        "A_w_phi": _A_in["w_phi"],
        "A_wo": _A_in["wo"],
        "B_x": _B_in["x"],
        "B_w1": _B_in["w1"],
        "B_b1": _B_in["b1"],
        "B_w2": _B_in["w2"],
        "gate_w": _w((lambda *s: torch.randn(*s, dtype=torch.bfloat16) * 0.05)(512) * 16.0),
    }

def reference(A_x, A_wqkv, A_w_phi, A_wo, B_x, B_w1, B_b1, B_w2, gate_w):
    def _A_ref(x, wqkv, w_phi, wo):
        B, S, D = x.shape
        H = 32; Dh = D // H
        qkv = (lambda x, *d: x.permute(*d))((x @ wqkv).reshape(B, S, 3, H, Dh), 2, 0, 3, 1, 4)
        q, k, v = qkv[0], qkv[1], qkv[2]
        pq = torch.einsum("bhsd,hdf->bhsf", q, w_phi)
        pk = torch.einsum("bhsd,hdf->bhsf", k, w_phi)
        phi_q = torch.concatenate([_softmax(pq, axis=-1), _softmax(-pq, axis=-1)], axis=-1)
        phi_k = torch.concatenate([_softmax(pk, axis=-1), _softmax(-pk, axis=-1)], axis=-1)
        kv = torch.einsum("bhsf,bhsd->bhfd", phi_k, v)
        z  = torch.einsum("bhsf->bhf", phi_k)
        num = torch.einsum("bhqf,bhfd->bhqd", phi_q, kv)
        den = torch.einsum("bhqf,bhf->bhq", phi_q, z)[..., None] + 1e-6
        o = num / den
        return (lambda x, *d: x.permute(*d))(o, 0, 2, 1, 3).reshape(B, S, D) @ wo

    def _B_ref(x, w1, b1, w2):
        h = torch.einsum("bsd,df->bsf", x, w1) + b1
        sp = torch.log1p(torch.exp(-torch.abs(h))) + torch.where(h > 0, h, torch.zeros_like(h))
        act = h * torch.tanh(sp)
        return torch.einsum("bsf,fd->bsd", act, w2)

    x = A_x
    g = _sigmoid((x * gate_w).sum(-1, keepdims=True))
    a = _A_ref(x, A_wqkv, A_w_phi, A_wo)
    b = _B_ref(x, B_w1, B_b1, B_w2)
    return g * a + (1 - g) * b
```

```asm
; @launch grid=(256,1,1) block=(512,1,1) lds=163840
.amdgcn_target "amdgcn-amd-amdhsa--gfx950"
.text
.globl gated_mix__linear_kernel_hedgehog__dense_activation_mish__prompt_kernel
.p2align 8
.type gated_mix__linear_kernel_hedgehog__dense_activation_mish__prompt_kernel,@function
gated_mix__linear_kernel_hedgehog__dense_activation_mish__prompt_kernel:
    s_cmp_ge_u32 s2, 0x100
    s_cbranch_scc1 L_end
    s_load_dwordx16 s[36:51], s[0:1], 0
    s_load_dwordx8 s[52:59], s[0:1], 64
    s_setprio 3
    v_lshrrev_b32 v35, 6, v0
    s_getpc_b64 s[60:61]
    s_and_b32 s83, s2, 0xf8
    s_lshl_b32 s83, s83, 6
    v_add_u32 v32, s83, v0
    v_subrev_u32 v34, 0x3000, v32
    v_min_u32 v32, v32, v34
    v_lshlrev_b32 v32, 2, v32
    global_load_dword v128, v32, s[60:61]
    v_readfirstlane_b32 s3, v35
    v_lshrrev_b32 v32, 3, v0
    v_and_b32 v33, 7, v0
    v_bfe_u32 v34, v0, 4, 2
    s_lshr_b32 s4, s2, 7
    s_bfe_u32 s83, s2, 0x30003
    s_bfe_u32 s84, s2, 0x10006
    s_and_b32 s5, s2, 1
    s_lshl3_add_u32 s5, s5, s83
    s_bfe_u32 s6, s2, 0x20001
    s_lshl1_add_u32 s6, s6, s84
    s_lshl1_add_u32 s7, s84, s83
    s_lshl2_add_u32 s7, s4, s7
    v_and_b32 v35, 0x38, v32
    v_add_u32 v35, v35, v32
    v_xor_b32 v1, v33, v34
    v_lshlrev_b32 v1, 4, v1
    v_lshl_add_u32 v1, v35, 10, v1
    s_lshr_b32 s86, s6, 1
    s_mul_i32 s91, s86, 7
    s_and_b32 s84, s6, 1
    s_lshl2_add_u32 s85, s84, s91
    s_add_u32 s86, s6, 8
    s_lshl_b32 s99, s5, 17
    s_cmp_eq_u32 s4, 0
    s_movk_i32 s82, 0xe00
    s_cmov_b32 s82, 0xc00
    s_cselect_b32 s86, s86, s85
    s_mov_b32 s14, 0x1c0000
    s_cmov_b32 s14, 0x180000
    v_xor_b32 v2, 64, v1
    v_add_u32 v2, 0x1c00, v2
    v_and_b32 v34, 1, v34
    v_lshlrev_b32 v34, 2, v34
    v_xor_b32 v34, v33, v34
    s_lshl_b32 s86, s86, 3
    v_add_lshl_u32 v34, v34, s86, 4
    v_mad_u32_u24 v3, v32, s82, v34
    s_lshl_b32 s79, s3, 10
    s_lshl1_add_u32 s78, s79, 0x14000
    s_lshl_b32 s96, s82, 3
    s_lshl_b32 s82, s82, 6
    s_add_u32 s83, s7, 0
    s_and_b32 s83, s83, 7
    s_mul_i32 s70, s83, s82
    s_lshl_b32 s83, s83, 7
    s_add_u32 s62, s83, s99
    s_mov_b32 s10, 0x200000
    s_mov_b32 s11, 0x20000
    s_mov_b32 s15, 0x20000
    s_add_u32 s83, s7, 1
    s_and_b32 s83, s83, 7
    s_mul_i32 s71, s83, s82
    s_lshl_b32 s83, s83, 7
    s_add_u32 s63, s83, s99
    v_and_b32 v0, 63, v0
    v_lshlrev_b32 v11, 4, v0
    s_cmp_eq_u32 s4, 0
    s_waitcnt lgkmcnt(0)
    s_mov_b32 s8, s36
    s_mov_b32 s9, s37
    s_cselect_b32 s12, s38, s46
    s_cselect_b32 s13, s39, s47
    s_cselect_b32 s20, s40, s48
    s_cselect_b32 s21, s41, s49
    s_add_u32 m0, s78, 0x0
    s_nop 0
    buffer_load_dwordx4 v1, s[8:11], s62 offen lds
    buffer_load_dwordx4 v2, s[8:11], s62 offen offset:1024 lds
    s_add_u32 m0, s79, 0x0
    s_nop 0
    buffer_load_dwordx4 v3, s[12:15], s70 offen lds
    s_setprio 2
    s_lshl_b32 s83, s91, 7
    s_lshl_b32 s86, s6, 11
    s_cmp_eq_u32 s4, 0
    s_cselect_b32 s83, s86, s83
    s_movk_i32 s22, 0xe00
    s_cmov_b32 s22, 0x4000
    s_mov_b32 s23, 0x20000
    s_lshr_b32 s86, s79, 2
    s_add_u32 s83, s83, s86
    s_add_u32 m0, s86, 0x24400
    s_mov_b64 exec, 0xffff
    buffer_load_dwordx4 v11, s[20:23], s83 offen lds
    s_mov_b64 exec, -1
    s_add_u32 m0, s79, 0x2000
    s_nop 0
    buffer_load_dwordx4 v3, s[12:15], s71 offen lds
    v_mov_b32 v16, 0
    v_mov_b32 v17, 0
    v_mov_b32 v18, 0
    v_mov_b32 v19, 0
    s_mov_b32 s16, s58
    s_mov_b32 s17, s59
    s_mov_b32 s18, 0x1000000
    s_mov_b32 s19, 0x20000
    s_xor_b32 s61, s4, 1
    s_or_b32 s61, s61, s5
    s_cbranch_scc1 L_noinit
    s_mul_i32 s83, s6, 9344
    s_add_u32 s83, s83, s79
    s_add_u32 s83, s83, 0x20000
    buffer_store_dwordx4 v[16:19], v11, s[16:19], s83 offen sc1
    s_cmp_ge_u32 s3, 3
    s_cbranch_scc1 L_noinit
    s_lshl_b32 s86, s6, 10
    s_add_u32 s85, s83, 0x2000
    s_cmp_eq_u32 s3, 0
    s_cselect_b32 s86, s85, s86
    s_sub_u32 s85, s85, 0x780
    s_cmp_eq_u32 s3, 2
    s_cselect_b32 s86, s85, s86
    buffer_store_dwordx4 v[16:19], v11, s[16:19], s86 offen sc1
L_noinit:
    s_setprio 0
    s_lshr_b32 s80, s3, 2
    s_and_b32 s81, s3, 3
    v_lshrrev_b32 v32, 5, v0
    v_and_b32 v33, 31, v0
    v_bfe_u32 v34, v0, 1, 3
    v_xor_b32 v34, v34, v32
    s_lshl_b32 s83, s81, 12
    s_add_u32 s83, s83, 0x14000
    v_lshlrev_b32 v35, 7, v33
    v_add_u32 v35, s83, v35
    v_lshl_add_u32 v4, v34, 4, v35
    v_xor_b32 v5, 32, v4
    v_xor_b32 v6, 64, v4
    v_xor_b32 v7, 96, v4
    v_bfe_u32 v34, v0, 2, 2
    v_lshl_add_u32 v35, v32, 3, v34
    v_lshlrev_b32 v8, 7, v35
    v_lshrrev_b32 v34, 1, v34
    v_xor_b32 v34, s80, v34
    v_lshl_add_u32 v8, v34, 6, v8
    v_bfe_u32 v34, v0, 4, 1
    v_lshl_add_u32 v8, v34, 5, v8
    v_and_b32 v34, 3, v0
    v_lshl_add_u32 v8, v34, 3, v8
    s_add_u32 s83, s7, 3
    s_and_b32 s83, s83, 7
    s_mul_i32 s73, s83, s82
    s_lshl_b32 s83, s83, 7
    s_add_u32 s65, s83, s99
    s_cmp_lg_u32 s4, 0
    s_cbranch_scc1 L_mlp
    s_add_u32 s83, s7, 4
    s_and_b32 s83, s83, 7
    s_mul_i32 s74, s83, s82
    s_lshl_b32 s83, s83, 7
    s_add_u32 s66, s83, s99
    v_and_b32 v76, 16, v11
    v_add_u32 v76, 0x24c00, v76
    ds_write_b128 v76, v[16:19]
    s_waitcnt lgkmcnt(0)
    v_lshrrev_b32 v72, 5, v0
    v_bfe_u32 v73, v0, 2, 2
    v_lshl_add_u32 v73, v72, 2, v73
    v_lshlrev_b32 v73, 5, v73
    v_bfe_u32 v74, v0, 4, 1
    v_lshl_add_u32 v73, v74, 4, v73
    v_bfe_u32 v74, v0, 1, 1
    v_lshl_add_u32 v73, v74, 3, v73
    s_lshl_b32 s83, s80, 10
    s_add_u32 s83, s83, 0x24400
    v_add_u32 v77, s83, v73
    v_and_b32 v73, 31, v0
    v_lshlrev_b32 v72, 2, v72
    v_sub_u32 v73, v73, v72
    v_and_b32 v72, 1, v73
    v_lshlrev_b32 v72, 4, v72
    s_movk_i32 s83, 0x3f80
    v_lshlrev_b32 v72, v72, s83
    v_ashrrev_i32 v73, 1, v73
    v_cmp_eq_u32 s[90:91], 0, v73
    v_cmp_eq_u32 s[92:93], 1, v73
    v_cmp_eq_u32 s[94:95], 4, v73
    v_cmp_eq_u32 vcc, 5, v73
    v_cndmask_b32 v16, 0, v72, s[90:91]
    v_cndmask_b32 v17, 0, v72, s[92:93]
    v_cndmask_b32 v18, 0, v72, s[94:95]
    v_cndmask_b32 v19, 0, v72, vcc
    v_cmp_eq_u32 s[90:91], 8, v73
    v_cmp_eq_u32 s[92:93], 9, v73
    v_cmp_eq_u32 s[94:95], 12, v73
    v_cmp_eq_u32 vcc, 13, v73
    v_cndmask_b32 v20, 0, v72, s[90:91]
    v_cndmask_b32 v21, 0, v72, s[92:93]
    v_cndmask_b32 v22, 0, v72, s[94:95]
    v_cndmask_b32 v23, 0, v72, vcc
    v_bfe_i32 v78, v0, 2, 1
    v_and_b32 v78, 0x80008000, v78
    s_add_u32 s83, s7, 5
    s_and_b32 s83, s83, 7
    s_mul_i32 s75, s83, s82
    s_lshl_b32 s83, s83, 7
    s_add_u32 s67, s83, s99
    s_add_u32 s83, s7, 6
    s_and_b32 s83, s83, 7
    s_mul_i32 s76, s83, s82
    s_lshl_b32 s83, s83, 7
    s_add_u32 s68, s83, s99
    s_mov_b32 s89, 0x400
    s_mov_b32 s90, 0xfffff800
    v_add_u32 v9, 0x14000, v8
    v_add_u32 v12, 0x10000, v8
    s_mov_b32 s87, 0x3fb8aa3b
    s_add_u32 s83, s7, 7
    s_and_b32 s83, s83, 7
    s_mul_i32 s77, s83, s82
    s_lshl_b32 s83, s83, 7
    s_add_u32 s69, s83, s99
    s_bfe_u32 s98, s2, 0x30004
    s_add_u32 s83, s98, s4
    s_and_b32 s83, s83, 1
    s_bfe_u32 s84, s2, 0x10003
    s_lshl1_add_u32 s83, s84, s83
    s_and_b32 s97, s2, 7
    s_lshl2_add_u32 s97, s97, s83
    s_mov_b32 s20, s56
    s_mov_b32 s21, s57
    s_mov_b32 s22, 4
    s_mov_b32 s23, 0x20000
    s_mov_b32 s24, s50
    s_mov_b32 s25, s51
    s_mov_b32 s26, 0x1c0000
    s_mov_b32 s27, 0x20000
    s_sub_u32 s28, s42, 0x1c0000
    s_subb_u32 s29, s43, 0
    s_mov_b32 s30, 0x240000
    s_mov_b32 s31, 0x20000
    v_lshrrev_b32 v72, 3, v0
    v_bfe_u32 v73, v0, 4, 1
    v_lshlrev_b32 v73, 2, v73
    v_and_b32 v14, 7, v0
    v_xor_b32 v14, v14, v73
    v_lshlrev_b32 v14, 4, v14
    v_lshl_add_u32 v14, v72, 10, v14
    s_lshl_b32 s83, s98, 7
    v_add_u32 v14, s83, v14
    v_add_u32 v15, 0x1c00, v14
    s_lshl_b32 s62, s81, 11
    s_and_b32 s83, s97, 3
    s_lshl1_add_u32 s83, s83, s98
    s_and_b32 s83, s83, 7
    v_add_u32 v72, s83, v0
    v_and_b32 v72, 7, v72
    v_lshrrev_b32 v73, 2, v72
    v_mad_u32_u24 v72, v73, 12, v72
    v_lshrrev_b32 v73, 3, v0
    v_lshl_add_u32 v13, v73, 2, v72
    v_add_u32 v72, s83, v0
    v_and_b32 v72, 3, v72
    v_add_u32 v72, 12, v72
    v_cmp_gt_u32 vcc, 24, v0
    s_mul_i32 s84, s81, 28
    s_nop 0
    v_cndmask_b32 v13, v72, v13, vcc
    v_add_u32 v13, s84, v13
    s_add_u32 s83, s83, 4
    v_add_u32 v72, s83, v0
    v_and_b32 v72, 7, v72
    s_lshl3_add_u32 s84, s81, 0x70
    v_add_u32 v72, s84, v72
    v_cmp_gt_u32 vcc, 28, v0
    s_nop 1
    v_cndmask_b32 v13, v72, v13, vcc
    s_add_u32 m0, s78, 0x4000
    s_nop 0
    buffer_load_dwordx4 v1, s[8:11], s63 offen lds
    buffer_load_dwordx4 v2, s[8:11], s63 offen offset:1024 lds
    s_cmp_eq_u32 s4, 0
    s_movk_i32 s83, 0x80
    s_cmov_b32 s83, 0x400
    s_add_u32 s83, s83, s70
    s_add_u32 m0, s79, 0x10000
    s_nop 0
    buffer_load_dwordx4 v3, s[12:15], s83 offen lds
    s_add_u32 s83, s7, 2
    s_and_b32 s83, s83, 7
    s_mul_i32 s72, s83, s82
    s_lshl_b32 s83, s83, 7
    s_add_u32 s64, s83, s99
    s_add_u32 m0, s78, 0x8000
    s_nop 0
    buffer_load_dwordx4 v1, s[8:11], s64 offen lds
    buffer_load_dwordx4 v2, s[8:11], s64 offen offset:1024 lds
    s_add_u32 m0, s79, 0x4000
    s_nop 0
    buffer_load_dwordx4 v3, s[12:15], s72 offen lds
    s_waitcnt vmcnt(7)
    s_barrier
    ds_read_b128 v[128:131], v4 offset:0
    ds_read_b128 v[132:135], v5 offset:0
    ds_read_b128 v[136:139], v6 offset:0
    ds_read_b128 v[140:143], v7 offset:0
    ds_read_b64_tr_b16 v[24:25], v77 offset:0
    ds_read_b64_tr_b16 v[26:27], v77 offset:256
    ds_read_b64_tr_b16 v[28:29], v77 offset:512
    ds_read_b64_tr_b16 v[30:31], v77 offset:768
    ds_read_b64_tr_b16 v[80:81], v8 offset:0
    ds_read_b64_tr_b16 v[82:83], v8 offset:512
    ds_read_b64_tr_b16 v[84:85], v8 offset:2048
    ds_read_b64_tr_b16 v[86:87], v8 offset:2560
    ds_read_b64_tr_b16 v[88:89], v8 offset:4096
    ds_read_b64_tr_b16 v[90:91], v8 offset:4608
    s_add_u32 m0, s78, 0xc000
    s_nop 0
    buffer_load_dwordx4 v1, s[8:11], s65 offen lds
    buffer_load_dwordx4 v2, s[8:11], s65 offen offset:1024 lds
    s_waitcnt lgkmcnt(11)
    ds_read_b64_tr_b16 v[92:93], v8 offset:6144
    ds_read_b64_tr_b16 v[94:95], v8 offset:6656
    s_waitcnt lgkmcnt(6)
    v_mfma_f32_32x32x16_bf16 v[96:111], v[80:83], v[128:131], 0
    s_add_u32 m0, s79, 0x6000
    s_nop 0
    buffer_load_dwordx4 v3, s[12:15], s73 offen lds
    s_waitcnt vmcnt(7)
    s_barrier
    s_or_b32 s83, s61, s3
    s_cbranch_scc1 L_nosig1
    s_mov_b32 s60, 1
    s_atomic_add s60, s[56:57], 0
L_nosig1:
    ds_read_b128 v[144:147], v4 offset:16384
    ds_read_b128 v[148:151], v5 offset:16384
    ds_read_b128 v[152:155], v6 offset:16384
    ds_read_b128 v[156:159], v7 offset:16384
    ds_read_b64_tr_b16 v[80:81], v8 offset:8192
    ds_read_b64_tr_b16 v[82:83], v8 offset:8704
    s_waitcnt lgkmcnt(10)
    v_mfma_f32_32x32x16_bf16 v[96:111], v[84:87], v[132:135], v[96:111]
    s_add_u32 m0, s78, 0x0
    s_nop 0
    buffer_load_dwordx4 v1, s[8:11], s66 offen lds
    buffer_load_dwordx4 v2, s[8:11], s66 offen offset:1024 lds
    ds_read_b64_tr_b16 v[84:85], v8 offset:10240
    ds_read_b64_tr_b16 v[86:87], v8 offset:10752
    s_waitcnt lgkmcnt(10)
    v_mfma_f32_32x32x16_bf16 v[96:111], v[88:91], v[136:139], v[96:111]
    s_add_u32 m0, s79, 0x8000
    s_nop 0
    buffer_load_dwordx4 v3, s[12:15], s74 offen lds
    ds_read_b64_tr_b16 v[88:89], v8 offset:12288
    ds_read_b64_tr_b16 v[90:91], v8 offset:12800
    s_waitcnt lgkmcnt(10)
    v_mfma_f32_32x32x16_bf16 v[96:111], v[92:95], v[140:143], v[96:111]
    ds_read_b64_tr_b16 v[92:93], v8 offset:14336
    ds_read_b64_tr_b16 v[94:95], v8 offset:14848
    s_waitcnt lgkmcnt(6)
    v_mfma_f32_32x32x16_bf16 v[96:111], v[80:83], v[144:147], v[96:111]
    s_waitcnt vmcnt(6)
    s_barrier
    ds_read_b128 v[160:163], v4 offset:32768
    ds_read_b128 v[164:167], v5 offset:32768
    ds_read_b128 v[168:171], v6 offset:32768
    ds_read_b128 v[172:175], v7 offset:32768
    ds_read_b64_tr_b16 v[80:81], v8 offset:16384
    ds_read_b64_tr_b16 v[82:83], v8 offset:16896
    s_waitcnt lgkmcnt(10)
    v_mfma_f32_32x32x16_bf16 v[96:111], v[84:87], v[148:151], v[96:111]
    s_add_u32 m0, s78, 0x4000
    s_nop 0
    buffer_load_dwordx4 v1, s[8:11], s67 offen lds
    buffer_load_dwordx4 v2, s[8:11], s67 offen offset:1024 lds
    ds_read_b64_tr_b16 v[84:85], v8 offset:18432
    ds_read_b64_tr_b16 v[86:87], v8 offset:18944
    s_waitcnt lgkmcnt(10)
    v_mfma_f32_32x32x16_bf16 v[96:111], v[88:91], v[152:155], v[96:111]
    s_add_u32 m0, s79, 0xa000
    s_nop 0
    buffer_load_dwordx4 v3, s[12:15], s75 offen lds
    ds_read_b64_tr_b16 v[88:89], v8 offset:20480
    ds_read_b64_tr_b16 v[90:91], v8 offset:20992
    s_waitcnt lgkmcnt(10)
    v_mfma_f32_32x32x16_bf16 v[96:111], v[92:95], v[156:159], v[96:111]
    v_xor_b32 v24, v78, v24
    v_xor_b32 v25, v78, v25
    v_xor_b32 v26, v78, v26
    v_xor_b32 v27, v78, v27
    v_xor_b32 v28, v78, v28
    v_xor_b32 v29, v78, v29
    v_xor_b32 v30, v78, v30
    v_xor_b32 v31, v78, v31
    ds_read_b64_tr_b16 v[92:93], v8 offset:22528
    ds_read_b64_tr_b16 v[94:95], v8 offset:23040
    s_waitcnt lgkmcnt(6)
    v_mfma_f32_32x32x16_bf16 v[96:111], v[80:83], v[160:163], v[96:111]
    s_waitcnt vmcnt(6)
    s_barrier
    ds_read_b128 v[176:179], v4 offset:49152
    ds_read_b128 v[180:183], v5 offset:49152
    ds_read_b128 v[184:187], v6 offset:49152
    ds_read_b128 v[188:191], v7 offset:49152
    ds_read_b64_tr_b16 v[80:81], v8 offset:24576
    ds_read_b64_tr_b16 v[82:83], v8 offset:25088
    s_waitcnt lgkmcnt(10)
    v_mfma_f32_32x32x16_bf16 v[96:111], v[84:87], v[164:167], v[96:111]
    s_add_u32 m0, s78, 0x8000
    s_nop 0
    buffer_load_dwordx4 v1, s[8:11], s68 offen lds
    buffer_load_dwordx4 v2, s[8:11], s68 offen offset:1024 lds
    ds_read_b64_tr_b16 v[84:85], v8 offset:26624
    ds_read_b64_tr_b16 v[86:87], v8 offset:27136
    s_waitcnt lgkmcnt(10)
    v_mfma_f32_32x32x16_bf16 v[96:111], v[88:91], v[168:171], v[96:111]
    s_add_u32 m0, s79, 0xc000
    s_nop 0
    buffer_load_dwordx4 v3, s[12:15], s76 offen lds
    ds_read_b64_tr_b16 v[88:89], v8 offset:28672
    ds_read_b64_tr_b16 v[90:91], v8 offset:29184
    s_waitcnt lgkmcnt(10)
    v_mfma_f32_32x32x16_bf16 v[96:111], v[92:95], v[172:175], v[96:111]
    ds_read_b64_tr_b16 v[92:93], v8 offset:30720
    ds_read_b64_tr_b16 v[94:95], v8 offset:31232
    s_waitcnt lgkmcnt(6)
    v_mfma_f32_32x32x16_bf16 v[96:111], v[80:83], v[176:179], v[96:111]
    s_waitcnt vmcnt(6)
    s_barrier
    ds_read_b128 v[192:195], v4 offset:0
    ds_read_b128 v[196:199], v5 offset:0
    ds_read_b128 v[200:203], v6 offset:0
    ds_read_b128 v[204:207], v7 offset:0
    ds_read_b64_tr_b16 v[80:81], v8 offset:32768
    ds_read_b64_tr_b16 v[82:83], v8 offset:33280
    s_waitcnt lgkmcnt(10)
    v_mfma_f32_32x32x16_bf16 v[96:111], v[84:87], v[180:183], v[96:111]
    s_add_u32 m0, s78, 0xc000
    s_nop 0
    buffer_load_dwordx4 v1, s[8:11], s69 offen lds
    buffer_load_dwordx4 v2, s[8:11], s69 offen offset:1024 lds
    ds_read_b64_tr_b16 v[84:85], v8 offset:34816
    ds_read_b64_tr_b16 v[86:87], v8 offset:35328
    s_waitcnt lgkmcnt(10)
    v_mfma_f32_32x32x16_bf16 v[96:111], v[88:91], v[184:187], v[96:111]
    s_add_u32 m0, s79, 0xe000
    s_nop 0
    buffer_load_dwordx4 v3, s[12:15], s77 offen lds
    ds_read_b64_tr_b16 v[88:89], v8 offset:36864
    ds_read_b64_tr_b16 v[90:91], v8 offset:37376
    s_waitcnt lgkmcnt(10)
    v_mfma_f32_32x32x16_bf16 v[96:111], v[92:95], v[188:191], v[96:111]
    ds_read_b64_tr_b16 v[92:93], v8 offset:38912
    ds_read_b64_tr_b16 v[94:95], v8 offset:39424
    s_waitcnt lgkmcnt(6)
    v_mfma_f32_32x32x16_bf16 v[96:111], v[80:83], v[192:195], v[96:111]
    s_waitcnt vmcnt(6)
    s_barrier
    ds_read_b128 v[208:211], v4 offset:16384
    ds_read_b128 v[212:215], v5 offset:16384
    ds_read_b128 v[216:219], v6 offset:16384
    ds_read_b128 v[220:223], v7 offset:16384
    ds_read_b64_tr_b16 v[80:81], v8 offset:40960
    ds_read_b64_tr_b16 v[82:83], v8 offset:41472
    s_waitcnt lgkmcnt(10)
    v_mfma_f32_32x32x16_bf16 v[96:111], v[84:87], v[196:199], v[96:111]
    v_add_u32 v3, s89, v3
    s_add_u32 m0, s79, 0x12000
    s_nop 0
    buffer_load_dwordx4 v3, s[12:15], s71 offen lds
    ds_read_b64_tr_b16 v[84:85], v8 offset:43008
    ds_read_b64_tr_b16 v[86:87], v8 offset:43520
    s_waitcnt lgkmcnt(10)
    v_mfma_f32_32x32x16_bf16 v[96:111], v[88:91], v[200:203], v[96:111]
    s_add_u32 m0, s79, 0x0
    s_nop 0
    buffer_load_dwordx4 v3, s[12:15], s72 offen lds
    ds_read_b64_tr_b16 v[88:89], v8 offset:45056
    ds_read_b64_tr_b16 v[90:91], v8 offset:45568
    s_waitcnt lgkmcnt(10)
    v_mfma_f32_32x32x16_bf16 v[96:111], v[92:95], v[204:207], v[96:111]
    s_add_u32 m0, s79, 0x2000
    s_nop 0
    buffer_load_dwordx4 v3, s[12:15], s73 offen lds
    ds_read_b64_tr_b16 v[92:93], v8 offset:47104
    ds_read_b64_tr_b16 v[94:95], v8 offset:47616
    s_waitcnt lgkmcnt(6)
    v_mfma_f32_32x32x16_bf16 v[96:111], v[80:83], v[208:211], v[96:111]
    s_waitcnt vmcnt(6)
    s_barrier
    ds_read_b128 v[224:227], v4 offset:32768
    ds_read_b128 v[228:231], v5 offset:32768
    ds_read_b128 v[232:235], v6 offset:32768
    ds_read_b128 v[236:239], v7 offset:32768
    ds_read_b64_tr_b16 v[80:81], v8 offset:49152
    ds_read_b64_tr_b16 v[82:83], v8 offset:49664
    s_waitcnt lgkmcnt(10)
    v_mfma_f32_32x32x16_bf16 v[96:111], v[84:87], v[212:215], v[96:111]
    s_add_u32 m0, s79, 0x4000
    s_nop 0
    buffer_load_dwordx4 v3, s[12:15], s74 offen lds
    ds_read_b64_tr_b16 v[84:85], v8 offset:51200
    ds_read_b64_tr_b16 v[86:87], v8 offset:51712
    s_waitcnt lgkmcnt(10)
    v_mfma_f32_32x32x16_bf16 v[96:111], v[88:91], v[216:219], v[96:111]
    s_add_u32 m0, s79, 0x6000
    s_nop 0
    buffer_load_dwordx4 v3, s[12:15], s75 offen lds
    ds_read_b64_tr_b16 v[88:89], v8 offset:53248
    ds_read_b64_tr_b16 v[90:91], v8 offset:53760
    s_waitcnt lgkmcnt(10)
    v_mfma_f32_32x32x16_bf16 v[96:111], v[92:95], v[220:223], v[96:111]
    s_add_u32 m0, s79, 0x8000
    s_nop 0
    buffer_load_dwordx4 v3, s[12:15], s76 offen lds
    ds_read_b64_tr_b16 v[92:93], v8 offset:55296
    ds_read_b64_tr_b16 v[94:95], v8 offset:55808
    s_waitcnt lgkmcnt(6)
    v_mfma_f32_32x32x16_bf16 v[96:111], v[80:83], v[224:227], v[96:111]
    s_waitcnt vmcnt(6)
    s_barrier
    ds_read_b128 v[240:243], v4 offset:49152
    ds_read_b128 v[244:247], v5 offset:49152
    ds_read_b128 v[248:251], v6 offset:49152
    ds_read_b128 v[252:255], v7 offset:49152
    ds_read_b64_tr_b16 v[80:81], v8 offset:57344
    ds_read_b64_tr_b16 v[82:83], v8 offset:57856
    s_waitcnt lgkmcnt(10)
    v_mfma_f32_32x32x16_bf16 v[96:111], v[84:87], v[228:231], v[96:111]
    s_add_u32 m0, s79, 0xa000
    s_nop 0
    buffer_load_dwordx4 v3, s[12:15], s77 offen lds
    ds_read_b64_tr_b16 v[84:85], v8 offset:59392
    ds_read_b64_tr_b16 v[86:87], v8 offset:59904
    s_waitcnt lgkmcnt(10)
    v_mfma_f32_32x32x16_bf16 v[96:111], v[88:91], v[232:235], v[96:111]
    ds_read_b64_tr_b16 v[88:89], v8 offset:61440
    ds_read_b64_tr_b16 v[90:91], v8 offset:61952
    s_waitcnt lgkmcnt(10)
    v_mfma_f32_32x32x16_bf16 v[96:111], v[92:95], v[236:239], v[96:111]
    ds_read_b64_tr_b16 v[92:93], v8 offset:63488
    ds_read_b64_tr_b16 v[94:95], v8 offset:64000
    s_waitcnt lgkmcnt(6)
    v_mfma_f32_32x32x16_bf16 v[96:111], v[80:83], v[240:243], v[96:111]
    s_waitcnt lgkmcnt(4)
    v_mfma_f32_32x32x16_bf16 v[96:111], v[84:87], v[244:247], v[96:111]
    s_waitcnt lgkmcnt(2)
    v_mfma_f32_32x32x16_bf16 v[96:111], v[88:91], v[248:251], v[96:111]
    s_waitcnt lgkmcnt(0)
    v_mfma_f32_32x32x16_bf16 v[96:111], v[92:95], v[252:255], v[96:111]
    s_lshl_b32 s83, s81, 1
    s_sub_u32 s83, s83, s3
    s_mul_i32 s83, s83, s96
    s_add_u32 s83, s83, s90
    v_add_u32 v6, s83, v3
    s_sub_u32 s83, s96, 0x400
    v_add_u32 v7, s83, v6
    s_lshl_b32 s88, s81, 11
    s_lshl2_add_u32 s83, s5, s81
    s_mul_i32 s83, s83, 0x24000
    v_add_u32 v1, s83, v11
    s_waitcnt vmcnt(4)
    s_barrier
    buffer_load_dword v2, off, s[20:23], 0 sc1
    s_cmp_lg_u32 s80, 0
    s_cbranch_scc1 L_attp
    v_cvt_pk_bf16_f32 v64, v96, v97
    v_cvt_pk_bf16_f32 v65, v98, v99
    v_cvt_pk_bf16_f32 v66, v100, v101
    v_cvt_pk_bf16_f32 v67, v102, v103
    v_cvt_pk_bf16_f32 v68, v104, v105
    v_cvt_pk_bf16_f32 v69, v106, v107
    v_cvt_pk_bf16_f32 v70, v108, v109
    v_cvt_pk_bf16_f32 v71, v110, v111
    s_setprio 2
    v_mfma_f32_32x32x16_bf16 v[32:47], v[24:27], v[64:67], 0
    v_mfma_f32_32x32x16_bf16 v[48:63], v[28:31], v[68:71], 0
    s_setprio 0
    s_mul_i32 s84, s6, 9344
    s_add_u32 s84, s84, 0x20000
    s_lshl_b32 s85, s81, 11
    s_add_u32 s85, s85, s84
    v_lshl_add_u32 v4, v0, 2, s85
    s_lshl_b32 s85, s81, 8
    s_add_u32 s85, s85, s84
    s_add_u32 s92, s85, 0x2000
    v_and_b32 v5, 48, v0
    v_lshlrev_b32 v5, 2, v5
    s_nop 0
    v_max3_f32 v76, v32, v33, v34
    v_max3_f32 v76, v76, v35, v36
    v_max3_f32 v76, v76, v37, v38
    v_max3_f32 v76, v76, v39, v40
    v_max3_f32 v76, v76, v41, v42
    v_max3_f32 v76, v76, v43, v44
    v_max3_f32 v76, v76, v45, v46
    v_max_f32 v76, v76, v47
    v_mul_f32 v76, s87, v76
    v_fma_f32 v32, v32, s87, -v76
    v_fma_f32 v33, v33, s87, -v76
    v_fma_f32 v34, v34, s87, -v76
    v_fma_f32 v35, v35, s87, -v76
    v_fma_f32 v36, v36, s87, -v76
    v_fma_f32 v37, v37, s87, -v76
    v_fma_f32 v38, v38, s87, -v76
    v_fma_f32 v39, v39, s87, -v76
    v_fma_f32 v40, v40, s87, -v76
    v_fma_f32 v41, v41, s87, -v76
    v_fma_f32 v42, v42, s87, -v76
    v_fma_f32 v43, v43, s87, -v76
    v_fma_f32 v44, v44, s87, -v76
    v_fma_f32 v45, v45, s87, -v76
    v_fma_f32 v46, v46, s87, -v76
    v_fma_f32 v47, v47, s87, -v76
    v_exp_f32 v32, v32
    v_exp_f32 v33, v33
    v_exp_f32 v34, v34
    v_exp_f32 v35, v35
    v_exp_f32 v36, v36
    v_exp_f32 v37, v37
    v_exp_f32 v38, v38
    v_exp_f32 v39, v39
    v_exp_f32 v40, v40
    v_exp_f32 v41, v41
    v_exp_f32 v42, v42
    v_exp_f32 v43, v43
    v_exp_f32 v44, v44
    v_exp_f32 v45, v45
    v_exp_f32 v46, v46
    v_exp_f32 v47, v47
    v_add_f32 v77, v32, v33
    v_add_f32 v76, v34, v35
    v_add_f32 v77, v77, v36
    v_add_f32 v76, v76, v37
    v_add_f32 v77, v77, v38
    v_add_f32 v76, v76, v39
    v_add_f32 v77, v77, v40
    v_add_f32 v76, v76, v41
    v_add_f32 v77, v77, v42
    v_add_f32 v76, v76, v43
    v_add_f32 v77, v77, v44
    v_add_f32 v76, v76, v45
    v_add_f32 v77, v77, v46
    v_add_f32 v76, v76, v47
    v_add_f32 v77, v77, v76
    v_rcp_f32 v77, v77
    s_nop 0
    v_mul_f32 v32, v77, v32
    v_mul_f32 v33, v77, v33
    v_mul_f32 v34, v77, v34
    v_mul_f32 v35, v77, v35
    v_mul_f32 v36, v77, v36
    v_mul_f32 v37, v77, v37
    v_mul_f32 v38, v77, v38
    v_mul_f32 v39, v77, v39
    v_mul_f32 v40, v77, v40
    v_mul_f32 v41, v77, v41
    v_mul_f32 v42, v77, v42
    v_mul_f32 v43, v77, v43
    v_mul_f32 v44, v77, v44
    v_mul_f32 v45, v77, v45
    v_mul_f32 v46, v77, v46
    v_mul_f32 v47, v77, v47
    v_cvt_pk_bf16_f32 v64, v32, v33
    v_cvt_pk_bf16_f32 v65, v34, v35
    v_cvt_pk_bf16_f32 v66, v36, v37
    v_cvt_pk_bf16_f32 v67, v38, v39
    v_cvt_pk_bf16_f32 v68, v40, v41
    v_cvt_pk_bf16_f32 v69, v42, v43
    v_cvt_pk_bf16_f32 v70, v44, v45
    v_cvt_pk_bf16_f32 v71, v46, v47
    s_setprio 2
    v_mfma_f32_32x32x16_bf16 v[96:111], v[64:67], v[16:19], 0
    v_mfma_f32_32x32x16_bf16 v[96:111], v[68:71], v[20:23], v[96:111]
    s_setprio 0
    s_waitcnt vmcnt(1)
    s_barrier
    v_max3_f32 v76, v48, v49, v50
    v_max3_f32 v76, v76, v51, v52
    v_max3_f32 v76, v76, v53, v54
    v_max3_f32 v76, v76, v55, v56
    v_max3_f32 v76, v76, v57, v58
    v_max3_f32 v76, v76, v59, v60
    v_max3_f32 v76, v76, v61, v62
    v_max_f32 v76, v76, v63
    v_mul_f32 v76, s87, v76
    v_fma_f32 v48, v48, s87, -v76
    v_fma_f32 v49, v49, s87, -v76
    v_fma_f32 v50, v50, s87, -v76
    v_fma_f32 v51, v51, s87, -v76
    v_fma_f32 v52, v52, s87, -v76
    v_fma_f32 v53, v53, s87, -v76
    v_fma_f32 v54, v54, s87, -v76
    v_fma_f32 v55, v55, s87, -v76
    v_fma_f32 v56, v56, s87, -v76
    v_fma_f32 v57, v57, s87, -v76
    v_fma_f32 v58, v58, s87, -v76
    v_cvt_pk_bf16_f32 v32, v96, v97
    v_cvt_pk_bf16_f32 v33, v98, v99
    v_cvt_pk_bf16_f32 v34, v100, v101
    v_cvt_pk_bf16_f32 v35, v102, v103
    v_cvt_pk_bf16_f32 v36, v104, v105
    v_cvt_pk_bf16_f32 v37, v106, v107
    v_cvt_pk_bf16_f32 v38, v108, v109
    v_cvt_pk_bf16_f32 v39, v110, v111
    v_fma_f32 v59, v59, s87, -v76
    v_fma_f32 v60, v60, s87, -v76
    v_fma_f32 v61, v61, s87, -v76
    v_fma_f32 v62, v62, s87, -v76
    v_fma_f32 v63, v63, s87, -v76
    v_exp_f32 v48, v48
    v_exp_f32 v49, v49
    v_exp_f32 v50, v50
    v_exp_f32 v51, v51
    v_exp_f32 v52, v52
    v_exp_f32 v53, v53
    v_exp_f32 v54, v54
    v_exp_f32 v55, v55
    v_exp_f32 v56, v56
    v_exp_f32 v57, v57
    v_exp_f32 v58, v58
    v_exp_f32 v59, v59
    v_exp_f32 v60, v60
    v_exp_f32 v61, v61
    v_exp_f32 v62, v62
    v_exp_f32 v63, v63
    v_add_f32 v77, v48, v49
    v_add_f32 v76, v50, v51
    v_add_f32 v77, v77, v52
    v_add_f32 v76, v76, v53
    v_add_f32 v77, v77, v54
    v_add_f32 v76, v76, v55
    v_add_f32 v77, v77, v56
    v_add_f32 v76, v76, v57
    v_add_f32 v77, v77, v58
    v_add_f32 v76, v76, v59
    v_add_f32 v77, v77, v60
    v_add_f32 v76, v76, v61
    v_add_f32 v77, v77, v62
    v_add_f32 v76, v76, v63
    v_add_f32 v77, v77, v76
    v_rcp_f32 v77, v77
    s_nop 0
    v_mul_f32 v48, v77, v48
    v_mul_f32 v49, v77, v49
    v_mul_f32 v50, v77, v50
    v_mul_f32 v51, v77, v51
    v_mul_f32 v52, v77, v52
    v_mul_f32 v53, v77, v53
    v_mul_f32 v54, v77, v54
    v_mul_f32 v55, v77, v55
    v_mul_f32 v56, v77, v56
    v_mul_f32 v57, v77, v57
    v_mul_f32 v58, v77, v58
    v_mul_f32 v59, v77, v59
    v_mul_f32 v60, v77, v60
    v_mul_f32 v61, v77, v61
    v_mul_f32 v62, v77, v62
    v_mul_f32 v63, v77, v63
    v_cvt_pk_bf16_f32 v64, v48, v49
    v_cvt_pk_bf16_f32 v65, v50, v51
    v_cvt_pk_bf16_f32 v66, v52, v53
    v_cvt_pk_bf16_f32 v67, v54, v55
    v_cvt_pk_bf16_f32 v68, v56, v57
    v_cvt_pk_bf16_f32 v69, v58, v59
    v_cvt_pk_bf16_f32 v70, v60, v61
    v_cvt_pk_bf16_f32 v71, v62, v63
    s_setprio 2
    v_mfma_f32_32x32x16_bf16 v[96:111], v[64:67], v[16:19], 0
    v_mfma_f32_32x32x16_bf16 v[96:111], v[68:71], v[20:23], v[96:111]
    s_setprio 0
    ds_read_b64_tr_b16 v[80:81], v12 offset:0
    ds_read_b64_tr_b16 v[82:83], v12 offset:512
    ds_read_b64_tr_b16 v[84:85], v12 offset:2048
    ds_read_b64_tr_b16 v[86:87], v12 offset:2560
    ds_read_b64_tr_b16 v[88:89], v12 offset:4096
    ds_read_b64_tr_b16 v[90:91], v12 offset:4608
    ds_read_b64_tr_b16 v[92:93], v12 offset:6144
    ds_read_b64_tr_b16 v[94:95], v12 offset:6656
    s_waitcnt lgkmcnt(6)
    v_mfma_f32_32x32x16_bf16 v[112:127], v[128:131], v[80:83], 0
    ds_read_b64_tr_b16 v[80:81], v12 offset:8192
    ds_read_b64_tr_b16 v[82:83], v12 offset:8704
    s_waitcnt lgkmcnt(6)
    v_mfma_f32_32x32x16_bf16 v[112:127], v[132:135], v[84:87], v[112:127]
    ds_read_b64_tr_b16 v[84:85], v12 offset:10240
    ds_read_b64_tr_b16 v[86:87], v12 offset:10752
    s_waitcnt lgkmcnt(6)
    v_mfma_f32_32x32x16_bf16 v[112:127], v[136:139], v[88:91], v[112:127]
    s_add_u32 m0, s88, 0x1c000
    s_nop 0
    buffer_load_dwordx4 v6, s[12:15], s74 offen lds
    buffer_load_dwordx4 v7, s[12:15], s74 offen offset:1024 lds
    ds_read_b64_tr_b16 v[88:89], v12 offset:12288
    ds_read_b64_tr_b16 v[90:91], v12 offset:12800
    s_waitcnt lgkmcnt(6)
    v_mfma_f32_32x32x16_bf16 v[112:127], v[140:143], v[92:95], v[112:127]
    s_add_u32 m0, s88, 0x1e000
    s_nop 0
    buffer_load_dwordx4 v6, s[12:15], s75 offen lds
    ds_read_b64_tr_b16 v[92:93], v12 offset:14336
    ds_read_b64_tr_b16 v[94:95], v12 offset:14848
    s_waitcnt lgkmcnt(6)
    v_mfma_f32_32x32x16_bf16 v[112:127], v[144:147], v[80:83], v[112:127]
    buffer_load_dwordx4 v7, s[12:15], s75 offen offset:1024 lds
    s_add_u32 m0, s88, 0x20000
    s_nop 0
    buffer_load_dwordx4 v6, s[12:15], s76 offen lds
    ds_read_b64_tr_b16 v[80:81], v8 offset:0
    ds_read_b64_tr_b16 v[82:83], v8 offset:512
    s_waitcnt lgkmcnt(6)
    v_mfma_f32_32x32x16_bf16 v[112:127], v[148:151], v[84:87], v[112:127]
    buffer_load_dwordx4 v7, s[12:15], s76 offen offset:1024 lds
    s_add_u32 m0, s88, 0x22000
    s_nop 0
    buffer_load_dwordx4 v6, s[12:15], s77 offen lds
    ds_read_b64_tr_b16 v[84:85], v8 offset:2048
    ds_read_b64_tr_b16 v[86:87], v8 offset:2560
    s_waitcnt lgkmcnt(6)
    v_mfma_f32_32x32x16_bf16 v[112:127], v[152:155], v[88:91], v[112:127]
    buffer_load_dwordx4 v7, s[12:15], s77 offen offset:1024 lds
    ds_read_b64_tr_b16 v[88:89], v8 offset:4096
    ds_read_b64_tr_b16 v[90:91], v8 offset:4608
    s_waitcnt lgkmcnt(6)
    v_mfma_f32_32x32x16_bf16 v[112:127], v[156:159], v[92:95], v[112:127]
    ds_read_b64_tr_b16 v[92:93], v8 offset:6144
    ds_read_b64_tr_b16 v[94:95], v8 offset:6656
    s_waitcnt lgkmcnt(6)
    v_mfma_f32_32x32x16_bf16 v[112:127], v[160:163], v[80:83], v[112:127]
    s_and_b32 s83, s2, 0x7f
    s_lshl2_add_u32 s83, s83, s81
    s_mul_i32 s84, s83, 0xe00
    v_lshlrev_b32 v72, 7, v0
    s_mov_b64 exec, 0xfffffff
    buffer_load_dword v79, v72, s[24:27], s84 offen
    s_lshl_b32 s83, s83, 10
    s_add_u32 s83, s83, 0x1c0000
    s_mov_b64 exec, 0xff
    buffer_load_dword v79, v72, s[28:31], s83 offen
    s_mov_b64 exec, -1
    ds_read_b64_tr_b16 v[80:81], v8 offset:8192
    ds_read_b64_tr_b16 v[82:83], v8 offset:8704
    s_waitcnt lgkmcnt(6)
    v_mfma_f32_32x32x16_bf16 v[112:127], v[164:167], v[84:87], v[112:127]
    ds_read_b64_tr_b16 v[84:85], v8 offset:10240
    ds_read_b64_tr_b16 v[86:87], v8 offset:10752
    s_waitcnt lgkmcnt(6)
    v_mfma_f32_32x32x16_bf16 v[112:127], v[168:171], v[88:91], v[112:127]
    ds_read_b64_tr_b16 v[88:89], v8 offset:12288
    ds_read_b64_tr_b16 v[90:91], v8 offset:12800
    s_waitcnt lgkmcnt(6)
    v_mfma_f32_32x32x16_bf16 v[112:127], v[172:175], v[92:95], v[112:127]
    ds_read_b64_tr_b16 v[92:93], v8 offset:14336
    ds_read_b64_tr_b16 v[94:95], v8 offset:14848
    s_waitcnt lgkmcnt(6)
    v_mfma_f32_32x32x16_bf16 v[112:127], v[176:179], v[80:83], v[112:127]
    ds_read_b64_tr_b16 v[80:81], v8 offset:16384
    ds_read_b64_tr_b16 v[82:83], v8 offset:16896
    s_waitcnt lgkmcnt(6)
    v_mfma_f32_32x32x16_bf16 v[112:127], v[180:183], v[84:87], v[112:127]
    ds_read_b64_tr_b16 v[84:85], v8 offset:18432
    ds_read_b64_tr_b16 v[86:87], v8 offset:18944
    s_waitcnt lgkmcnt(6)
    v_mfma_f32_32x32x16_bf16 v[112:127], v[184:187], v[88:91], v[112:127]
    ds_read_b64_tr_b16 v[88:89], v8 offset:20480
    ds_read_b64_tr_b16 v[90:91], v8 offset:20992
    s_waitcnt lgkmcnt(6)
    v_mfma_f32_32x32x16_bf16 v[112:127], v[188:191], v[92:95], v[112:127]
    ds_read_b64_tr_b16 v[92:93], v8 offset:22528
    ds_read_b64_tr_b16 v[94:95], v8 offset:23040
    s_waitcnt lgkmcnt(6)
    v_mfma_f32_32x32x16_bf16 v[112:127], v[192:195], v[80:83], v[112:127]
    ds_read_b64_tr_b16 v[80:81], v8 offset:24576
    ds_read_b64_tr_b16 v[82:83], v8 offset:25088
    s_waitcnt lgkmcnt(6)
    v_mfma_f32_32x32x16_bf16 v[112:127], v[196:199], v[84:87], v[112:127]
    ds_read_b64_tr_b16 v[84:85], v8 offset:26624
    ds_read_b64_tr_b16 v[86:87], v8 offset:27136
    s_waitcnt lgkmcnt(6)
    v_mfma_f32_32x32x16_bf16 v[112:127], v[200:203], v[88:91], v[112:127]
    ds_read_b64_tr_b16 v[88:89], v8 offset:28672
    ds_read_b64_tr_b16 v[90:91], v8 offset:29184
    s_waitcnt lgkmcnt(6)
    v_mfma_f32_32x32x16_bf16 v[112:127], v[204:207], v[92:95], v[112:127]
    ds_read_b64_tr_b16 v[92:93], v8 offset:30720
    ds_read_b64_tr_b16 v[94:95], v8 offset:31232
    s_waitcnt lgkmcnt(6)
    v_mfma_f32_32x32x16_bf16 v[112:127], v[208:211], v[80:83], v[112:127]
    ds_read_b64_tr_b16 v[80:81], v8 offset:32768
    ds_read_b64_tr_b16 v[82:83], v8 offset:33280
    s_waitcnt lgkmcnt(6)
    v_mfma_f32_32x32x16_bf16 v[112:127], v[212:215], v[84:87], v[112:127]
    ds_read_b64_tr_b16 v[84:85], v8 offset:34816
    ds_read_b64_tr_b16 v[86:87], v8 offset:35328
    s_waitcnt lgkmcnt(6)
    v_mfma_f32_32x32x16_bf16 v[112:127], v[216:219], v[88:91], v[112:127]
    ds_read_b64_tr_b16 v[88:89], v8 offset:36864
    ds_read_b64_tr_b16 v[90:91], v8 offset:37376
    s_waitcnt lgkmcnt(6)
    v_mfma_f32_32x32x16_bf16 v[112:127], v[220:223], v[92:95], v[112:127]
    ds_read_b64_tr_b16 v[92:93], v8 offset:38912
    ds_read_b64_tr_b16 v[94:95], v8 offset:39424
    s_waitcnt lgkmcnt(6)
    v_mfma_f32_32x32x16_bf16 v[112:127], v[224:227], v[80:83], v[112:127]
    ds_read_b64_tr_b16 v[80:81], v8 offset:40960
    ds_read_b64_tr_b16 v[82:83], v8 offset:41472
    s_waitcnt lgkmcnt(6)
    v_mfma_f32_32x32x16_bf16 v[112:127], v[228:231], v[84:87], v[112:127]
    ds_read_b64_tr_b16 v[84:85], v8 offset:43008
    ds_read_b64_tr_b16 v[86:87], v8 offset:43520
    s_waitcnt lgkmcnt(6)
    v_mfma_f32_32x32x16_bf16 v[112:127], v[232:235], v[88:91], v[112:127]
    ds_read_b64_tr_b16 v[88:89], v8 offset:45056
    ds_read_b64_tr_b16 v[90:91], v8 offset:45568
    s_waitcnt lgkmcnt(6)
    v_mfma_f32_32x32x16_bf16 v[112:127], v[236:239], v[92:95], v[112:127]
    ds_read_b64_tr_b16 v[92:93], v8 offset:47104
    ds_read_b64_tr_b16 v[94:95], v8 offset:47616
    s_waitcnt lgkmcnt(6)
    v_mfma_f32_32x32x16_bf16 v[112:127], v[240:243], v[80:83], v[112:127]
    s_barrier
    s_waitcnt lgkmcnt(4)
    v_mfma_f32_32x32x16_bf16 v[112:127], v[244:247], v[84:87], v[112:127]
    s_waitcnt lgkmcnt(2)
    v_mfma_f32_32x32x16_bf16 v[112:127], v[248:251], v[88:91], v[112:127]
    s_waitcnt lgkmcnt(0)
    v_mfma_f32_32x32x16_bf16 v[112:127], v[252:255], v[92:95], v[112:127]
    s_lshl_b32 s84, s81, 11
    s_add_u32 s84, s84, 0xc000
    v_add_u32 v73, s84, v11
    s_nop 8
    v_cvt_pk_bf16_f32 v48, v112, v113
    v_cvt_pk_bf16_f32 v49, v114, v115
    v_cvt_pk_bf16_f32 v50, v116, v117
    v_cvt_pk_bf16_f32 v51, v118, v119
    v_cvt_pk_bf16_f32 v52, v120, v121
    v_cvt_pk_bf16_f32 v53, v122, v123
    v_cvt_pk_bf16_f32 v54, v124, v125
    v_cvt_pk_bf16_f32 v55, v126, v127
    v_mov_b32 v56, 0x3f803f80
    v_mov_b32 v57, 0x3f803f80
    v_mov_b32 v58, 0x3f803f80
    v_mov_b32 v59, 0x3f803f80
    v_mov_b32 v60, 0x3f803f80
    v_mov_b32 v61, 0x3f803f80
    v_mov_b32 v62, 0x3f803f80
    v_mov_b32 v63, 0x3f803f80
    v_permlane16_swap_b32 v48, v56
    v_permlane16_swap_b32 v49, v57
    v_permlane16_swap_b32 v50, v58
    v_permlane16_swap_b32 v51, v59
    v_permlane16_swap_b32 v52, v60
    v_permlane16_swap_b32 v53, v61
    v_permlane16_swap_b32 v54, v62
    v_permlane16_swap_b32 v55, v63
    v_cvt_pk_bf16_f32 v40, v96, v97
    v_cvt_pk_bf16_f32 v41, v98, v99
    s_setprio 2
    v_mfma_f32_32x32x16_bf16 v[112:127], v[32:35], v[48:51], 0
    v_mfma_f32_32x32x16_bf16 v[112:127], v[36:39], v[52:55], v[112:127]
    s_setprio 0
    v_cvt_pk_bf16_f32 v42, v100, v101
    v_cvt_pk_bf16_f32 v43, v102, v103
    v_cvt_pk_bf16_f32 v44, v104, v105
    v_cvt_pk_bf16_f32 v45, v106, v107
    v_cvt_pk_bf16_f32 v46, v108, v109
    v_cvt_pk_bf16_f32 v47, v110, v111
    s_nop 0
    s_setprio 2
    v_mfma_f32_32x32x16_bf16 v[96:111], v[40:43], v[56:59], 0
    v_mfma_f32_32x32x16_bf16 v[96:111], v[44:47], v[60:63], v[96:111]
    s_setprio 0
    v_cvt_pk_bf16_f32 v64, v112, v113
    v_cvt_pk_bf16_f32 v65, v114, v115
    v_cvt_pk_bf16_f32 v66, v116, v117
    v_cvt_pk_bf16_f32 v67, v118, v119
    v_cvt_pk_bf16_f32 v68, v120, v121
    v_cvt_pk_bf16_f32 v69, v122, v123
    v_cvt_pk_bf16_f32 v70, v124, v125
    v_cvt_pk_bf16_f32 v71, v126, v127
    ds_write_b128 v73, v[64:67] offset:0
    ds_write_b128 v73, v[68:71] offset:1024
    s_lshr_b32 s84, s81, 1
    s_lshl_b32 s84, s84, 13
    s_and_b32 s85, s81, 1
    s_lshl_b32 s85, s85, 10
    s_add_u32 s84, s84, s85
    s_add_u32 s84, s84, 0x10000
    v_add_u32 v74, s84, v11
    v_add_u32 v75, 0xffffc000, v74
    s_waitcnt vmcnt(10)
    v_readfirstlane_b32 s83, v2
    s_movk_i32 s84, 0x7fff
L_kvi_chk:
    s_cmp_ge_u32 s83, 8
    s_cbranch_scc1 L_kvi_ok
    s_sub_u32 s84, s84, 1
    s_cbranch_scc1 L_kvi_ok
    buffer_load_dword v2, off, s[20:23], 0 sc1
    s_waitcnt vmcnt(0)
    v_readfirstlane_b32 s83, v2
    s_branch L_kvi_chk
L_kvi_ok:
    v_cvt_pk_bf16_f32 v112, v96, v97
    v_cvt_pk_bf16_f32 v113, v98, v99
    v_cvt_pk_bf16_f32 v114, v100, v101
    v_cvt_pk_bf16_f32 v115, v102, v103
    v_cvt_pk_bf16_f32 v116, v104, v105
    v_cvt_pk_bf16_f32 v117, v106, v107
    v_cvt_pk_bf16_f32 v118, v108, v109
    v_cvt_pk_bf16_f32 v119, v110, v111
    ds_write_b128 v73, v[112:115] offset:8192
    ds_write_b128 v73, v[116:119] offset:9216
    s_waitcnt vmcnt(2) lgkmcnt(0)
    s_barrier
    ds_read_b128 v[32:35], v75 offset:0
    ds_read_b128 v[36:39], v75 offset:2048
    ds_read_b128 v[40:43], v75 offset:4096
    ds_read_b128 v[44:47], v75 offset:6144
    ds_read_b128 v[48:51], v74 offset:0
    ds_read_b128 v[52:55], v74 offset:2048
    ds_read_b128 v[56:59], v74 offset:4096
    ds_read_b128 v[60:63], v74 offset:6144
    s_setprio 2
    s_waitcnt lgkmcnt(7)
    v_mfma_f32_32x32x16_bf16 v[96:111], v[16:19], v[32:35], 0
    s_waitcnt lgkmcnt(6)
    v_mfma_f32_32x32x16_bf16 v[96:111], v[16:19], v[36:39], v[96:111]
    s_waitcnt lgkmcnt(5)
    v_mfma_f32_32x32x16_bf16 v[96:111], v[16:19], v[40:43], v[96:111]
    s_waitcnt lgkmcnt(4)
    v_mfma_f32_32x32x16_bf16 v[96:111], v[16:19], v[44:47], v[96:111]
    s_waitcnt lgkmcnt(3)
    v_mfma_f32_32x32x16_bf16 v[112:127], v[16:19], v[48:51], 0
    s_waitcnt lgkmcnt(2)
    v_mfma_f32_32x32x16_bf16 v[112:127], v[16:19], v[52:55], v[112:127]
    s_waitcnt lgkmcnt(1)
    v_mfma_f32_32x32x16_bf16 v[112:127], v[16:19], v[56:59], v[112:127]
    s_waitcnt lgkmcnt(0)
    v_mfma_f32_32x32x16_bf16 v[112:127], v[16:19], v[60:63], v[112:127]
    v_mov_b32 v64, 0x24c1c
    v_mov_b32 v65, 1
    s_mov_b64 exec, 1
    ds_add_u32 v64, v65
    s_mov_b64 exec, -1
    s_mov_b32 s60, 0x10001
    s_mov_b32 s61, 0x10001
    v_lshlrev_b32 v72, 2, v0
    s_nop 3
    v_permlane16_swap_b32 v96, v112
    buffer_atomic_add_f32 v96, v4, s[16:19], 0 offen offset:0
    v_permlane16_swap_b32 v97, v113
    buffer_atomic_add_f32 v97, v4, s[16:19], 0 offen offset:256
    s_lshl_b64 s[60:61], s[60:61], 1
    v_cndmask_b32 v112, v112, v113, s[60:61]
    v_permlane16_swap_b32 v98, v114
    buffer_atomic_add_f32 v98, v4, s[16:19], 0 offen offset:512
    s_lshl_b64 s[60:61], s[60:61], 1
    v_cndmask_b32 v112, v112, v114, s[60:61]
    v_permlane16_swap_b32 v99, v115
    buffer_atomic_add_f32 v99, v4, s[16:19], 0 offen offset:768
    s_lshl_b64 s[60:61], s[60:61], 1
    v_cndmask_b32 v112, v112, v115, s[60:61]
    v_permlane16_swap_b32 v100, v116
    buffer_atomic_add_f32 v100, v4, s[16:19], 0 offen offset:1024
    s_lshl_b64 s[60:61], s[60:61], 1
    v_cndmask_b32 v112, v112, v116, s[60:61]
    v_permlane16_swap_b32 v101, v117
    buffer_atomic_add_f32 v101, v4, s[16:19], 0 offen offset:1280
    s_lshl_b64 s[60:61], s[60:61], 1
    v_cndmask_b32 v112, v112, v117, s[60:61]
    v_permlane16_swap_b32 v102, v118
    buffer_atomic_add_f32 v102, v4, s[16:19], 0 offen offset:1536
    s_lshl_b64 s[60:61], s[60:61], 1
    v_cndmask_b32 v112, v112, v118, s[60:61]
    v_permlane16_swap_b32 v103, v119
    buffer_atomic_add_f32 v103, v4, s[16:19], 0 offen offset:1792
    s_lshl_b64 s[60:61], s[60:61], 1
    v_cndmask_b32 v112, v112, v119, s[60:61]
    buffer_atomic_add_f32 v112, v72, s[16:19], s92 offen
    s_setprio 0
    ds_read_b64_tr_b16 v[80:81], v9 offset:0
    ds_read_b64_tr_b16 v[82:83], v9 offset:512
    ds_read_b64_tr_b16 v[84:85], v9 offset:2048
    ds_read_b64_tr_b16 v[86:87], v9 offset:2560
    ds_read_b64_tr_b16 v[88:89], v9 offset:4096
    ds_read_b64_tr_b16 v[90:91], v9 offset:4608
    ds_read_b64_tr_b16 v[92:93], v9 offset:6144
    ds_read_b64_tr_b16 v[94:95], v9 offset:6656
    s_waitcnt lgkmcnt(6)
    v_mfma_f32_32x32x16_bf16 v[96:111], v[80:83], v[128:131], 0
    ds_read_b64_tr_b16 v[80:81], v9 offset:8192
    ds_read_b64_tr_b16 v[82:83], v9 offset:8704
    s_waitcnt lgkmcnt(6)
    v_mfma_f32_32x32x16_bf16 v[96:111], v[84:87], v[132:135], v[96:111]
    ds_read_b64_tr_b16 v[84:85], v9 offset:10240
    ds_read_b64_tr_b16 v[86:87], v9 offset:10752
    s_waitcnt lgkmcnt(6)
    v_mfma_f32_32x32x16_bf16 v[96:111], v[88:91], v[136:139], v[96:111]
    ds_read_b64_tr_b16 v[88:89], v9 offset:12288
    ds_read_b64_tr_b16 v[90:91], v9 offset:12800
    s_waitcnt lgkmcnt(6)
    v_mfma_f32_32x32x16_bf16 v[96:111], v[92:95], v[140:143], v[96:111]
    ds_read_b64_tr_b16 v[92:93], v9 offset:14336
    ds_read_b64_tr_b16 v[94:95], v9 offset:14848
    s_waitcnt lgkmcnt(6)
    v_mfma_f32_32x32x16_bf16 v[96:111], v[80:83], v[144:147], v[96:111]
    ds_read_b64_tr_b16 v[80:81], v9 offset:16384
    ds_read_b64_tr_b16 v[82:83], v9 offset:16896
    s_waitcnt lgkmcnt(6)
    v_mfma_f32_32x32x16_bf16 v[96:111], v[84:87], v[148:151], v[96:111]
    ds_read_b64_tr_b16 v[84:85], v9 offset:18432
    ds_read_b64_tr_b16 v[86:87], v9 offset:18944
    s_waitcnt lgkmcnt(6)
    v_mfma_f32_32x32x16_bf16 v[96:111], v[88:91], v[152:155], v[96:111]
    ds_read_b64_tr_b16 v[88:89], v9 offset:20480
    ds_read_b64_tr_b16 v[90:91], v9 offset:20992
    s_waitcnt lgkmcnt(6)
    v_mfma_f32_32x32x16_bf16 v[96:111], v[92:95], v[156:159], v[96:111]
    ds_read_b64_tr_b16 v[92:93], v9 offset:22528
    ds_read_b64_tr_b16 v[94:95], v9 offset:23040
    s_waitcnt lgkmcnt(6)
    v_mfma_f32_32x32x16_bf16 v[96:111], v[80:83], v[160:163], v[96:111]
    ds_read_b64_tr_b16 v[80:81], v9 offset:24576
    ds_read_b64_tr_b16 v[82:83], v9 offset:25088
    s_waitcnt lgkmcnt(6)
    v_mfma_f32_32x32x16_bf16 v[96:111], v[84:87], v[164:167], v[96:111]
    ds_read_b64_tr_b16 v[84:85], v9 offset:26624
    ds_read_b64_tr_b16 v[86:87], v9 offset:27136
    s_waitcnt lgkmcnt(6)
    v_mfma_f32_32x32x16_bf16 v[96:111], v[88:91], v[168:171], v[96:111]
    ds_read_b64_tr_b16 v[88:89], v9 offset:28672
    ds_read_b64_tr_b16 v[90:91], v9 offset:29184
    s_waitcnt lgkmcnt(6)
    v_mfma_f32_32x32x16_bf16 v[96:111], v[92:95], v[172:175], v[96:111]
    ds_read_b64_tr_b16 v[92:93], v9 offset:30720
    ds_read_b64_tr_b16 v[94:95], v9 offset:31232
    s_waitcnt lgkmcnt(6)
    v_mfma_f32_32x32x16_bf16 v[96:111], v[80:83], v[176:179], v[96:111]
    ds_read_b64_tr_b16 v[80:81], v9 offset:32768
    ds_read_b64_tr_b16 v[82:83], v9 offset:33280
    s_waitcnt lgkmcnt(6)
    v_mfma_f32_32x32x16_bf16 v[96:111], v[84:87], v[180:183], v[96:111]
    ds_read_b64_tr_b16 v[84:85], v9 offset:34816
    ds_read_b64_tr_b16 v[86:87], v9 offset:35328
    s_waitcnt lgkmcnt(6)
    v_mfma_f32_32x32x16_bf16 v[96:111], v[88:91], v[184:187], v[96:111]
    ds_read_b64_tr_b16 v[88:89], v9 offset:36864
    ds_read_b64_tr_b16 v[90:91], v9 offset:37376
    s_waitcnt lgkmcnt(6)
    v_mfma_f32_32x32x16_bf16 v[96:111], v[92:95], v[188:191], v[96:111]
    ds_read_b64_tr_b16 v[92:93], v9 offset:38912
    ds_read_b64_tr_b16 v[94:95], v9 offset:39424
    s_waitcnt lgkmcnt(6)
    v_mfma_f32_32x32x16_bf16 v[96:111], v[80:83], v[192:195], v[96:111]
    ds_read_b64_tr_b16 v[80:81], v9 offset:40960
    ds_read_b64_tr_b16 v[82:83], v9 offset:41472
    s_waitcnt lgkmcnt(6)
    v_mfma_f32_32x32x16_bf16 v[96:111], v[84:87], v[196:199], v[96:111]
    ds_read_b64_tr_b16 v[84:85], v9 offset:43008
    ds_read_b64_tr_b16 v[86:87], v9 offset:43520
    s_waitcnt lgkmcnt(6)
    v_mfma_f32_32x32x16_bf16 v[96:111], v[88:91], v[200:203], v[96:111]
    ds_read_b64_tr_b16 v[88:89], v9 offset:45056
    ds_read_b64_tr_b16 v[90:91], v9 offset:45568
    s_waitcnt lgkmcnt(6)
    v_mfma_f32_32x32x16_bf16 v[96:111], v[92:95], v[204:207], v[96:111]
    ds_read_b64_tr_b16 v[92:93], v9 offset:47104
    ds_read_b64_tr_b16 v[94:95], v9 offset:47616
    s_waitcnt lgkmcnt(6)
    v_mfma_f32_32x32x16_bf16 v[96:111], v[80:83], v[208:211], v[96:111]
    ds_read_b64_tr_b16 v[80:81], v9 offset:49152
    ds_read_b64_tr_b16 v[82:83], v9 offset:49664
    s_waitcnt lgkmcnt(6)
    v_mfma_f32_32x32x16_bf16 v[96:111], v[84:87], v[212:215], v[96:111]
    s_waitcnt vmcnt(0)
    v_mov_b32 v76, 0x24c10
    v_mov_b32 v77, 1
    s_mov_b64 exec, 1
    ds_add_rtn_u32 v77, v76, v77
    s_mov_b64 exec, -1
    s_waitcnt lgkmcnt(0)
    v_readfirstlane_b32 s83, v77
    s_cmp_lg_u32 s83, 3
    s_cbranch_scc1 L_kpub_skip
    s_mul_i32 s85, s6, 9344
    s_add_u32 s85, s85, 0x22400
    s_mov_b32 s99, 1
    s_atomic_add s99, s[58:59], s85
L_kpub_skip:
    s_lshr_b32 s83, s2, 3
    s_lshl2_add_u32 s83, s83, s81
    s_mul_i32 s84, s83, 0x7000
    v_lshlrev_b32 v75, 10, v0
    s_mov_b64 exec, 0xfffffff
    buffer_load_dword v79, v75, s[24:27], s84 offen offset:384
    s_lshl_b32 s83, s83, 13
    s_add_u32 s83, s83, 0x1c0000
    s_mov_b64 exec, 0xff
    buffer_load_dword v79, v75, s[28:31], s83 offen offset:384
    s_mov_b64 exec, -1
    ds_read_b64_tr_b16 v[84:85], v9 offset:51200
    ds_read_b64_tr_b16 v[86:87], v9 offset:51712
    v_mfma_f32_32x32x16_bf16 v[96:111], v[88:91], v[216:219], v[96:111]
    ds_read_b64_tr_b16 v[88:89], v9 offset:53248
    ds_read_b64_tr_b16 v[90:91], v9 offset:53760
    v_mfma_f32_32x32x16_bf16 v[96:111], v[92:95], v[220:223], v[96:111]
    ds_read_b64_tr_b16 v[92:93], v9 offset:55296
    ds_read_b64_tr_b16 v[94:95], v9 offset:55808
    v_mfma_f32_32x32x16_bf16 v[96:111], v[80:83], v[224:227], v[96:111]
    ds_read_b64_tr_b16 v[80:81], v9 offset:57344
    ds_read_b64_tr_b16 v[82:83], v9 offset:57856
    s_waitcnt lgkmcnt(6)
    v_mfma_f32_32x32x16_bf16 v[96:111], v[84:87], v[228:231], v[96:111]
    ds_read_b64_tr_b16 v[84:85], v9 offset:59392
    ds_read_b64_tr_b16 v[86:87], v9 offset:59904
    s_waitcnt lgkmcnt(6)
    v_mfma_f32_32x32x16_bf16 v[96:111], v[88:91], v[232:235], v[96:111]
    ds_read_b64_tr_b16 v[88:89], v9 offset:61440
    ds_read_b64_tr_b16 v[90:91], v9 offset:61952
    s_waitcnt lgkmcnt(6)
    v_mfma_f32_32x32x16_bf16 v[96:111], v[92:95], v[236:239], v[96:111]
    ds_read_b64_tr_b16 v[92:93], v9 offset:63488
    ds_read_b64_tr_b16 v[94:95], v9 offset:64000
    s_waitcnt lgkmcnt(6)
    v_mfma_f32_32x32x16_bf16 v[96:111], v[80:83], v[240:243], v[96:111]
    s_waitcnt lgkmcnt(4)
    v_mfma_f32_32x32x16_bf16 v[96:111], v[84:87], v[244:247], v[96:111]
    s_waitcnt lgkmcnt(2)
    v_mfma_f32_32x32x16_bf16 v[96:111], v[88:91], v[248:251], v[96:111]
    s_waitcnt lgkmcnt(0)
    v_mfma_f32_32x32x16_bf16 v[96:111], v[92:95], v[252:255], v[96:111]
    v_mov_b32 v76, 0x24c0c
    v_mov_b32 v77, 1
    s_mov_b64 exec, 1
    ds_add_u32 v76, v77
    s_mov_b64 exec, -1
    s_nop 6
    v_cvt_pk_bf16_f32 v64, v96, v97
    v_cvt_pk_bf16_f32 v65, v98, v99
    v_cvt_pk_bf16_f32 v66, v100, v101
    v_cvt_pk_bf16_f32 v67, v102, v103
    v_cvt_pk_bf16_f32 v68, v104, v105
    v_cvt_pk_bf16_f32 v69, v106, v107
    v_cvt_pk_bf16_f32 v70, v108, v109
    v_cvt_pk_bf16_f32 v71, v110, v111
    s_setprio 2
    v_mfma_f32_32x32x16_bf16 v[32:47], v[24:27], v[64:67], 0
    v_mfma_f32_32x32x16_bf16 v[48:63], v[28:31], v[68:71], 0
    s_setprio 0
    v_lshrrev_b32 v72, 5, v0
    v_bfe_u32 v73, v0, 2, 2
    v_lshl_add_u32 v73, v72, 2, v73
    v_lshlrev_b32 v73, 5, v73
    v_bfe_u32 v74, v0, 4, 1
    v_lshl_add_u32 v73, v74, 4, v73
    v_bfe_u32 v74, v0, 1, 1
    v_lshl_add_u32 v73, v74, 3, v73
    s_lshl_b32 s83, s80, 10
    s_add_u32 s83, s83, 0x24800
    v_add_u32 v77, s83, v73
    ds_read_b64_tr_b16 v[240:241], v77 offset:0
    ds_read_b64_tr_b16 v[242:243], v77 offset:256
    ds_read_b64_tr_b16 v[244:245], v77 offset:512
    ds_read_b64_tr_b16 v[246:247], v77 offset:768
    v_bfe_i32 v78, v0, 2, 1
    v_and_b32 v78, 0x80008000, v78
    v_max3_f32 v76, v32, v33, v34
    v_max3_f32 v76, v76, v35, v36
    v_max3_f32 v76, v76, v37, v38
    v_max3_f32 v76, v76, v39, v40
    v_max3_f32 v76, v76, v41, v42
    v_max3_f32 v76, v76, v43, v44
    v_max3_f32 v76, v76, v45, v46
    v_max_f32 v76, v76, v47
    v_mul_f32 v76, s87, v76
    v_fma_f32 v32, v32, s87, -v76
    v_fma_f32 v33, v33, s87, -v76
    v_fma_f32 v34, v34, s87, -v76
    v_fma_f32 v35, v35, s87, -v76
    v_fma_f32 v36, v36, s87, -v76
    v_fma_f32 v37, v37, s87, -v76
    v_fma_f32 v38, v38, s87, -v76
    v_fma_f32 v39, v39, s87, -v76
    v_fma_f32 v40, v40, s87, -v76
    v_fma_f32 v41, v41, s87, -v76
    v_fma_f32 v42, v42, s87, -v76
    v_fma_f32 v43, v43, s87, -v76
    v_fma_f32 v44, v44, s87, -v76
    v_fma_f32 v45, v45, s87, -v76
    v_fma_f32 v46, v46, s87, -v76
    v_fma_f32 v47, v47, s87, -v76
    v_exp_f32 v32, v32
    v_exp_f32 v33, v33
    v_exp_f32 v34, v34
    v_exp_f32 v35, v35
    v_exp_f32 v36, v36
    v_exp_f32 v37, v37
    s_mul_i32 s85, s6, 9344
    s_add_u32 s85, s85, 0x22400
    s_cmp_lg_u32 s3, 0
    s_cbranch_scc1 L_kv_nos
    s_load_dword s68, s[58:59], s85 glc
L_kv_nos:
    v_exp_f32 v38, v38
    v_exp_f32 v39, v39
    v_exp_f32 v40, v40
    v_exp_f32 v41, v41
    v_exp_f32 v42, v42
    v_exp_f32 v43, v43
    v_exp_f32 v44, v44
    v_exp_f32 v45, v45
    v_exp_f32 v46, v46
    v_exp_f32 v47, v47
    v_add_f32 v77, v32, v33
    v_add_f32 v76, v34, v35
    v_add_f32 v77, v77, v36
    v_add_f32 v76, v76, v37
    v_add_f32 v77, v77, v38
    v_add_f32 v76, v76, v39
    v_add_f32 v77, v77, v40
    v_add_f32 v76, v76, v41
    v_add_f32 v77, v77, v42
    v_add_f32 v76, v76, v43
    v_add_f32 v77, v77, v44
    v_add_f32 v76, v76, v45
    v_add_f32 v77, v77, v46
    v_add_f32 v76, v76, v47
    v_add_f32 v77, v77, v76
    v_rcp_f32 v77, v77
    s_nop 0
    v_mul_f32 v32, v77, v32
    v_mul_f32 v33, v77, v33
    v_mul_f32 v34, v77, v34
    v_mul_f32 v35, v77, v35
    v_mul_f32 v36, v77, v36
    v_mul_f32 v37, v77, v37
    v_mul_f32 v38, v77, v38
    v_mul_f32 v39, v77, v39
    v_mul_f32 v40, v77, v40
    v_mul_f32 v41, v77, v41
    v_mul_f32 v42, v77, v42
    v_mul_f32 v43, v77, v43
    v_mul_f32 v44, v77, v44
    v_mul_f32 v45, v77, v45
    v_mul_f32 v46, v77, v46
    v_mul_f32 v47, v77, v47
    v_cvt_pk_bf16_f32 v80, v32, v33
    v_cvt_pk_bf16_f32 v81, v34, v35
    v_cvt_pk_bf16_f32 v82, v36, v37
    v_cvt_pk_bf16_f32 v83, v38, v39
    v_cvt_pk_bf16_f32 v84, v40, v41
    v_cvt_pk_bf16_f32 v85, v42, v43
    v_cvt_pk_bf16_f32 v86, v44, v45
    v_cvt_pk_bf16_f32 v87, v46, v47
    v_max3_f32 v76, v48, v49, v50
    v_max3_f32 v76, v76, v51, v52
    v_max3_f32 v76, v76, v53, v54
    v_max3_f32 v76, v76, v55, v56
    v_max3_f32 v76, v76, v57, v58
    v_max3_f32 v76, v76, v59, v60
    v_max3_f32 v76, v76, v61, v62
    v_max_f32 v76, v76, v63
    v_mul_f32 v76, s87, v76
    v_fma_f32 v48, v48, s87, -v76
    v_fma_f32 v49, v49, s87, -v76
    v_fma_f32 v50, v50, s87, -v76
    v_fma_f32 v51, v51, s87, -v76
    v_fma_f32 v52, v52, s87, -v76
    v_fma_f32 v53, v53, s87, -v76
    v_fma_f32 v54, v54, s87, -v76
    v_fma_f32 v55, v55, s87, -v76
    v_fma_f32 v56, v56, s87, -v76
    v_fma_f32 v57, v57, s87, -v76
    v_fma_f32 v58, v58, s87, -v76
    v_fma_f32 v59, v59, s87, -v76
    v_fma_f32 v60, v60, s87, -v76
    v_fma_f32 v61, v61, s87, -v76
    v_fma_f32 v62, v62, s87, -v76
    v_fma_f32 v63, v63, s87, -v76
    v_exp_f32 v48, v48
    v_exp_f32 v49, v49
    v_exp_f32 v50, v50
    v_exp_f32 v51, v51
    v_exp_f32 v52, v52
    v_exp_f32 v53, v53
    v_exp_f32 v54, v54
    v_exp_f32 v55, v55
    v_exp_f32 v56, v56
    v_exp_f32 v57, v57
    v_exp_f32 v58, v58
    v_exp_f32 v59, v59
    v_exp_f32 v60, v60
    v_exp_f32 v61, v61
    v_exp_f32 v62, v62
    v_exp_f32 v63, v63
    v_add_f32 v77, v48, v49
    v_add_f32 v76, v50, v51
    v_add_f32 v77, v77, v52
    v_add_f32 v76, v76, v53
    v_add_f32 v77, v77, v54
    v_add_f32 v76, v76, v55
    v_add_f32 v77, v77, v56
    v_add_f32 v76, v76, v57
    v_add_f32 v77, v77, v58
    v_add_f32 v76, v76, v59
    v_add_f32 v77, v77, v60
    v_add_f32 v76, v76, v61
    v_add_f32 v77, v77, v62
    v_add_f32 v76, v76, v63
    v_add_f32 v77, v77, v76
    v_rcp_f32 v77, v77
    s_nop 0
    v_mul_f32 v48, v77, v48
    v_mul_f32 v49, v77, v49
    v_mul_f32 v50, v77, v50
    v_mul_f32 v51, v77, v51
    v_mul_f32 v52, v77, v52
    v_mul_f32 v53, v77, v53
    v_mul_f32 v54, v77, v54
    v_mul_f32 v55, v77, v55
    v_mul_f32 v56, v77, v56
    v_mul_f32 v57, v77, v57
    v_mul_f32 v58, v77, v58
    v_mul_f32 v59, v77, v59
    v_mul_f32 v60, v77, v60
    v_mul_f32 v61, v77, v61
    v_mul_f32 v62, v77, v62
    v_mul_f32 v63, v77, v63
    v_cvt_pk_bf16_f32 v88, v48, v49
    v_cvt_pk_bf16_f32 v89, v50, v51
    v_cvt_pk_bf16_f32 v90, v52, v53
    v_cvt_pk_bf16_f32 v91, v54, v55
    v_cvt_pk_bf16_f32 v92, v56, v57
    v_cvt_pk_bf16_f32 v93, v58, v59
    v_cvt_pk_bf16_f32 v94, v60, v61
    v_cvt_pk_bf16_f32 v95, v62, v63
    v_mov_b32 v76, 0x24c14
    s_mov_b32 s84, 0x80000
L_pq_spin:
    ds_read_b32 v77, v76
    s_waitcnt lgkmcnt(0)
    v_readfirstlane_b32 s83, v77
    s_cmp_ge_u32 s83, 4
    s_cbranch_scc1 L_pq_done
    s_sub_u32 s84, s84, 1
    s_cbranch_scc0 L_pq_spin
L_pq_done:
    s_waitcnt lgkmcnt(0)
    s_lshl_b32 s84, s81, 11
    s_add_u32 s84, s84, 0x10000
    v_add_u32 v73, s84, v11
    ds_read_b128 v[64:67], v73 offset:0
    ds_read_b128 v[68:71], v73 offset:1024
    v_xor_b32 v240, v78, v240
    v_xor_b32 v241, v78, v241
    v_xor_b32 v242, v78, v242
    v_xor_b32 v243, v78, v243
    v_xor_b32 v244, v78, v244
    v_xor_b32 v245, v78, v245
    v_xor_b32 v246, v78, v246
    v_xor_b32 v247, v78, v247
    s_waitcnt lgkmcnt(0)
    s_setprio 2
    v_mfma_f32_32x32x16_bf16 v[32:47], v[240:243], v[64:67], 0
    v_mfma_f32_32x32x16_bf16 v[48:63], v[244:247], v[68:71], 0
    s_setprio 0
    s_cmp_lg_u32 s3, 0
    s_cbranch_scc1 L_kv_others
    s_waitcnt lgkmcnt(0)
    s_cmp_ge_u32 s68, 16
    s_cbranch_scc1 L_kv_done
    s_mov_b32 s84, 0x8000
L_kv_spin:
    s_load_dword s68, s[58:59], s85 glc
    s_waitcnt lgkmcnt(0)
    s_cmp_ge_u32 s68, 16
    s_cbranch_scc1 L_kv_done
    s_sleep 2
    s_sub_u32 s84, s84, 1
    s_cbranch_scc0 L_kv_spin
L_kv_done:
    v_mov_b32 v76, 0x24c18
    v_mov_b32 v77, 1
    s_mov_b64 exec, 1
    ds_add_u32 v76, v77
    s_mov_b64 exec, -1
L_kv_others:
    v_mov_b32 v76, 0x24c18
    s_mov_b32 s84, 0x80000
L_kvo_spin:
    ds_read_b32 v77, v76
    s_waitcnt lgkmcnt(0)
    v_readfirstlane_b32 s83, v77
    s_cmp_ge_u32 s83, 1
    s_cbranch_scc1 L_kvo_done
    s_sleep 1
    s_sub_u32 s84, s84, 1
    s_cbranch_scc0 L_kvo_spin
L_kvo_done:
    s_waitcnt lgkmcnt(0)
    buffer_load_dword v96, v4, s[16:19], 0 offen offset:0 sc1
    buffer_load_dword v97, v4, s[16:19], 0 offen offset:256 sc1
    buffer_load_dword v98, v4, s[16:19], 0 offen offset:512 sc1
    buffer_load_dword v99, v4, s[16:19], 0 offen offset:768 sc1
    buffer_load_dword v100, v4, s[16:19], 0 offen offset:1024 sc1
    buffer_load_dword v101, v4, s[16:19], 0 offen offset:1280 sc1
    buffer_load_dword v102, v4, s[16:19], 0 offen offset:1536 sc1
    buffer_load_dword v103, v4, s[16:19], 0 offen offset:1792 sc1
    buffer_load_dwordx4 v[112:115], v5, s[16:19], s92 offen offset:0 sc1
    buffer_load_dwordx4 v[116:119], v5, s[16:19], s92 offen offset:16 sc1
    v_max3_f32 v76, v32, v33, v34
    v_max3_f32 v76, v76, v35, v36
    v_max3_f32 v76, v76, v37, v38
    v_max3_f32 v76, v76, v39, v40
    v_max3_f32 v76, v76, v41, v42
    v_max3_f32 v76, v76, v43, v44
    v_max3_f32 v76, v76, v45, v46
    v_max_f32 v76, v76, v47
    v_mul_f32 v76, s87, v76
    v_fma_f32 v32, v32, s87, -v76
    v_fma_f32 v33, v33, s87, -v76
    v_fma_f32 v34, v34, s87, -v76
    v_fma_f32 v35, v35, s87, -v76
    v_fma_f32 v36, v36, s87, -v76
    v_fma_f32 v37, v37, s87, -v76
    v_fma_f32 v38, v38, s87, -v76
    v_fma_f32 v39, v39, s87, -v76
    v_fma_f32 v40, v40, s87, -v76
    v_fma_f32 v41, v41, s87, -v76
    v_fma_f32 v42, v42, s87, -v76
    v_fma_f32 v43, v43, s87, -v76
    v_fma_f32 v44, v44, s87, -v76
    v_fma_f32 v45, v45, s87, -v76
    v_fma_f32 v46, v46, s87, -v76
    v_fma_f32 v47, v47, s87, -v76
    v_exp_f32 v32, v32
    v_exp_f32 v33, v33
    v_exp_f32 v34, v34
    v_exp_f32 v35, v35
    v_exp_f32 v36, v36
    v_exp_f32 v37, v37
    v_exp_f32 v38, v38
    v_exp_f32 v39, v39
    v_exp_f32 v40, v40
    v_exp_f32 v41, v41
    v_exp_f32 v42, v42
    v_exp_f32 v43, v43
    v_exp_f32 v44, v44
    v_exp_f32 v45, v45
    v_exp_f32 v46, v46
    v_exp_f32 v47, v47
    v_add_f32 v77, v32, v33
    v_add_f32 v76, v34, v35
    v_add_f32 v77, v77, v36
    v_add_f32 v76, v76, v37
    v_add_f32 v77, v77, v38
    v_add_f32 v76, v76, v39
    v_add_f32 v77, v77, v40
    v_add_f32 v76, v76, v41
    v_add_f32 v77, v77, v42
    v_add_f32 v76, v76, v43
    v_add_f32 v77, v77, v44
    v_add_f32 v76, v76, v45
    v_add_f32 v77, v77, v46
    v_add_f32 v76, v76, v47
    v_add_f32 v77, v77, v76
    v_rcp_f32 v77, v77
    s_nop 0
    v_mul_f32 v32, v77, v32
    v_mul_f32 v33, v77, v33
    v_mul_f32 v34, v77, v34
    v_mul_f32 v35, v77, v35
    v_mul_f32 v36, v77, v36
    v_mul_f32 v37, v77, v37
    v_mul_f32 v38, v77, v38
    v_mul_f32 v39, v77, v39
    v_mul_f32 v40, v77, v40
    v_mul_f32 v41, v77, v41
    v_mul_f32 v42, v77, v42
    v_mul_f32 v43, v77, v43
    v_mul_f32 v44, v77, v44
    v_mul_f32 v45, v77, v45
    v_mul_f32 v46, v77, v46
    v_mul_f32 v47, v77, v47
    v_cvt_pk_bf16_f32 v224, v32, v33
    v_cvt_pk_bf16_f32 v225, v34, v35
    v_cvt_pk_bf16_f32 v226, v36, v37
    v_cvt_pk_bf16_f32 v227, v38, v39
    v_cvt_pk_bf16_f32 v228, v40, v41
    v_cvt_pk_bf16_f32 v229, v42, v43
    v_cvt_pk_bf16_f32 v230, v44, v45
    v_cvt_pk_bf16_f32 v231, v46, v47
    v_max3_f32 v76, v48, v49, v50
    v_max3_f32 v76, v76, v51, v52
    v_max3_f32 v76, v76, v53, v54
    v_max3_f32 v76, v76, v55, v56
    v_max3_f32 v76, v76, v57, v58
    v_max3_f32 v76, v76, v59, v60
    v_max3_f32 v76, v76, v61, v62
    v_max_f32 v76, v76, v63
    v_mul_f32 v76, s87, v76
    v_fma_f32 v48, v48, s87, -v76
    v_fma_f32 v49, v49, s87, -v76
    v_fma_f32 v50, v50, s87, -v76
    v_fma_f32 v51, v51, s87, -v76
    v_fma_f32 v52, v52, s87, -v76
    v_fma_f32 v53, v53, s87, -v76
    v_fma_f32 v54, v54, s87, -v76
    v_fma_f32 v55, v55, s87, -v76
    v_fma_f32 v56, v56, s87, -v76
    v_fma_f32 v57, v57, s87, -v76
    v_fma_f32 v58, v58, s87, -v76
    v_fma_f32 v59, v59, s87, -v76
    v_fma_f32 v60, v60, s87, -v76
    v_fma_f32 v61, v61, s87, -v76
    v_fma_f32 v62, v62, s87, -v76
    v_fma_f32 v63, v63, s87, -v76
    v_exp_f32 v48, v48
    v_exp_f32 v49, v49
    v_exp_f32 v50, v50
    v_exp_f32 v51, v51
    v_exp_f32 v52, v52
    v_exp_f32 v53, v53
    v_exp_f32 v54, v54
    v_exp_f32 v55, v55
    v_exp_f32 v56, v56
    v_exp_f32 v57, v57
    v_exp_f32 v58, v58
    v_exp_f32 v59, v59
    v_exp_f32 v60, v60
    v_exp_f32 v61, v61
    v_exp_f32 v62, v62
    v_exp_f32 v63, v63
    v_add_f32 v77, v48, v49
    v_add_f32 v76, v50, v51
    v_add_f32 v77, v77, v52
    v_add_f32 v76, v76, v53
    v_add_f32 v77, v77, v54
    v_add_f32 v76, v76, v55
    v_add_f32 v77, v77, v56
    v_add_f32 v76, v76, v57
    v_add_f32 v77, v77, v58
    v_add_f32 v76, v76, v59
    v_add_f32 v77, v77, v60
    v_add_f32 v76, v76, v61
    v_add_f32 v77, v77, v62
    v_add_f32 v76, v76, v63
    v_add_f32 v77, v77, v76
    v_rcp_f32 v77, v77
    s_nop 0
    v_mul_f32 v48, v77, v48
    v_mul_f32 v49, v77, v49
    v_mul_f32 v50, v77, v50
    v_mul_f32 v51, v77, v51
    v_mul_f32 v52, v77, v52
    v_mul_f32 v53, v77, v53
    v_mul_f32 v54, v77, v54
    v_mul_f32 v55, v77, v55
    v_mul_f32 v56, v77, v56
    v_mul_f32 v57, v77, v57
    v_mul_f32 v58, v77, v58
    v_mul_f32 v59, v77, v59
    v_mul_f32 v60, v77, v60
    v_mul_f32 v61, v77, v61
    v_mul_f32 v62, v77, v62
    v_mul_f32 v63, v77, v63
    v_cvt_pk_bf16_f32 v232, v48, v49
    v_cvt_pk_bf16_f32 v233, v50, v51
    v_cvt_pk_bf16_f32 v234, v52, v53
    v_cvt_pk_bf16_f32 v235, v54, v55
    v_cvt_pk_bf16_f32 v236, v56, v57
    v_cvt_pk_bf16_f32 v237, v58, v59
    v_cvt_pk_bf16_f32 v238, v60, v61
    v_cvt_pk_bf16_f32 v239, v62, v63
    s_lshl_b32 s84, s81, 10
    s_add_u32 s84, s84, 0x26000
    v_add_u32 v72, s84, v11
    v_add_u32 v73, 0x26000, v11
    v_mov_b32 v74, 0x24c04
    v_mov_b32 v75, 1
    s_setprio 3
    s_waitcnt vmcnt(0)
    v_permlane16_swap_b32 v96, v112
    v_permlane16_swap_b32 v97, v113
    v_permlane16_swap_b32 v98, v114
    v_permlane16_swap_b32 v99, v115
    v_permlane16_swap_b32 v100, v116
    v_permlane16_swap_b32 v101, v117
    v_permlane16_swap_b32 v102, v118
    v_permlane16_swap_b32 v103, v119
    v_cvt_pk_bf16_f32 v64, v96, v97
    v_cvt_pk_bf16_f32 v65, v98, v99
    v_cvt_pk_bf16_f32 v66, v100, v101
    v_cvt_pk_bf16_f32 v67, v102, v103
    ds_write_b128 v72, v[64:67] offset:0
    v_cvt_pk_bf16_f32 v68, v112, v113
    v_cvt_pk_bf16_f32 v69, v114, v115
    v_cvt_pk_bf16_f32 v70, v116, v117
    v_cvt_pk_bf16_f32 v71, v118, v119
    ds_write_b128 v72, v[68:71] offset:4096
    s_waitcnt lgkmcnt(0)
    s_mov_b64 exec, 1
    ds_add_u32 v74, v75
    s_mov_b64 exec, -1
    s_mov_b32 s84, 0x80000
L_qb_spin:
    ds_read_b32 v76, v74
    s_waitcnt lgkmcnt(0)
    v_readfirstlane_b32 s83, v76
    s_cmp_ge_u32 s83, 4
    s_cbranch_scc1 L_qb_done
    s_sub_u32 s84, s84, 1
    s_cbranch_scc0 L_qb_spin
L_qb_done:
    ds_read_b128 v[192:195], v73 offset:0
    ds_read_b128 v[196:199], v73 offset:1024
    ds_read_b128 v[200:203], v73 offset:2048
    ds_read_b128 v[204:207], v73 offset:3072
    ds_read_b128 v[208:211], v73 offset:4096
    ds_read_b128 v[212:215], v73 offset:5120
    ds_read_b128 v[216:219], v73 offset:6144
    ds_read_b128 v[220:223], v73 offset:7168
    s_lshl_b32 s84, s6, 12
    s_add_u32 s84, s84, 0x11c000
    s_waitcnt lgkmcnt(6)
    v_mfma_f32_32x32x16_bf16 v[128:143], v[192:195], v[80:83], 0
    v_mfma_f32_32x32x16_bf16 v[128:143], v[196:199], v[84:87], v[128:143]
    s_waitcnt lgkmcnt(4)
    v_mfma_f32_32x32x16_bf16 v[144:159], v[200:203], v[88:91], 0
    v_mfma_f32_32x32x16_bf16 v[144:159], v[204:207], v[92:95], v[144:159]
    s_waitcnt lgkmcnt(2)
    v_mfma_f32_32x32x16_bf16 v[160:175], v[208:211], v[224:227], 0
    v_mfma_f32_32x32x16_bf16 v[160:175], v[212:215], v[228:231], v[160:175]
    s_waitcnt lgkmcnt(0)
    v_mfma_f32_32x32x16_bf16 v[176:191], v[216:219], v[232:235], 0
    v_mfma_f32_32x32x16_bf16 v[176:191], v[220:223], v[236:239], v[176:191]
    s_nop 2
    v_add_f32 v72, 0x358637bd, v136
    v_rcp_f32 v72, v72
    s_nop 0
    v_mul_f32 v128, v72, v128
    v_mul_f32 v129, v72, v129
    v_mul_f32 v130, v72, v130
    v_mul_f32 v131, v72, v131
    v_mul_f32 v132, v72, v132
    v_mul_f32 v133, v72, v133
    v_mul_f32 v134, v72, v134
    v_mul_f32 v135, v72, v135
    v_cvt_pk_bf16_f32 v32, v128, v129
    v_cvt_pk_bf16_f32 v33, v130, v131
    v_cvt_pk_bf16_f32 v34, v132, v133
    v_cvt_pk_bf16_f32 v35, v134, v135
    buffer_store_dwordx4 v[32:35], v1, s[16:19], s84 offen offset:0 sc1
    v_add_f32 v73, 0x358637bd, v152
    v_rcp_f32 v73, v73
    s_nop 0
    v_mul_f32 v144, v73, v144
    v_mul_f32 v145, v73, v145
    v_mul_f32 v146, v73, v146
    v_mul_f32 v147, v73, v147
    v_mul_f32 v148, v73, v148
    v_mul_f32 v149, v73, v149
    v_mul_f32 v150, v73, v150
    v_mul_f32 v151, v73, v151
    v_cvt_pk_bf16_f32 v36, v144, v145
    v_cvt_pk_bf16_f32 v37, v146, v147
    v_cvt_pk_bf16_f32 v38, v148, v149
    v_cvt_pk_bf16_f32 v39, v150, v151
    buffer_store_dwordx4 v[36:39], v1, s[16:19], s84 offen offset:1024 sc1
    v_add_f32 v72, 0x358637bd, v168
    v_rcp_f32 v72, v72
    s_nop 0
    v_mul_f32 v160, v72, v160
    v_mul_f32 v161, v72, v161
    v_mul_f32 v162, v72, v162
    v_mul_f32 v163, v72, v163
    v_mul_f32 v164, v72, v164
    v_mul_f32 v165, v72, v165
    v_mul_f32 v166, v72, v166
    v_mul_f32 v167, v72, v167
    v_cvt_pk_bf16_f32 v40, v160, v161
    v_cvt_pk_bf16_f32 v41, v162, v163
    v_cvt_pk_bf16_f32 v42, v164, v165
    v_cvt_pk_bf16_f32 v43, v166, v167
    buffer_store_dwordx4 v[40:43], v1, s[16:19], s84 offen offset:2048 sc1
    v_add_f32 v73, 0x358637bd, v184
    v_rcp_f32 v73, v73
    s_nop 0
    v_mul_f32 v176, v73, v176
    v_mul_f32 v177, v73, v177
    v_mul_f32 v178, v73, v178
    v_mul_f32 v179, v73, v179
    v_mul_f32 v180, v73, v180
    v_mul_f32 v181, v73, v181
    v_mul_f32 v182, v73, v182
    v_mul_f32 v183, v73, v183
    v_cvt_pk_bf16_f32 v44, v176, v177
    v_cvt_pk_bf16_f32 v45, v178, v179
    v_cvt_pk_bf16_f32 v46, v180, v181
    v_cvt_pk_bf16_f32 v47, v182, v183
    buffer_store_dwordx4 v[44:47], v1, s[16:19], s84 offen offset:3072 sc1
    s_waitcnt vmcnt(0)
    v_mov_b32 v76, 0x24c08
    v_mov_b32 v77, 1
    s_mov_b64 exec, 1
    ds_add_rtn_u32 v77, v76, v77
    s_mov_b64 exec, -1
    s_waitcnt lgkmcnt(0)
    v_readfirstlane_b32 s83, v77
    s_cmp_lg_u32 s83, 3
    s_cbranch_scc1 L_opub_skip
    s_lshr_b32 s85, s6, 1
    s_lshl2_add_u32 s85, s5, s85
    s_lshl_b32 s85, s85, 5
    s_and_b32 s86, s6, 1
    s_add_u32 s85, s85, s86
    s_add_u32 s85, s85, 2
    s_lshl_b32 s85, s85, 2
    s_mov_b32 s99, 1
    s_atomic_add s99, s[58:59], s85
L_opub_skip:
    s_branch L_fin
L_attp:
    ds_read_b64_tr_b16 v[80:81], v12 offset:0
    ds_read_b64_tr_b16 v[82:83], v12 offset:512
    ds_read_b64_tr_b16 v[84:85], v12 offset:2048
    ds_read_b64_tr_b16 v[86:87], v12 offset:2560
    ds_read_b64_tr_b16 v[88:89], v12 offset:4096
    ds_read_b64_tr_b16 v[90:91], v12 offset:4608
    ds_read_b64_tr_b16 v[92:93], v12 offset:6144
    ds_read_b64_tr_b16 v[94:95], v12 offset:6656
    s_waitcnt lgkmcnt(6)
    v_mfma_f32_32x32x16_bf16 v[112:127], v[128:131], v[80:83], 0
    ds_read_b64_tr_b16 v[80:81], v12 offset:8192
    ds_read_b64_tr_b16 v[82:83], v12 offset:8704
    s_waitcnt lgkmcnt(6)
    v_mfma_f32_32x32x16_bf16 v[112:127], v[132:135], v[84:87], v[112:127]
    ds_read_b64_tr_b16 v[84:85], v12 offset:10240
    ds_read_b64_tr_b16 v[86:87], v12 offset:10752
    s_waitcnt lgkmcnt(6)
    v_mfma_f32_32x32x16_bf16 v[112:127], v[136:139], v[88:91], v[112:127]
    s_add_u32 m0, s88, 0x14000
    s_nop 0
    buffer_load_dwordx4 v6, s[12:15], s70 offen lds
    ds_read_b64_tr_b16 v[88:89], v12 offset:12288
    ds_read_b64_tr_b16 v[90:91], v12 offset:12800
    s_waitcnt lgkmcnt(6)
    v_mfma_f32_32x32x16_bf16 v[112:127], v[140:143], v[92:95], v[112:127]
    ds_read_b64_tr_b16 v[92:93], v12 offset:14336
    ds_read_b64_tr_b16 v[94:95], v12 offset:14848
    s_waitcnt lgkmcnt(6)
    v_mfma_f32_32x32x16_bf16 v[112:127], v[144:147], v[80:83], v[112:127]
    ds_read_b64_tr_b16 v[80:81], v8 offset:0
    ds_read_b64_tr_b16 v[82:83], v8 offset:512
    s_waitcnt lgkmcnt(6)
    v_mfma_f32_32x32x16_bf16 v[112:127], v[148:151], v[84:87], v[112:127]
    buffer_load_dwordx4 v7, s[12:15], s70 offen offset:1024 lds
    ds_read_b64_tr_b16 v[84:85], v8 offset:2048
    ds_read_b64_tr_b16 v[86:87], v8 offset:2560
    s_waitcnt lgkmcnt(6)
    v_mfma_f32_32x32x16_bf16 v[112:127], v[152:155], v[88:91], v[112:127]
    ds_read_b64_tr_b16 v[88:89], v8 offset:4096
    ds_read_b64_tr_b16 v[90:91], v8 offset:4608
    s_waitcnt lgkmcnt(6)
    v_mfma_f32_32x32x16_bf16 v[112:127], v[156:159], v[92:95], v[112:127]
    ds_read_b64_tr_b16 v[92:93], v8 offset:6144
    ds_read_b64_tr_b16 v[94:95], v8 offset:6656
    s_waitcnt lgkmcnt(6)
    v_mfma_f32_32x32x16_bf16 v[112:127], v[160:163], v[80:83], v[112:127]
    s_add_u32 m0, s88, 0x16000
    s_nop 0
    buffer_load_dwordx4 v6, s[12:15], s71 offen lds
    ds_read_b64_tr_b16 v[80:81], v8 offset:8192
    ds_read_b64_tr_b16 v[82:83], v8 offset:8704
    s_waitcnt lgkmcnt(6)
    v_mfma_f32_32x32x16_bf16 v[112:127], v[164:167], v[84:87], v[112:127]
    ds_read_b64_tr_b16 v[84:85], v8 offset:10240
    ds_read_b64_tr_b16 v[86:87], v8 offset:10752
    s_waitcnt lgkmcnt(6)
    v_mfma_f32_32x32x16_bf16 v[112:127], v[168:171], v[88:91], v[112:127]
    ds_read_b64_tr_b16 v[88:89], v8 offset:12288
    ds_read_b64_tr_b16 v[90:91], v8 offset:12800
    s_waitcnt lgkmcnt(6)
    v_mfma_f32_32x32x16_bf16 v[112:127], v[172:175], v[92:95], v[112:127]
    ds_read_b64_tr_b16 v[92:93], v8 offset:14336
    ds_read_b64_tr_b16 v[94:95], v8 offset:14848
    s_waitcnt lgkmcnt(6)
    v_mfma_f32_32x32x16_bf16 v[112:127], v[176:179], v[80:83], v[112:127]
    buffer_load_dwordx4 v7, s[12:15], s71 offen offset:1024 lds
    s_waitcnt vmcnt(5)
    s_barrier
    ds_read_b64_tr_b16 v[80:81], v8 offset:16384
    ds_read_b64_tr_b16 v[82:83], v8 offset:16896
    s_waitcnt lgkmcnt(6)
    v_mfma_f32_32x32x16_bf16 v[112:127], v[180:183], v[84:87], v[112:127]
    ds_read_b64_tr_b16 v[84:85], v8 offset:18432
    ds_read_b64_tr_b16 v[86:87], v8 offset:18944
    s_waitcnt lgkmcnt(6)
    v_mfma_f32_32x32x16_bf16 v[112:127], v[184:187], v[88:91], v[112:127]
    s_add_u32 m0, s88, 0x18000
    s_nop 0
    buffer_load_dwordx4 v6, s[12:15], s72 offen lds
    ds_read_b64_tr_b16 v[88:89], v8 offset:20480
    ds_read_b64_tr_b16 v[90:91], v8 offset:20992
    s_waitcnt lgkmcnt(6)
    v_mfma_f32_32x32x16_bf16 v[112:127], v[188:191], v[92:95], v[112:127]
    ds_read_b64_tr_b16 v[92:93], v8 offset:22528
    ds_read_b64_tr_b16 v[94:95], v8 offset:23040
    s_waitcnt lgkmcnt(6)
    v_mfma_f32_32x32x16_bf16 v[112:127], v[192:195], v[80:83], v[112:127]
    ds_read_b64_tr_b16 v[80:81], v8 offset:24576
    ds_read_b64_tr_b16 v[82:83], v8 offset:25088
    s_waitcnt lgkmcnt(6)
    v_mfma_f32_32x32x16_bf16 v[112:127], v[196:199], v[84:87], v[112:127]
    ds_read_b64_tr_b16 v[84:85], v8 offset:26624
    ds_read_b64_tr_b16 v[86:87], v8 offset:27136
    s_waitcnt lgkmcnt(6)
    v_mfma_f32_32x32x16_bf16 v[112:127], v[200:203], v[88:91], v[112:127]
    buffer_load_dwordx4 v7, s[12:15], s72 offen offset:1024 lds
    ds_read_b64_tr_b16 v[88:89], v8 offset:28672
    ds_read_b64_tr_b16 v[90:91], v8 offset:29184
    s_waitcnt lgkmcnt(6)
    v_mfma_f32_32x32x16_bf16 v[112:127], v[204:207], v[92:95], v[112:127]
    ds_read_b64_tr_b16 v[92:93], v8 offset:30720
    ds_read_b64_tr_b16 v[94:95], v8 offset:31232
    s_waitcnt lgkmcnt(6)
    v_mfma_f32_32x32x16_bf16 v[112:127], v[208:211], v[80:83], v[112:127]
    s_add_u32 m0, s88, 0x1a000
    s_nop 0
    buffer_load_dwordx4 v6, s[12:15], s73 offen lds
    ds_read_b64_tr_b16 v[80:81], v8 offset:32768
    ds_read_b64_tr_b16 v[82:83], v8 offset:33280
    s_waitcnt lgkmcnt(6)
    v_mfma_f32_32x32x16_bf16 v[112:127], v[212:215], v[84:87], v[112:127]
    ds_read_b64_tr_b16 v[84:85], v8 offset:34816
    ds_read_b64_tr_b16 v[86:87], v8 offset:35328
    s_waitcnt lgkmcnt(6)
    v_mfma_f32_32x32x16_bf16 v[112:127], v[216:219], v[88:91], v[112:127]
    ds_read_b64_tr_b16 v[88:89], v8 offset:36864
    ds_read_b64_tr_b16 v[90:91], v8 offset:37376
    s_waitcnt lgkmcnt(6)
    v_mfma_f32_32x32x16_bf16 v[112:127], v[220:223], v[92:95], v[112:127]
    ds_read_b64_tr_b16 v[92:93], v8 offset:38912
    ds_read_b64_tr_b16 v[94:95], v8 offset:39424
    s_waitcnt lgkmcnt(6)
    v_mfma_f32_32x32x16_bf16 v[112:127], v[224:227], v[80:83], v[112:127]
    buffer_load_dwordx4 v7, s[12:15], s73 offen offset:1024 lds
    ds_read_b64_tr_b16 v[80:81], v8 offset:40960
    ds_read_b64_tr_b16 v[82:83], v8 offset:41472
    s_waitcnt lgkmcnt(6)
    v_mfma_f32_32x32x16_bf16 v[112:127], v[228:231], v[84:87], v[112:127]
    ds_read_b64_tr_b16 v[84:85], v8 offset:43008
    ds_read_b64_tr_b16 v[86:87], v8 offset:43520
    s_waitcnt lgkmcnt(6)
    v_mfma_f32_32x32x16_bf16 v[112:127], v[232:235], v[88:91], v[112:127]
    ds_read_b64_tr_b16 v[88:89], v8 offset:45056
    ds_read_b64_tr_b16 v[90:91], v8 offset:45568
    s_waitcnt lgkmcnt(6)
    v_mfma_f32_32x32x16_bf16 v[112:127], v[236:239], v[92:95], v[112:127]
    ds_read_b64_tr_b16 v[92:93], v8 offset:47104
    ds_read_b64_tr_b16 v[94:95], v8 offset:47616
    s_waitcnt lgkmcnt(6)
    v_mfma_f32_32x32x16_bf16 v[112:127], v[240:243], v[80:83], v[112:127]
    s_waitcnt lgkmcnt(4)
    v_mfma_f32_32x32x16_bf16 v[112:127], v[244:247], v[84:87], v[112:127]
    s_waitcnt lgkmcnt(2)
    v_mfma_f32_32x32x16_bf16 v[112:127], v[248:251], v[88:91], v[112:127]
    s_waitcnt lgkmcnt(0)
    v_mfma_f32_32x32x16_bf16 v[112:127], v[252:255], v[92:95], v[112:127]
    v_cvt_pk_bf16_f32 v64, v96, v97
    v_cvt_pk_bf16_f32 v65, v98, v99
    v_cvt_pk_bf16_f32 v66, v100, v101
    v_cvt_pk_bf16_f32 v67, v102, v103
    v_cvt_pk_bf16_f32 v68, v104, v105
    v_cvt_pk_bf16_f32 v69, v106, v107
    v_cvt_pk_bf16_f32 v70, v108, v109
    v_cvt_pk_bf16_f32 v71, v110, v111
    s_setprio 2
    v_mfma_f32_32x32x16_bf16 v[32:47], v[24:27], v[64:67], 0
    v_mfma_f32_32x32x16_bf16 v[48:63], v[28:31], v[68:71], 0
    s_setprio 0
    s_lshr_b32 s67, s97, 1
    s_lshl2_add_u32 s67, s67, s81
    s_lshl_b32 s67, s67, 7
    s_and_b32 s84, s81, 1
    s_lshl1_add_u32 s83, s97, s84
    s_xor_b32 s84, s83, 1
    s_mul_i32 s83, s83, 0x24000
    s_mul_i32 s84, s84, 0x24000
    v_add_u32 v72, 0x100000, v11
    v_add_u32 v6, s83, v72
    v_add_u32 v7, s84, v72
    v_max3_f32 v76, v32, v33, v34
    v_max3_f32 v76, v76, v35, v36
    v_max3_f32 v76, v76, v37, v38
    v_max3_f32 v76, v76, v39, v40
    v_max3_f32 v76, v76, v41, v42
    v_max3_f32 v76, v76, v43, v44
    v_max3_f32 v76, v76, v45, v46
    v_max_f32 v76, v76, v47
    v_mul_f32 v76, s87, v76
    v_fma_f32 v32, v32, s87, -v76
    v_fma_f32 v33, v33, s87, -v76
    v_fma_f32 v34, v34, s87, -v76
    v_fma_f32 v35, v35, s87, -v76
    v_fma_f32 v36, v36, s87, -v76
    v_fma_f32 v37, v37, s87, -v76
    v_fma_f32 v38, v38, s87, -v76
    v_fma_f32 v39, v39, s87, -v76
    v_fma_f32 v40, v40, s87, -v76
    v_fma_f32 v41, v41, s87, -v76
    v_fma_f32 v42, v42, s87, -v76
    v_fma_f32 v43, v43, s87, -v76
    v_fma_f32 v44, v44, s87, -v76
    v_fma_f32 v45, v45, s87, -v76
    v_fma_f32 v46, v46, s87, -v76
    v_fma_f32 v47, v47, s87, -v76
    v_exp_f32 v32, v32
    v_exp_f32 v33, v33
    v_exp_f32 v34, v34
    v_exp_f32 v35, v35
    v_exp_f32 v36, v36
    v_exp_f32 v37, v37
    v_exp_f32 v38, v38
    v_exp_f32 v39, v39
    v_exp_f32 v40, v40
    v_exp_f32 v41, v41
    v_exp_f32 v42, v42
    v_exp_f32 v43, v43
    v_exp_f32 v44, v44
    v_exp_f32 v45, v45
    v_exp_f32 v46, v46
    v_exp_f32 v47, v47
    v_add_f32 v77, v32, v33
    v_add_f32 v76, v34, v35
    v_add_f32 v77, v77, v36
    v_add_f32 v76, v76, v37
    v_add_f32 v77, v77, v38
    v_add_f32 v76, v76, v39
    v_add_f32 v77, v77, v40
    v_add_f32 v76, v76, v41
    v_add_f32 v77, v77, v42
    v_add_f32 v76, v76, v43
    v_add_f32 v77, v77, v44
    v_add_f32 v76, v76, v45
    v_add_f32 v77, v77, v46
    v_add_f32 v76, v76, v47
    v_add_f32 v77, v77, v76
    v_rcp_f32 v77, v77
    s_nop 0
    v_mul_f32 v32, v77, v32
    v_mul_f32 v33, v77, v33
    v_mul_f32 v34, v77, v34
    v_mul_f32 v35, v77, v35
    v_mul_f32 v36, v77, v36
    v_mul_f32 v37, v77, v37
    v_mul_f32 v38, v77, v38
    v_mul_f32 v39, v77, v39
    v_mul_f32 v40, v77, v40
    v_mul_f32 v41, v77, v41
    v_mul_f32 v42, v77, v42
    v_mul_f32 v43, v77, v43
    v_mul_f32 v44, v77, v44
    v_mul_f32 v45, v77, v45
    v_mul_f32 v46, v77, v46
    v_mul_f32 v47, v77, v47
    v_cvt_pk_bf16_f32 v64, v32, v33
    v_cvt_pk_bf16_f32 v65, v34, v35
    v_cvt_pk_bf16_f32 v66, v36, v37
    v_cvt_pk_bf16_f32 v67, v38, v39
    v_cvt_pk_bf16_f32 v68, v40, v41
    v_cvt_pk_bf16_f32 v69, v42, v43
    v_cvt_pk_bf16_f32 v70, v44, v45
    v_cvt_pk_bf16_f32 v71, v46, v47
    s_setprio 2
    v_mfma_f32_32x32x16_bf16 v[96:111], v[64:67], v[16:19], 0
    v_mfma_f32_32x32x16_bf16 v[96:111], v[68:71], v[20:23], v[96:111]
    s_setprio 0
    v_max3_f32 v76, v48, v49, v50
    v_max3_f32 v76, v76, v51, v52
    v_max3_f32 v76, v76, v53, v54
    v_max3_f32 v76, v76, v55, v56
    v_max3_f32 v76, v76, v57, v58
    v_max3_f32 v76, v76, v59, v60
    v_max3_f32 v76, v76, v61, v62
    v_max_f32 v76, v76, v63
    v_mul_f32 v76, s87, v76
    v_fma_f32 v48, v48, s87, -v76
    v_fma_f32 v49, v49, s87, -v76
    v_fma_f32 v50, v50, s87, -v76
    v_fma_f32 v51, v51, s87, -v76
    v_fma_f32 v52, v52, s87, -v76
    v_fma_f32 v53, v53, s87, -v76
    v_fma_f32 v54, v54, s87, -v76
    v_fma_f32 v55, v55, s87, -v76
    v_fma_f32 v56, v56, s87, -v76
    v_fma_f32 v57, v57, s87, -v76
    v_fma_f32 v58, v58, s87, -v76
    v_cvt_pk_bf16_f32 v32, v96, v97
    v_cvt_pk_bf16_f32 v33, v98, v99
    v_cvt_pk_bf16_f32 v34, v100, v101
    v_cvt_pk_bf16_f32 v35, v102, v103
    v_cvt_pk_bf16_f32 v36, v104, v105
    v_cvt_pk_bf16_f32 v37, v106, v107
    v_cvt_pk_bf16_f32 v38, v108, v109
    v_cvt_pk_bf16_f32 v39, v110, v111
    v_fma_f32 v59, v59, s87, -v76
    v_fma_f32 v60, v60, s87, -v76
    v_fma_f32 v61, v61, s87, -v76
    v_fma_f32 v62, v62, s87, -v76
    v_fma_f32 v63, v63, s87, -v76
    v_exp_f32 v48, v48
    v_exp_f32 v49, v49
    v_exp_f32 v50, v50
    v_exp_f32 v51, v51
    v_exp_f32 v52, v52
    v_exp_f32 v53, v53
    v_exp_f32 v54, v54
    v_exp_f32 v55, v55
    v_exp_f32 v56, v56
    v_exp_f32 v57, v57
    v_exp_f32 v58, v58
    v_exp_f32 v59, v59
    v_exp_f32 v60, v60
    v_exp_f32 v61, v61
    v_exp_f32 v62, v62
    v_exp_f32 v63, v63
    v_add_f32 v77, v48, v49
    v_add_f32 v76, v50, v51
    v_add_f32 v77, v77, v52
    v_add_f32 v76, v76, v53
    v_add_f32 v77, v77, v54
    v_add_f32 v76, v76, v55
    v_add_f32 v77, v77, v56
    v_add_f32 v76, v76, v57
    v_add_f32 v77, v77, v58
    v_add_f32 v76, v76, v59
    v_add_f32 v77, v77, v60
    v_add_f32 v76, v76, v61
    v_add_f32 v77, v77, v62
    v_add_f32 v76, v76, v63
    v_add_f32 v77, v77, v76
    v_rcp_f32 v77, v77
    s_nop 0
    v_mul_f32 v48, v77, v48
    v_mul_f32 v49, v77, v49
    v_mul_f32 v50, v77, v50
    v_mul_f32 v51, v77, v51
    v_mul_f32 v52, v77, v52
    v_mul_f32 v53, v77, v53
    v_mul_f32 v54, v77, v54
    v_mul_f32 v55, v77, v55
    v_mul_f32 v56, v77, v56
    v_mul_f32 v57, v77, v57
    v_mul_f32 v58, v77, v58
    v_mul_f32 v59, v77, v59
    v_mul_f32 v60, v77, v60
    v_mul_f32 v61, v77, v61
    v_mul_f32 v62, v77, v62
    v_mul_f32 v63, v77, v63
    v_cvt_pk_bf16_f32 v64, v48, v49
    v_cvt_pk_bf16_f32 v65, v50, v51
    v_cvt_pk_bf16_f32 v66, v52, v53
    v_cvt_pk_bf16_f32 v67, v54, v55
    v_cvt_pk_bf16_f32 v68, v56, v57
    v_cvt_pk_bf16_f32 v69, v58, v59
    v_cvt_pk_bf16_f32 v70, v60, v61
    v_cvt_pk_bf16_f32 v71, v62, v63
    s_setprio 2
    v_mfma_f32_32x32x16_bf16 v[96:111], v[64:67], v[16:19], 0
    v_mfma_f32_32x32x16_bf16 v[96:111], v[68:71], v[20:23], v[96:111]
    s_setprio 0
    v_cvt_pk_bf16_f32 v48, v112, v113
    v_cvt_pk_bf16_f32 v49, v114, v115
    v_cvt_pk_bf16_f32 v50, v116, v117
    v_cvt_pk_bf16_f32 v51, v118, v119
    v_cvt_pk_bf16_f32 v52, v120, v121
    v_cvt_pk_bf16_f32 v53, v122, v123
    v_cvt_pk_bf16_f32 v54, v124, v125
    v_cvt_pk_bf16_f32 v55, v126, v127
    v_mov_b32 v56, 0x3f803f80
    v_mov_b32 v57, 0x3f803f80
    v_mov_b32 v58, 0x3f803f80
    v_mov_b32 v59, 0x3f803f80
    v_mov_b32 v60, 0x3f803f80
    v_mov_b32 v61, 0x3f803f80
    v_mov_b32 v62, 0x3f803f80
    v_mov_b32 v63, 0x3f803f80
    v_permlane16_swap_b32 v48, v56
    v_permlane16_swap_b32 v49, v57
    v_permlane16_swap_b32 v50, v58
    v_permlane16_swap_b32 v51, v59
    v_permlane16_swap_b32 v52, v60
    v_permlane16_swap_b32 v53, v61
    v_permlane16_swap_b32 v54, v62
    v_permlane16_swap_b32 v55, v63
    v_cvt_pk_bf16_f32 v40, v96, v97
    v_cvt_pk_bf16_f32 v41, v98, v99
    s_setprio 2
    v_mfma_f32_32x32x16_bf16 v[112:127], v[32:35], v[48:51], 0
    v_mfma_f32_32x32x16_bf16 v[112:127], v[36:39], v[52:55], v[112:127]
    s_setprio 0
    v_cvt_pk_bf16_f32 v42, v100, v101
    v_cvt_pk_bf16_f32 v43, v102, v103
    v_cvt_pk_bf16_f32 v44, v104, v105
    v_cvt_pk_bf16_f32 v45, v106, v107
    v_cvt_pk_bf16_f32 v46, v108, v109
    v_cvt_pk_bf16_f32 v47, v110, v111
    s_nop 0
    s_setprio 2
    v_mfma_f32_32x32x16_bf16 v[96:111], v[40:43], v[56:59], 0
    v_mfma_f32_32x32x16_bf16 v[96:111], v[44:47], v[60:63], v[96:111]
    s_setprio 0
    s_lshl_b32 s84, s81, 11
    s_add_u32 s84, s84, 0x10000
    v_add_u32 v73, s84, v11
    s_waitcnt vmcnt(0)
    s_barrier
    ds_read_b64_tr_b16 v[80:81], v9 offset:0
    ds_read_b64_tr_b16 v[82:83], v9 offset:512
    ds_read_b64_tr_b16 v[84:85], v9 offset:2048
    ds_read_b64_tr_b16 v[86:87], v9 offset:2560
    ds_read_b64_tr_b16 v[88:89], v9 offset:4096
    ds_read_b64_tr_b16 v[90:91], v9 offset:4608
    s_setprio 1
    ds_read_b64_tr_b16 v[92:93], v9 offset:6144
    ds_read_b64_tr_b16 v[94:95], v9 offset:6656
    s_waitcnt lgkmcnt(6)
    v_mfma_f32_32x32x16_bf16 v[48:63], v[80:83], v[128:131], 0
    ds_read_b64_tr_b16 v[80:81], v9 offset:8192
    ds_read_b64_tr_b16 v[82:83], v9 offset:8704
    s_waitcnt lgkmcnt(6)
    v_mfma_f32_32x32x16_bf16 v[48:63], v[84:87], v[132:135], v[48:63]
    v_cvt_pk_bf16_f32 v64, v112, v113
    v_cvt_pk_bf16_f32 v65, v114, v115
    ds_read_b64_tr_b16 v[84:85], v9 offset:10240
    ds_read_b64_tr_b16 v[86:87], v9 offset:10752
    s_waitcnt lgkmcnt(6)
    v_mfma_f32_32x32x16_bf16 v[48:63], v[88:91], v[136:139], v[48:63]
    v_cvt_pk_bf16_f32 v66, v116, v117
    v_cvt_pk_bf16_f32 v67, v118, v119
    ds_read_b64_tr_b16 v[88:89], v9 offset:12288
    ds_read_b64_tr_b16 v[90:91], v9 offset:12800
    s_waitcnt lgkmcnt(6)
    v_mfma_f32_32x32x16_bf16 v[48:63], v[92:95], v[140:143], v[48:63]
    v_cvt_pk_bf16_f32 v68, v120, v121
    v_cvt_pk_bf16_f32 v69, v122, v123
    ds_read_b64_tr_b16 v[92:93], v9 offset:14336
    ds_read_b64_tr_b16 v[94:95], v9 offset:14848
    s_waitcnt lgkmcnt(6)
    v_mfma_f32_32x32x16_bf16 v[48:63], v[80:83], v[144:147], v[48:63]
    v_cvt_pk_bf16_f32 v70, v124, v125
    v_cvt_pk_bf16_f32 v71, v126, v127
    ds_read_b64_tr_b16 v[80:81], v9 offset:16384
    ds_read_b64_tr_b16 v[82:83], v9 offset:16896
    s_waitcnt lgkmcnt(6)
    v_mfma_f32_32x32x16_bf16 v[48:63], v[84:87], v[148:151], v[48:63]
    ds_write_b128 v73, v[64:67] offset:0
    ds_write_b128 v73, v[68:71] offset:1024
    ds_read_b64_tr_b16 v[84:85], v9 offset:18432
    ds_read_b64_tr_b16 v[86:87], v9 offset:18944
    s_waitcnt lgkmcnt(8)
    v_mfma_f32_32x32x16_bf16 v[48:63], v[88:91], v[152:155], v[48:63]
    v_cvt_pk_bf16_f32 v112, v96, v97
    v_cvt_pk_bf16_f32 v113, v98, v99
    ds_read_b64_tr_b16 v[88:89], v9 offset:20480
    ds_read_b64_tr_b16 v[90:91], v9 offset:20992
    s_waitcnt lgkmcnt(8)
    v_mfma_f32_32x32x16_bf16 v[48:63], v[92:95], v[156:159], v[48:63]
    v_cvt_pk_bf16_f32 v114, v100, v101
    v_cvt_pk_bf16_f32 v115, v102, v103
    ds_read_b64_tr_b16 v[92:93], v9 offset:22528
    ds_read_b64_tr_b16 v[94:95], v9 offset:23040
    s_waitcnt lgkmcnt(8)
    v_mfma_f32_32x32x16_bf16 v[48:63], v[80:83], v[160:163], v[48:63]
    v_cvt_pk_bf16_f32 v116, v104, v105
    v_cvt_pk_bf16_f32 v117, v106, v107
    ds_read_b64_tr_b16 v[80:81], v9 offset:24576
    ds_read_b64_tr_b16 v[82:83], v9 offset:25088
    s_waitcnt lgkmcnt(6)
    v_mfma_f32_32x32x16_bf16 v[48:63], v[84:87], v[164:167], v[48:63]
    v_cvt_pk_bf16_f32 v118, v108, v109
    v_cvt_pk_bf16_f32 v119, v110, v111
    ds_read_b64_tr_b16 v[84:85], v9 offset:26624
    ds_read_b64_tr_b16 v[86:87], v9 offset:27136
    s_waitcnt lgkmcnt(6)
    v_mfma_f32_32x32x16_bf16 v[48:63], v[88:91], v[168:171], v[48:63]
    ds_write_b128 v73, v[112:115] offset:8192
    ds_write_b128 v73, v[116:119] offset:9216
    ds_read_b64_tr_b16 v[88:89], v9 offset:28672
    ds_read_b64_tr_b16 v[90:91], v9 offset:29184
    s_waitcnt lgkmcnt(8)
    v_mfma_f32_32x32x16_bf16 v[48:63], v[92:95], v[172:175], v[48:63]
    ds_read_b64_tr_b16 v[92:93], v9 offset:30720
    ds_read_b64_tr_b16 v[94:95], v9 offset:31232
    s_waitcnt lgkmcnt(8)
    v_mfma_f32_32x32x16_bf16 v[48:63], v[80:83], v[176:179], v[48:63]
    s_waitcnt lgkmcnt(4)
    s_barrier
    ds_read_b64_tr_b16 v[80:81], v9 offset:32768
    ds_read_b64_tr_b16 v[82:83], v9 offset:33280
    v_mfma_f32_32x32x16_bf16 v[48:63], v[84:87], v[180:183], v[48:63]
    ds_read_b64_tr_b16 v[84:85], v9 offset:34816
    ds_read_b64_tr_b16 v[86:87], v9 offset:35328
    s_waitcnt lgkmcnt(6)
    v_mfma_f32_32x32x16_bf16 v[48:63], v[88:91], v[184:187], v[48:63]
    ds_read_b64_tr_b16 v[88:89], v9 offset:36864
    ds_read_b64_tr_b16 v[90:91], v9 offset:37376
    s_waitcnt lgkmcnt(6)
    v_mfma_f32_32x32x16_bf16 v[48:63], v[92:95], v[188:191], v[48:63]
    ds_read_b64_tr_b16 v[92:93], v9 offset:38912
    ds_read_b64_tr_b16 v[94:95], v9 offset:39424
    s_waitcnt lgkmcnt(6)
    v_mfma_f32_32x32x16_bf16 v[48:63], v[80:83], v[192:195], v[48:63]
    ds_read_b64_tr_b16 v[80:81], v9 offset:40960
    ds_read_b64_tr_b16 v[82:83], v9 offset:41472
    s_waitcnt lgkmcnt(6)
    v_mfma_f32_32x32x16_bf16 v[48:63], v[84:87], v[196:199], v[48:63]
    ds_read_b64_tr_b16 v[84:85], v9 offset:43008
    ds_read_b64_tr_b16 v[86:87], v9 offset:43520
    s_waitcnt lgkmcnt(6)
    v_mfma_f32_32x32x16_bf16 v[48:63], v[88:91], v[200:203], v[48:63]
    ds_read_b64_tr_b16 v[88:89], v9 offset:45056
    ds_read_b64_tr_b16 v[90:91], v9 offset:45568
    s_waitcnt lgkmcnt(6)
    v_mfma_f32_32x32x16_bf16 v[48:63], v[92:95], v[204:207], v[48:63]
    ds_read_b64_tr_b16 v[92:93], v9 offset:47104
    ds_read_b64_tr_b16 v[94:95], v9 offset:47616
    s_waitcnt lgkmcnt(6)
    v_mfma_f32_32x32x16_bf16 v[48:63], v[80:83], v[208:211], v[48:63]
    v_readfirstlane_b32 s83, v2
    s_movk_i32 s84, 0x7fff
L_pia_chk:
    s_cmp_ge_u32 s83, 8
    s_cbranch_scc1 L_pia_ok
    s_sub_u32 s84, s84, 1
    s_cbranch_scc1 L_pia_ok
    buffer_load_dword v2, off, s[20:23], 0 sc1
    s_waitcnt vmcnt(0)
    v_readfirstlane_b32 s83, v2
    s_branch L_pia_chk
L_pia_ok:
    ds_read_b64_tr_b16 v[80:81], v9 offset:49152
    ds_read_b64_tr_b16 v[82:83], v9 offset:49664
    s_waitcnt lgkmcnt(6)
    v_mfma_f32_32x32x16_bf16 v[48:63], v[84:87], v[212:215], v[48:63]
    s_add_u32 s72, s62, 0xc000
    s_mov_b32 s73, 0x14000
    v_lshrrev_b32 v72, 5, v0
    ds_read_b64_tr_b16 v[84:85], v9 offset:51200
    ds_read_b64_tr_b16 v[86:87], v9 offset:51712
    s_waitcnt lgkmcnt(6)
    v_mfma_f32_32x32x16_bf16 v[48:63], v[88:91], v[216:219], v[48:63]
    v_bfe_u32 v73, v0, 2, 2
    v_lshl_add_u32 v72, v72, 2, v73
    ds_read_b64_tr_b16 v[88:89], v9 offset:53248
    ds_read_b64_tr_b16 v[90:91], v9 offset:53760
    s_waitcnt lgkmcnt(6)
    v_mfma_f32_32x32x16_bf16 v[48:63], v[92:95], v[220:223], v[48:63]
    v_lshlrev_b32 v4, 7, v72
    v_lshrrev_b32 v73, 1, v73
    ds_read_b64_tr_b16 v[92:93], v9 offset:55296
    ds_read_b64_tr_b16 v[94:95], v9 offset:55808
    s_waitcnt lgkmcnt(6)
    v_mfma_f32_32x32x16_bf16 v[48:63], v[80:83], v[224:227], v[48:63]
    s_lshr_b32 s83, s81, 1
    v_xor_b32 v73, s83, v73
    ds_read_b64_tr_b16 v[80:81], v9 offset:57344
    ds_read_b64_tr_b16 v[82:83], v9 offset:57856
    s_waitcnt lgkmcnt(6)
    v_mfma_f32_32x32x16_bf16 v[48:63], v[84:87], v[228:231], v[48:63]
    v_lshl_add_u32 v4, v73, 6, v4
    v_bfe_u32 v73, v0, 4, 1
    ds_read_b64_tr_b16 v[84:85], v9 offset:59392
    ds_read_b64_tr_b16 v[86:87], v9 offset:59904
    s_waitcnt lgkmcnt(6)
    v_mfma_f32_32x32x16_bf16 v[48:63], v[88:91], v[232:235], v[48:63]
    v_lshl_add_u32 v4, v73, 5, v4
    v_and_b32 v73, 3, v0
    ds_read_b64_tr_b16 v[88:89], v9 offset:61440
    ds_read_b64_tr_b16 v[90:91], v9 offset:61952
    s_waitcnt lgkmcnt(6)
    v_mfma_f32_32x32x16_bf16 v[48:63], v[92:95], v[236:239], v[48:63]
    v_lshl_add_u32 v4, v73, 3, v4
    v_add_u32 v4, s62, v4
    ds_read_b64_tr_b16 v[92:93], v9 offset:63488
    ds_read_b64_tr_b16 v[94:95], v9 offset:64000
    s_waitcnt lgkmcnt(6)
    v_mfma_f32_32x32x16_bf16 v[48:63], v[80:83], v[240:243], v[48:63]
    v_xor_b32 v5, 64, v4
    v_add_u32 v2, 0xc000, v4
    s_waitcnt lgkmcnt(4)
    v_mfma_f32_32x32x16_bf16 v[48:63], v[84:87], v[244:247], v[48:63]
    v_add_u32 v3, 0xc000, v5
    s_waitcnt lgkmcnt(2)
    v_mfma_f32_32x32x16_bf16 v[48:63], v[88:91], v[248:251], v[48:63]
    s_waitcnt lgkmcnt(0)
    v_mfma_f32_32x32x16_bf16 v[48:63], v[92:95], v[252:255], v[48:63]
    s_load_dwordx2 s[68:69], s[58:59], s67 offset:0 glc
    s_setprio 0
    v_readlane_b32 s63, v13, 0
    s_add_u32 m0, s62, 0x0
    s_lshl_b32 s64, s63, 14
    buffer_load_dwordx4 v14, s[24:27], s64 offen lds
    buffer_load_dwordx4 v15, s[24:27], s64 offen offset:1024 lds
    v_readlane_b32 s63, v13, 1
    s_add_u32 m0, s62, 0x2000
    s_lshl_b32 s64, s63, 14
    buffer_load_dwordx4 v14, s[24:27], s64 offen lds
    buffer_load_dwordx4 v15, s[24:27], s64 offen offset:1024 lds
    v_readlane_b32 s63, v13, 2
    s_add_u32 m0, s62, 0x4000
    s_lshl_b32 s64, s63, 14
    buffer_load_dwordx4 v14, s[24:27], s64 offen lds
    buffer_load_dwordx4 v15, s[24:27], s64 offen offset:1024 lds
    v_readlane_b32 s63, v13, 3
    s_add_u32 m0, s62, 0x6000
    s_lshl_b32 s64, s63, 14
    buffer_load_dwordx4 v14, s[24:27], s64 offen lds
    buffer_load_dwordx4 v15, s[24:27], s64 offen offset:1024 lds
    s_lshl_b32 s84, s81, 11
    s_add_u32 s84, s84, 0x10000
    v_add_u32 v73, s84, v11
    v_mov_b32 v76, 0x24c1c
    s_mov_b32 s84, 0x80000
L_sf_spin:
    ds_read_b32 v77, v76
    s_waitcnt lgkmcnt(0)
    v_readfirstlane_b32 s83, v77
    s_cmp_ge_u32 s83, 4
    s_cbranch_scc1 L_sf_done
    s_sub_u32 s84, s84, 1
    s_cbranch_scc0 L_sf_spin
L_sf_done:
    s_waitcnt lgkmcnt(0)
    v_cvt_pk_bf16_f32 v64, v48, v49
    v_cvt_pk_bf16_f32 v65, v50, v51
    v_cvt_pk_bf16_f32 v66, v52, v53
    v_cvt_pk_bf16_f32 v67, v54, v55
    v_cvt_pk_bf16_f32 v68, v56, v57
    v_cvt_pk_bf16_f32 v69, v58, v59
    v_cvt_pk_bf16_f32 v70, v60, v61
    v_cvt_pk_bf16_f32 v71, v62, v63
    ds_write_b128 v73, v[64:67] offset:0
    ds_write_b128 v73, v[68:71] offset:1024
    s_waitcnt lgkmcnt(0)
    v_mov_b32 v76, 0x24c14
    v_mov_b32 v77, 1
    s_mov_b64 exec, 1
    ds_add_u32 v76, v77
    s_mov_b64 exec, -1
    v_mov_b32 v76, 0x24c0c
    v_mov_b32 v77, 1
    s_mov_b64 exec, 1
    ds_add_u32 v76, v77
    s_mov_b64 exec, -1
    s_waitcnt lgkmcnt(0)
    s_min_u32 s83, s68, s69
    s_cmp_ge_u32 s83, 1
    s_cbranch_scc1 L_f0a_done
    s_mov_b32 s84, 0x8000
L_f0a_spin:
    s_load_dwordx2 s[68:69], s[58:59], s67 offset:0 glc
    s_waitcnt lgkmcnt(0)
    s_min_u32 s83, s68, s69
    s_cmp_ge_u32 s83, 1
    s_cbranch_scc1 L_f0a_done
    s_sleep 2
    s_sub_u32 s84, s84, 1
    s_cbranch_scc0 L_f0a_spin
L_f0a_done:
    v_readlane_b32 s65, v13, 0
    s_lshl_b32 s66, s65, 10
    buffer_load_dwordx4 v[192:195], v6, s[16:19], s66 offen sc1
    buffer_load_dwordx4 v[196:199], v7, s[16:19], s66 offen sc1
    v_readlane_b32 s65, v13, 1
    s_lshl_b32 s66, s65, 10
    buffer_load_dwordx4 v[200:203], v6, s[16:19], s66 offen sc1
    buffer_load_dwordx4 v[204:207], v7, s[16:19], s66 offen sc1
    v_readlane_b32 s63, v13, 4
    s_add_u32 m0, s62, 0x8000
    s_lshl_b32 s64, s63, 14
    buffer_load_dwordx4 v14, s[24:27], s64 offen lds
    buffer_load_dwordx4 v15, s[24:27], s64 offen offset:1024 lds
    v_readlane_b32 s65, v13, 2
    s_lshl_b32 s66, s65, 10
    buffer_load_dwordx4 v[208:211], v6, s[16:19], s66 offen sc1
    buffer_load_dwordx4 v[212:215], v7, s[16:19], s66 offen sc1
    v_readlane_b32 s63, v13, 5
    s_add_u32 m0, s62, 0xa000
    s_lshl_b32 s64, s63, 14
    buffer_load_dwordx4 v14, s[24:27], s64 offen lds
    buffer_load_dwordx4 v15, s[24:27], s64 offen offset:1024 lds
    v_readlane_b32 s65, v13, 3
    s_lshl_b32 s66, s65, 10
    buffer_load_dwordx4 v[216:219], v6, s[16:19], s66 offen sc1
    buffer_load_dwordx4 v[220:223], v7, s[16:19], s66 offen sc1
    v_readlane_b32 s63, v13, 6
    s_add_u32 m0, s72, 0x0
    s_lshl_b32 s64, s63, 14
    buffer_load_dwordx4 v14, s[24:27], s64 offen lds
    buffer_load_dwordx4 v15, s[24:27], s64 offen offset:1024 lds
    s_waitcnt vmcnt(18)
    ds_read_b64_tr_b16 v[64:65], v4 offset:0
    ds_read_b64_tr_b16 v[66:67], v4 offset:1024
    ds_read_b64_tr_b16 v[68:69], v5 offset:0
    ds_read_b64_tr_b16 v[70:71], v5 offset:1024
    ds_read_b64_tr_b16 v[72:73], v4 offset:8192
    ds_read_b64_tr_b16 v[74:75], v4 offset:9216
    ds_read_b64_tr_b16 v[76:77], v5 offset:8192
    ds_read_b64_tr_b16 v[78:79], v5 offset:9216
    s_load_dwordx2 s[68:69], s[58:59], s67 offset:0 glc
    s_waitcnt vmcnt(12)
    s_waitcnt lgkmcnt(6)
    s_setprio 2
    v_mfma_f32_32x32x16_bf16 v[128:143], v[64:67], v[192:195], 0
    s_setprio 0
    ds_read_b64_tr_b16 v[80:81], v4 offset:16384
    v_readlane_b32 s65, v13, 4
    s_lshl_b32 s66, s65, 10
    buffer_load_dwordx4 v[224:227], v6, s[16:19], s66 offen sc1
    s_setprio 2
    v_mfma_f32_32x32x16_bf16 v[144:159], v[64:67], v[196:199], 0
    s_setprio 0
    ds_read_b64_tr_b16 v[82:83], v4 offset:17408
    buffer_load_dwordx4 v[228:231], v7, s[16:19], s66 offen sc1
    s_waitcnt lgkmcnt(6)
    s_setprio 2
    v_mfma_f32_32x32x16_bf16 v[176:191], v[68:71], v[196:199], 0
    s_setprio 0
    ds_read_b64_tr_b16 v[84:85], v5 offset:16384
    v_readlane_b32 s63, v13, 7
    s_add_u32 m0, s72, 0x2000
    s_lshl_b32 s64, s63, 14
    buffer_load_dwordx4 v14, s[24:27], s64 offen lds
    s_setprio 2
    v_mfma_f32_32x32x16_bf16 v[160:175], v[68:71], v[192:195], 0
    s_setprio 0
    ds_read_b64_tr_b16 v[86:87], v5 offset:17408
    buffer_load_dwordx4 v15, s[24:27], s64 offen offset:1024 lds
    s_waitcnt vmcnt(14)
    s_waitcnt lgkmcnt(6)
    s_setprio 2
    v_mfma_f32_32x32x16_bf16 v[128:143], v[72:75], v[200:203], v[128:143]
    s_setprio 0
    ds_read_b64_tr_b16 v[88:89], v4 offset:24576
    v_readlane_b32 s65, v13, 5
    s_lshl_b32 s66, s65, 10
    buffer_load_dwordx4 v[192:195], v6, s[16:19], s66 offen sc1
    s_setprio 2
    v_mfma_f32_32x32x16_bf16 v[144:159], v[72:75], v[204:207], v[144:159]
    s_setprio 0
    ds_read_b64_tr_b16 v[90:91], v4 offset:25600
    buffer_load_dwordx4 v[196:199], v7, s[16:19], s66 offen sc1
    s_waitcnt lgkmcnt(6)
    s_setprio 2
    v_mfma_f32_32x32x16_bf16 v[176:191], v[76:79], v[204:207], v[176:191]
    s_setprio 0
    ds_read_b64_tr_b16 v[92:93], v5 offset:24576
    v_readlane_b32 s63, v13, 8
    s_add_u32 m0, s62, 0x0
    s_lshl_b32 s64, s63, 14
    buffer_load_dwordx4 v14, s[24:27], s64 offen lds
    s_setprio 2
    v_mfma_f32_32x32x16_bf16 v[160:175], v[76:79], v[200:203], v[160:175]
    s_setprio 0
    ds_read_b64_tr_b16 v[94:95], v5 offset:25600
    buffer_load_dwordx4 v15, s[24:27], s64 offen offset:1024 lds
    s_waitcnt vmcnt(14)
    s_waitcnt lgkmcnt(6)
    s_setprio 2
    v_mfma_f32_32x32x16_bf16 v[128:143], v[80:83], v[208:211], v[128:143]
    s_setprio 0
    ds_read_b64_tr_b16 v[64:65], v4 offset:32768
    v_readlane_b32 s65, v13, 6
    s_lshl_b32 s66, s65, 10
    buffer_load_dwordx4 v[200:203], v6, s[16:19], s66 offen sc1
    s_setprio 2
    v_mfma_f32_32x32x16_bf16 v[144:159], v[80:83], v[212:215], v[144:159]
    s_setprio 0
    ds_read_b64_tr_b16 v[66:67], v4 offset:33792
    buffer_load_dwordx4 v[204:207], v7, s[16:19], s66 offen sc1
    s_waitcnt lgkmcnt(6)
    s_setprio 2
    v_mfma_f32_32x32x16_bf16 v[176:191], v[84:87], v[212:215], v[176:191]
    s_setprio 0
    ds_read_b64_tr_b16 v[68:69], v5 offset:32768
    v_readlane_b32 s63, v13, 9
    s_add_u32 m0, s62, 0x2000
    s_lshl_b32 s64, s63, 14
    buffer_load_dwordx4 v14, s[24:27], s64 offen lds
    s_setprio 2
    v_mfma_f32_32x32x16_bf16 v[160:175], v[84:87], v[208:211], v[160:175]
    s_setprio 0
    ds_read_b64_tr_b16 v[70:71], v5 offset:33792
    buffer_load_dwordx4 v15, s[24:27], s64 offen offset:1024 lds
    s_waitcnt vmcnt(14)
    s_waitcnt lgkmcnt(6)
    s_setprio 2
    v_mfma_f32_32x32x16_bf16 v[128:143], v[88:91], v[216:219], v[128:143]
    s_setprio 0
    ds_read_b64_tr_b16 v[72:73], v4 offset:40960
    v_readlane_b32 s65, v13, 7
    s_lshl_b32 s66, s65, 10
    buffer_load_dwordx4 v[208:211], v6, s[16:19], s66 offen sc1
    s_setprio 2
    v_mfma_f32_32x32x16_bf16 v[144:159], v[88:91], v[220:223], v[144:159]
    s_setprio 0
    ds_read_b64_tr_b16 v[74:75], v4 offset:41984
    buffer_load_dwordx4 v[212:215], v7, s[16:19], s66 offen sc1
    s_waitcnt lgkmcnt(6)
    s_setprio 2
    v_mfma_f32_32x32x16_bf16 v[176:191], v[92:95], v[220:223], v[176:191]
    s_setprio 0
    ds_read_b64_tr_b16 v[76:77], v5 offset:40960
    v_readlane_b32 s63, v13, 10
    s_add_u32 m0, s62, 0x4000
    s_lshl_b32 s64, s63, 14
    buffer_load_dwordx4 v14, s[24:27], s64 offen lds
    s_setprio 2
    v_mfma_f32_32x32x16_bf16 v[160:175], v[92:95], v[216:219], v[160:175]
    s_setprio 0
    ds_read_b64_tr_b16 v[78:79], v5 offset:41984
    buffer_load_dwordx4 v15, s[24:27], s64 offen offset:1024 lds
    s_waitcnt lgkmcnt(0)
    s_min_u32 s83, s68, s69
    s_cmp_ge_u32 s83, 2
    s_cbranch_scc1 L_f1a_done
    s_mov_b32 s84, 0x8000
L_f1a_spin:
    s_load_dwordx2 s[68:69], s[58:59], s67 offset:0 glc
    s_waitcnt lgkmcnt(0)
    s_min_u32 s83, s68, s69
    s_cmp_ge_u32 s83, 2
    s_cbranch_scc1 L_f1a_done
    s_sleep 2
    s_sub_u32 s84, s84, 1
    s_cbranch_scc0 L_f1a_spin
L_f1a_done:
    s_waitcnt vmcnt(14)
    s_setprio 2
    v_mfma_f32_32x32x16_bf16 v[128:143], v[64:67], v[224:227], v[128:143]
    s_setprio 0
    ds_read_b64_tr_b16 v[80:81], v2 offset:0
    v_readlane_b32 s65, v13, 8
    s_lshl_b32 s66, s65, 10
    buffer_load_dwordx4 v[216:219], v6, s[16:19], s66 offen sc1
    s_setprio 2
    v_mfma_f32_32x32x16_bf16 v[144:159], v[64:67], v[228:231], v[144:159]
    s_setprio 0
    ds_read_b64_tr_b16 v[82:83], v2 offset:1024
    buffer_load_dwordx4 v[220:223], v7, s[16:19], s66 offen sc1
    s_setprio 2
    v_mfma_f32_32x32x16_bf16 v[176:191], v[68:71], v[228:231], v[176:191]
    s_setprio 0
    ds_read_b64_tr_b16 v[84:85], v3 offset:0
    v_readlane_b32 s63, v13, 11
    s_add_u32 m0, s62, 0x6000
    s_lshl_b32 s64, s63, 14
    buffer_load_dwordx4 v14, s[24:27], s64 offen lds
    s_setprio 2
    v_mfma_f32_32x32x16_bf16 v[160:175], v[68:71], v[224:227], v[160:175]
    s_setprio 0
    ds_read_b64_tr_b16 v[86:87], v3 offset:1024
    buffer_load_dwordx4 v15, s[24:27], s64 offen offset:1024 lds
    s_waitcnt vmcnt(14)
    s_setprio 2
    v_mfma_f32_32x32x16_bf16 v[128:143], v[72:75], v[192:195], v[128:143]
    s_setprio 0
    ds_read_b64_tr_b16 v[88:89], v2 offset:8192
    v_readlane_b32 s65, v13, 9
    s_lshl_b32 s66, s65, 10
    buffer_load_dwordx4 v[224:227], v6, s[16:19], s66 offen sc1
    s_setprio 2
    v_mfma_f32_32x32x16_bf16 v[144:159], v[72:75], v[196:199], v[144:159]
    s_setprio 0
    ds_read_b64_tr_b16 v[90:91], v2 offset:9216
    buffer_load_dwordx4 v[228:231], v7, s[16:19], s66 offen sc1
    s_setprio 2
    v_mfma_f32_32x32x16_bf16 v[176:191], v[76:79], v[196:199], v[176:191]
    s_setprio 0
    ds_read_b64_tr_b16 v[92:93], v3 offset:8192
    v_readlane_b32 s63, v13, 12
    s_add_u32 m0, s62, 0x8000
    s_lshl_b32 s64, s63, 14
    buffer_load_dwordx4 v14, s[24:27], s64 offen lds
    s_setprio 2
    v_mfma_f32_32x32x16_bf16 v[160:175], v[76:79], v[192:195], v[160:175]
    s_setprio 0
    ds_read_b64_tr_b16 v[94:95], v3 offset:9216
    buffer_load_dwordx4 v15, s[24:27], s64 offen offset:1024 lds
    s_waitcnt vmcnt(14)
    s_waitcnt lgkmcnt(6)
    s_setprio 2
    v_mfma_f32_32x32x16_bf16 v[128:143], v[80:83], v[200:203], v[128:143]
    s_setprio 0
    ds_read_b64_tr_b16 v[64:65], v4 offset:0
    v_readlane_b32 s65, v13, 10
    s_lshl_b32 s66, s65, 10
    buffer_load_dwordx4 v[192:195], v6, s[16:19], s66 offen sc1
    s_setprio 2
    v_mfma_f32_32x32x16_bf16 v[144:159], v[80:83], v[204:207], v[144:159]
    s_setprio 0
    ds_read_b64_tr_b16 v[66:67], v4 offset:1024
    buffer_load_dwordx4 v[196:199], v7, s[16:19], s66 offen sc1
    s_waitcnt lgkmcnt(6)
    s_setprio 2
    v_mfma_f32_32x32x16_bf16 v[176:191], v[84:87], v[204:207], v[176:191]
    s_setprio 0
    ds_read_b64_tr_b16 v[68:69], v5 offset:0
    v_readlane_b32 s63, v13, 13
    s_add_u32 m0, s62, 0xa000
    s_lshl_b32 s64, s63, 14
    buffer_load_dwordx4 v14, s[24:27], s64 offen lds
    s_setprio 2
    v_mfma_f32_32x32x16_bf16 v[160:175], v[84:87], v[200:203], v[160:175]
    s_setprio 0
    ds_read_b64_tr_b16 v[70:71], v5 offset:1024
    buffer_load_dwordx4 v15, s[24:27], s64 offen offset:1024 lds
    s_load_dwordx2 s[68:69], s[58:59], s67 offset:0 glc
    s_waitcnt vmcnt(14)
    s_waitcnt lgkmcnt(6)
    s_setprio 2
    v_mfma_f32_32x32x16_bf16 v[128:143], v[88:91], v[208:211], v[128:143]
    s_setprio 0
    ds_read_b64_tr_b16 v[72:73], v4 offset:8192
    v_readlane_b32 s65, v13, 11
    s_lshl_b32 s66, s65, 10
    buffer_load_dwordx4 v[200:203], v6, s[16:19], s66 offen sc1
    s_setprio 2
    v_mfma_f32_32x32x16_bf16 v[144:159], v[88:91], v[212:215], v[144:159]
    s_setprio 0
    ds_read_b64_tr_b16 v[74:75], v4 offset:9216
    buffer_load_dwordx4 v[204:207], v7, s[16:19], s66 offen sc1
    s_waitcnt lgkmcnt(6)
    s_setprio 2
    v_mfma_f32_32x32x16_bf16 v[176:191], v[92:95], v[212:215], v[176:191]
    s_setprio 0
    ds_read_b64_tr_b16 v[76:77], v5 offset:8192
    v_readlane_b32 s63, v13, 14
    s_add_u32 m0, s72, 0x0
    s_lshl_b32 s64, s63, 14
    buffer_load_dwordx4 v14, s[24:27], s64 offen lds
    s_setprio 2
    v_mfma_f32_32x32x16_bf16 v[160:175], v[92:95], v[208:211], v[160:175]
    s_setprio 0
    ds_read_b64_tr_b16 v[78:79], v5 offset:9216
    buffer_load_dwordx4 v15, s[24:27], s64 offen offset:1024 lds
    s_waitcnt vmcnt(14)
    s_waitcnt lgkmcnt(6)
    s_setprio 2
    v_mfma_f32_32x32x16_bf16 v[128:143], v[64:67], v[216:219], v[128:143]
    s_setprio 0
    ds_read_b64_tr_b16 v[80:81], v4 offset:16384
    v_readlane_b32 s65, v13, 12
    s_lshl_b32 s66, s65, 10
    buffer_load_dwordx4 v[208:211], v6, s[16:19], s66 offen sc1
    s_setprio 2
    v_mfma_f32_32x32x16_bf16 v[144:159], v[64:67], v[220:223], v[144:159]
    s_setprio 0
    ds_read_b64_tr_b16 v[82:83], v4 offset:17408
    buffer_load_dwordx4 v[212:215], v7, s[16:19], s66 offen sc1
    s_waitcnt lgkmcnt(6)
    s_setprio 2
    v_mfma_f32_32x32x16_bf16 v[176:191], v[68:71], v[220:223], v[176:191]
    s_setprio 0
    ds_read_b64_tr_b16 v[84:85], v5 offset:16384
    v_readlane_b32 s63, v13, 15
    s_add_u32 m0, s72, 0x2000
    s_lshl_b32 s64, s63, 14
    buffer_load_dwordx4 v14, s[24:27], s64 offen lds
    s_setprio 2
    v_mfma_f32_32x32x16_bf16 v[160:175], v[68:71], v[216:219], v[160:175]
    s_setprio 0
    ds_read_b64_tr_b16 v[86:87], v5 offset:17408
    buffer_load_dwordx4 v15, s[24:27], s64 offen offset:1024 lds
    s_waitcnt vmcnt(14)
    s_waitcnt lgkmcnt(6)
    s_setprio 2
    v_mfma_f32_32x32x16_bf16 v[128:143], v[72:75], v[224:227], v[128:143]
    s_setprio 0
    ds_read_b64_tr_b16 v[88:89], v4 offset:24576
    v_readlane_b32 s65, v13, 13
    s_lshl_b32 s66, s65, 10
    buffer_load_dwordx4 v[216:219], v6, s[16:19], s66 offen sc1
    s_setprio 2
    v_mfma_f32_32x32x16_bf16 v[144:159], v[72:75], v[228:231], v[144:159]
    s_setprio 0
    ds_read_b64_tr_b16 v[90:91], v4 offset:25600
    buffer_load_dwordx4 v[220:223], v7, s[16:19], s66 offen sc1
    s_waitcnt lgkmcnt(6)
    s_setprio 2
    v_mfma_f32_32x32x16_bf16 v[176:191], v[76:79], v[228:231], v[176:191]
    s_setprio 0
    ds_read_b64_tr_b16 v[92:93], v5 offset:24576
    v_readlane_b32 s63, v13, 16
    s_add_u32 m0, s62, 0x0
    s_lshl_b32 s64, s63, 14
    buffer_load_dwordx4 v14, s[24:27], s64 offen lds
    s_setprio 2
    v_mfma_f32_32x32x16_bf16 v[160:175], v[76:79], v[224:227], v[160:175]
    s_setprio 0
    ds_read_b64_tr_b16 v[94:95], v5 offset:25600
    buffer_load_dwordx4 v15, s[24:27], s64 offen offset:1024 lds
    s_waitcnt vmcnt(14)
    s_waitcnt lgkmcnt(6)
    s_setprio 2
    v_mfma_f32_32x32x16_bf16 v[128:143], v[80:83], v[192:195], v[128:143]
    s_setprio 0
    ds_read_b64_tr_b16 v[64:65], v4 offset:32768
    v_readlane_b32 s65, v13, 14
    s_lshl_b32 s66, s65, 10
    buffer_load_dwordx4 v[224:227], v6, s[16:19], s66 offen sc1
    s_setprio 2
    v_mfma_f32_32x32x16_bf16 v[144:159], v[80:83], v[196:199], v[144:159]
    s_setprio 0
    ds_read_b64_tr_b16 v[66:67], v4 offset:33792
    buffer_load_dwordx4 v[228:231], v7, s[16:19], s66 offen sc1
    s_waitcnt lgkmcnt(6)
    s_setprio 2
    v_mfma_f32_32x32x16_bf16 v[176:191], v[84:87], v[196:199], v[176:191]
    s_setprio 0
    ds_read_b64_tr_b16 v[68:69], v5 offset:32768
    v_readlane_b32 s63, v13, 17
    s_add_u32 m0, s62, 0x2000
    s_lshl_b32 s64, s63, 14
    buffer_load_dwordx4 v14, s[24:27], s64 offen lds
    s_setprio 2
    v_mfma_f32_32x32x16_bf16 v[160:175], v[84:87], v[192:195], v[160:175]
    s_setprio 0
    ds_read_b64_tr_b16 v[70:71], v5 offset:33792
    buffer_load_dwordx4 v15, s[24:27], s64 offen offset:1024 lds
    s_waitcnt vmcnt(14)
    s_waitcnt lgkmcnt(6)
    s_setprio 2
    v_mfma_f32_32x32x16_bf16 v[128:143], v[88:91], v[200:203], v[128:143]
    s_setprio 0
    ds_read_b64_tr_b16 v[72:73], v4 offset:40960
    v_readlane_b32 s65, v13, 15
    s_lshl_b32 s66, s65, 10
    buffer_load_dwordx4 v[192:195], v6, s[16:19], s66 offen sc1
    s_setprio 2
    v_mfma_f32_32x32x16_bf16 v[144:159], v[88:91], v[204:207], v[144:159]
    s_setprio 0
    ds_read_b64_tr_b16 v[74:75], v4 offset:41984
    buffer_load_dwordx4 v[196:199], v7, s[16:19], s66 offen sc1
    s_waitcnt lgkmcnt(6)
    s_setprio 2
    v_mfma_f32_32x32x16_bf16 v[176:191], v[92:95], v[204:207], v[176:191]
    s_setprio 0
    ds_read_b64_tr_b16 v[76:77], v5 offset:40960
    v_readlane_b32 s63, v13, 18
    s_add_u32 m0, s62, 0x4000
    s_lshl_b32 s64, s63, 14
    buffer_load_dwordx4 v14, s[24:27], s64 offen lds
    s_setprio 2
    v_mfma_f32_32x32x16_bf16 v[160:175], v[92:95], v[200:203], v[160:175]
    s_setprio 0
    ds_read_b64_tr_b16 v[78:79], v5 offset:41984
    buffer_load_dwordx4 v15, s[24:27], s64 offen offset:1024 lds
    s_waitcnt lgkmcnt(0)
    s_min_u32 s83, s68, s69
    s_cmp_ge_u32 s83, 3
    s_cbranch_scc1 L_f2a_done
    s_mov_b32 s84, 0x8000
L_f2a_spin:
    s_load_dwordx2 s[68:69], s[58:59], s67 offset:0 glc
    s_waitcnt lgkmcnt(0)
    s_min_u32 s83, s68, s69
    s_cmp_ge_u32 s83, 3
    s_cbranch_scc1 L_f2a_done
    s_sleep 2
    s_sub_u32 s84, s84, 1
    s_cbranch_scc0 L_f2a_spin
L_f2a_done:
    s_waitcnt vmcnt(14)
    v_mfma_f32_32x32x16_bf16 v[128:143], v[64:67], v[208:211], v[128:143]
    ds_read_b64_tr_b16 v[80:81], v2 offset:0
    v_readlane_b32 s65, v13, 16
    s_lshl_b32 s66, s65, 10
    buffer_load_dwordx4 v[200:203], v6, s[16:19], s66 offen sc1
    v_mfma_f32_32x32x16_bf16 v[144:159], v[64:67], v[212:215], v[144:159]
    ds_read_b64_tr_b16 v[82:83], v2 offset:1024
    buffer_load_dwordx4 v[204:207], v7, s[16:19], s66 offen sc1
    v_mfma_f32_32x32x16_bf16 v[176:191], v[68:71], v[212:215], v[176:191]
    ds_read_b64_tr_b16 v[84:85], v3 offset:0
    v_readlane_b32 s63, v13, 19
    s_add_u32 m0, s62, 0x6000
    s_lshl_b32 s64, s63, 14
    buffer_load_dwordx4 v14, s[24:27], s64 offen lds
    v_mfma_f32_32x32x16_bf16 v[160:175], v[68:71], v[208:211], v[160:175]
    ds_read_b64_tr_b16 v[86:87], v3 offset:1024
    buffer_load_dwordx4 v15, s[24:27], s64 offen offset:1024 lds
    s_waitcnt vmcnt(14)
    v_mfma_f32_32x32x16_bf16 v[128:143], v[72:75], v[216:219], v[128:143]
    ds_read_b64_tr_b16 v[88:89], v2 offset:8192
    v_readlane_b32 s65, v13, 17
    s_lshl_b32 s66, s65, 10
    buffer_load_dwordx4 v[208:211], v6, s[16:19], s66 offen sc1
    v_mfma_f32_32x32x16_bf16 v[144:159], v[72:75], v[220:223], v[144:159]
    ds_read_b64_tr_b16 v[90:91], v2 offset:9216
    buffer_load_dwordx4 v[212:215], v7, s[16:19], s66 offen sc1
    v_mfma_f32_32x32x16_bf16 v[176:191], v[76:79], v[220:223], v[176:191]
    ds_read_b64_tr_b16 v[92:93], v3 offset:8192
    v_readlane_b32 s63, v13, 20
    s_add_u32 m0, s62, 0x8000
    s_lshl_b32 s64, s63, 14
    buffer_load_dwordx4 v14, s[24:27], s64 offen lds
    v_mfma_f32_32x32x16_bf16 v[160:175], v[76:79], v[216:219], v[160:175]
    ds_read_b64_tr_b16 v[94:95], v3 offset:9216
    buffer_load_dwordx4 v15, s[24:27], s64 offen offset:1024 lds
    s_waitcnt vmcnt(14)
    s_waitcnt lgkmcnt(6)
    v_mfma_f32_32x32x16_bf16 v[128:143], v[80:83], v[224:227], v[128:143]
    ds_read_b64_tr_b16 v[64:65], v4 offset:0
    v_readlane_b32 s65, v13, 18
    s_lshl_b32 s66, s65, 10
    buffer_load_dwordx4 v[216:219], v6, s[16:19], s66 offen sc1
    v_mfma_f32_32x32x16_bf16 v[144:159], v[80:83], v[228:231], v[144:159]
    ds_read_b64_tr_b16 v[66:67], v4 offset:1024
    buffer_load_dwordx4 v[220:223], v7, s[16:19], s66 offen sc1
    s_waitcnt lgkmcnt(6)
    v_mfma_f32_32x32x16_bf16 v[176:191], v[84:87], v[228:231], v[176:191]
    ds_read_b64_tr_b16 v[68:69], v5 offset:0
    v_readlane_b32 s63, v13, 21
    s_add_u32 m0, s62, 0xa000
    s_lshl_b32 s64, s63, 14
    buffer_load_dwordx4 v14, s[24:27], s64 offen lds
    v_mfma_f32_32x32x16_bf16 v[160:175], v[84:87], v[224:227], v[160:175]
    ds_read_b64_tr_b16 v[70:71], v5 offset:1024
    buffer_load_dwordx4 v15, s[24:27], s64 offen offset:1024 lds
    s_load_dwordx2 s[68:69], s[58:59], s67 offset:24 glc
    s_waitcnt vmcnt(14)
    s_waitcnt lgkmcnt(6)
    v_mfma_f32_32x32x16_bf16 v[128:143], v[88:91], v[192:195], v[128:143]
    ds_read_b64_tr_b16 v[72:73], v4 offset:8192
    v_readlane_b32 s65, v13, 19
    s_lshl_b32 s66, s65, 10
    buffer_load_dwordx4 v[224:227], v6, s[16:19], s66 offen sc1
    v_mfma_f32_32x32x16_bf16 v[144:159], v[88:91], v[196:199], v[144:159]
    ds_read_b64_tr_b16 v[74:75], v4 offset:9216
    buffer_load_dwordx4 v[228:231], v7, s[16:19], s66 offen sc1
    s_waitcnt lgkmcnt(6)
    v_mfma_f32_32x32x16_bf16 v[176:191], v[92:95], v[196:199], v[176:191]
    ds_read_b64_tr_b16 v[76:77], v5 offset:8192
    v_readlane_b32 s63, v13, 22
    s_add_u32 m0, s72, 0x0
    s_lshl_b32 s64, s63, 14
    buffer_load_dwordx4 v14, s[24:27], s64 offen lds
    v_mfma_f32_32x32x16_bf16 v[160:175], v[92:95], v[192:195], v[160:175]
    ds_read_b64_tr_b16 v[78:79], v5 offset:9216
    buffer_load_dwordx4 v15, s[24:27], s64 offen offset:1024 lds
    s_waitcnt vmcnt(14)
    s_waitcnt lgkmcnt(6)
    v_mfma_f32_32x32x16_bf16 v[128:143], v[64:67], v[200:203], v[128:143]
    ds_read_b64_tr_b16 v[80:81], v4 offset:16384
    v_readlane_b32 s65, v13, 20
    s_lshl_b32 s66, s65, 10
    buffer_load_dwordx4 v[192:195], v6, s[16:19], s66 offen sc1
    v_mfma_f32_32x32x16_bf16 v[144:159], v[64:67], v[204:207], v[144:159]
    ds_read_b64_tr_b16 v[82:83], v4 offset:17408
    buffer_load_dwordx4 v[196:199], v7, s[16:19], s66 offen sc1
    s_waitcnt lgkmcnt(6)
    v_mfma_f32_32x32x16_bf16 v[176:191], v[68:71], v[204:207], v[176:191]
    ds_read_b64_tr_b16 v[84:85], v5 offset:16384
    v_readlane_b32 s63, v13, 23
    s_add_u32 m0, s72, 0x2000
    s_lshl_b32 s64, s63, 14
    buffer_load_dwordx4 v14, s[24:27], s64 offen lds
    v_mfma_f32_32x32x16_bf16 v[160:175], v[68:71], v[200:203], v[160:175]
    ds_read_b64_tr_b16 v[86:87], v5 offset:17408
    buffer_load_dwordx4 v15, s[24:27], s64 offen offset:1024 lds
    s_waitcnt vmcnt(14)
    s_waitcnt lgkmcnt(6)
    v_mfma_f32_32x32x16_bf16 v[128:143], v[72:75], v[208:211], v[128:143]
    ds_read_b64_tr_b16 v[88:89], v4 offset:24576
    v_readlane_b32 s65, v13, 21
    s_lshl_b32 s66, s65, 10
    buffer_load_dwordx4 v[200:203], v6, s[16:19], s66 offen sc1
    v_mfma_f32_32x32x16_bf16 v[144:159], v[72:75], v[212:215], v[144:159]
    ds_read_b64_tr_b16 v[90:91], v4 offset:25600
    buffer_load_dwordx4 v[204:207], v7, s[16:19], s66 offen sc1
    s_waitcnt lgkmcnt(6)
    v_mfma_f32_32x32x16_bf16 v[176:191], v[76:79], v[212:215], v[176:191]
    ds_read_b64_tr_b16 v[92:93], v5 offset:24576
    v_readlane_b32 s63, v13, 24
    s_add_u32 m0, s62, 0x0
    s_lshl_b32 s64, s63, 14
    buffer_load_dwordx4 v14, s[24:27], s64 offen lds
    v_mfma_f32_32x32x16_bf16 v[160:175], v[76:79], v[208:211], v[160:175]
    ds_read_b64_tr_b16 v[94:95], v5 offset:25600
    buffer_load_dwordx4 v15, s[24:27], s64 offen offset:1024 lds
    s_waitcnt vmcnt(14)
    s_waitcnt lgkmcnt(6)
    v_mfma_f32_32x32x16_bf16 v[128:143], v[80:83], v[216:219], v[128:143]
    ds_read_b64_tr_b16 v[64:65], v4 offset:32768
    v_readlane_b32 s65, v13, 22
    s_lshl_b32 s66, s65, 10
    buffer_load_dwordx4 v[208:211], v6, s[16:19], s66 offen sc1
    v_mfma_f32_32x32x16_bf16 v[144:159], v[80:83], v[220:223], v[144:159]
    ds_read_b64_tr_b16 v[66:67], v4 offset:33792
    buffer_load_dwordx4 v[212:215], v7, s[16:19], s66 offen sc1
    s_waitcnt lgkmcnt(6)
    v_mfma_f32_32x32x16_bf16 v[176:191], v[84:87], v[220:223], v[176:191]
    ds_read_b64_tr_b16 v[68:69], v5 offset:32768
    v_readlane_b32 s63, v13, 25
    s_add_u32 m0, s62, 0x2000
    s_lshl_b32 s64, s63, 14
    buffer_load_dwordx4 v14, s[24:27], s64 offen lds
    v_mfma_f32_32x32x16_bf16 v[160:175], v[84:87], v[216:219], v[160:175]
    ds_read_b64_tr_b16 v[70:71], v5 offset:33792
    buffer_load_dwordx4 v15, s[24:27], s64 offen offset:1024 lds
    s_waitcnt vmcnt(14)
    s_waitcnt lgkmcnt(6)
    v_mfma_f32_32x32x16_bf16 v[128:143], v[88:91], v[224:227], v[128:143]
    ds_read_b64_tr_b16 v[72:73], v4 offset:40960
    v_readlane_b32 s65, v13, 23
    s_lshl_b32 s66, s65, 10
    buffer_load_dwordx4 v[216:219], v6, s[16:19], s66 offen sc1
    v_mfma_f32_32x32x16_bf16 v[144:159], v[88:91], v[228:231], v[144:159]
    ds_read_b64_tr_b16 v[74:75], v4 offset:41984
    buffer_load_dwordx4 v[220:223], v7, s[16:19], s66 offen sc1
    s_waitcnt lgkmcnt(6)
    v_mfma_f32_32x32x16_bf16 v[176:191], v[92:95], v[228:231], v[176:191]
    ds_read_b64_tr_b16 v[76:77], v5 offset:40960
    v_readlane_b32 s63, v13, 26
    s_add_u32 m0, s62, 0x4000
    s_lshl_b32 s64, s63, 14
    buffer_load_dwordx4 v14, s[24:27], s64 offen lds
    v_mfma_f32_32x32x16_bf16 v[160:175], v[92:95], v[224:227], v[160:175]
    ds_read_b64_tr_b16 v[78:79], v5 offset:41984
    buffer_load_dwordx4 v15, s[24:27], s64 offen offset:1024 lds
    s_waitcnt lgkmcnt(0)
    s_min_u32 s83, s68, s69
    s_cmp_ge_u32 s83, 1
    s_cbranch_scc1 L_f4a_done
    s_mov_b32 s84, 0x8000
L_f4a_spin:
    s_load_dwordx2 s[68:69], s[58:59], s67 offset:24 glc
    s_waitcnt lgkmcnt(0)
    s_min_u32 s83, s68, s69
    s_cmp_ge_u32 s83, 1
    s_cbranch_scc1 L_f4a_done
    s_sleep 2
    s_sub_u32 s84, s84, 1
    s_cbranch_scc0 L_f4a_spin
L_f4a_done:
    s_load_dwordx4 s[68:71], s[58:59], s67 offset:8 glc
    s_waitcnt vmcnt(14)
    v_mfma_f32_32x32x16_bf16 v[128:143], v[64:67], v[192:195], v[128:143]
    ds_read_b64_tr_b16 v[80:81], v2 offset:0
    v_readlane_b32 s65, v13, 24
    s_lshl_b32 s66, s65, 10
    buffer_load_dwordx4 v[224:227], v6, s[16:19], s66 offen sc1
    v_mfma_f32_32x32x16_bf16 v[144:159], v[64:67], v[196:199], v[144:159]
    ds_read_b64_tr_b16 v[82:83], v2 offset:1024
    buffer_load_dwordx4 v[228:231], v7, s[16:19], s66 offen sc1
    v_mfma_f32_32x32x16_bf16 v[176:191], v[68:71], v[196:199], v[176:191]
    ds_read_b64_tr_b16 v[84:85], v3 offset:0
    v_readlane_b32 s63, v13, 27
    s_add_u32 m0, s62, 0x6000
    s_lshl_b32 s64, s63, 14
    buffer_load_dwordx4 v14, s[24:27], s64 offen lds
    v_mfma_f32_32x32x16_bf16 v[160:175], v[68:71], v[192:195], v[160:175]
    ds_read_b64_tr_b16 v[86:87], v3 offset:1024
    buffer_load_dwordx4 v15, s[24:27], s64 offen offset:1024 lds
    s_waitcnt vmcnt(14)
    v_mfma_f32_32x32x16_bf16 v[128:143], v[72:75], v[200:203], v[128:143]
    ds_read_b64_tr_b16 v[88:89], v2 offset:8192
    v_readlane_b32 s65, v13, 25
    s_lshl_b32 s66, s65, 10
    buffer_load_dwordx4 v[192:195], v6, s[16:19], s66 offen sc1
    v_mfma_f32_32x32x16_bf16 v[144:159], v[72:75], v[204:207], v[144:159]
    ds_read_b64_tr_b16 v[90:91], v2 offset:9216
    buffer_load_dwordx4 v[196:199], v7, s[16:19], s66 offen sc1
    v_mfma_f32_32x32x16_bf16 v[176:191], v[76:79], v[204:207], v[176:191]
    ds_read_b64_tr_b16 v[92:93], v3 offset:8192
    v_readlane_b32 s63, v13, 28
    s_add_u32 m0, s62, 0x8000
    s_lshl_b32 s64, s63, 14
    buffer_load_dwordx4 v14, s[28:31], s64 offen lds
    v_mfma_f32_32x32x16_bf16 v[160:175], v[76:79], v[200:203], v[160:175]
    ds_read_b64_tr_b16 v[94:95], v3 offset:9216
    buffer_load_dwordx4 v15, s[28:31], s64 offen offset:1024 lds
    s_waitcnt vmcnt(14)
    s_waitcnt lgkmcnt(6)
    v_mfma_f32_32x32x16_bf16 v[128:143], v[80:83], v[208:211], v[128:143]
    ds_read_b64_tr_b16 v[64:65], v4 offset:0
    v_readlane_b32 s65, v13, 26
    s_lshl_b32 s66, s65, 10
    buffer_load_dwordx4 v[200:203], v6, s[16:19], s66 offen sc1
    v_mfma_f32_32x32x16_bf16 v[144:159], v[80:83], v[212:215], v[144:159]
    ds_read_b64_tr_b16 v[66:67], v4 offset:1024
    buffer_load_dwordx4 v[204:207], v7, s[16:19], s66 offen sc1
    s_waitcnt lgkmcnt(6)
    v_mfma_f32_32x32x16_bf16 v[176:191], v[84:87], v[212:215], v[176:191]
    ds_read_b64_tr_b16 v[68:69], v5 offset:0
    v_readlane_b32 s63, v13, 29
    s_add_u32 m0, s62, 0xa000
    s_lshl_b32 s64, s63, 14
    buffer_load_dwordx4 v14, s[28:31], s64 offen lds
    v_mfma_f32_32x32x16_bf16 v[160:175], v[84:87], v[208:211], v[160:175]
    ds_read_b64_tr_b16 v[70:71], v5 offset:1024
    buffer_load_dwordx4 v15, s[28:31], s64 offen offset:1024 lds
    s_waitcnt vmcnt(14)
    s_waitcnt lgkmcnt(6)
    v_mfma_f32_32x32x16_bf16 v[128:143], v[88:91], v[216:219], v[128:143]
    ds_read_b64_tr_b16 v[72:73], v4 offset:8192
    v_readlane_b32 s65, v13, 27
    s_lshl_b32 s66, s65, 10
    buffer_load_dwordx4 v[208:211], v6, s[16:19], s66 offen sc1
    v_mfma_f32_32x32x16_bf16 v[144:159], v[88:91], v[220:223], v[144:159]
    ds_read_b64_tr_b16 v[74:75], v4 offset:9216
    buffer_load_dwordx4 v[212:215], v7, s[16:19], s66 offen sc1
    s_waitcnt lgkmcnt(6)
    v_mfma_f32_32x32x16_bf16 v[176:191], v[92:95], v[220:223], v[176:191]
    ds_read_b64_tr_b16 v[76:77], v5 offset:8192
    v_readlane_b32 s63, v13, 30
    s_add_u32 m0, s72, 0x0
    s_lshl_b32 s64, s63, 14
    buffer_load_dwordx4 v14, s[28:31], s64 offen lds
    v_mfma_f32_32x32x16_bf16 v[160:175], v[92:95], v[216:219], v[160:175]
    ds_read_b64_tr_b16 v[78:79], v5 offset:9216
    buffer_load_dwordx4 v15, s[28:31], s64 offen offset:1024 lds
    s_waitcnt lgkmcnt(0)
    s_min_u32 s83, s68, s69
    s_min_u32 s83, s83, s70
    s_min_u32 s83, s83, s71
    s_cmp_ge_u32 s83, 1
    s_cbranch_scc1 L_f3a_done
    s_mov_b32 s84, 0x8000
L_f3a_spin:
    s_load_dwordx4 s[68:71], s[58:59], s67 offset:8 glc
    s_waitcnt lgkmcnt(0)
    s_min_u32 s83, s68, s69
    s_min_u32 s83, s83, s70
    s_min_u32 s83, s83, s71
    s_cmp_ge_u32 s83, 1
    s_cbranch_scc1 L_f3a_done
    s_sleep 2
    s_sub_u32 s84, s84, 1
    s_cbranch_scc0 L_f3a_spin
L_f3a_done:
    v_and_b32 v32, 31, v0
    v_lshlrev_b32 v32, 2, v32
    s_and_b32 s84, s81, 1
    s_lshl1_add_u32 s84, s97, s84
    s_lshl_b32 s84, s84, 8
    s_lshl_b32 s83, s81, 15
    s_add_u32 s83, s83, s84
    s_add_u32 s83, s83, 0x40000
    s_xor_b32 s84, s83, 0x100
    buffer_load_dword v244, v32, s[16:19], s83 offen offset:0 sc1
    buffer_load_dword v245, v32, s[16:19], s84 offen offset:0 sc1
    buffer_load_dword v246, v32, s[16:19], s83 offen offset:128 sc1
    buffer_load_dword v247, v32, s[16:19], s84 offen offset:128 sc1
    s_waitcnt vmcnt(18)
    v_mfma_f32_32x32x16_bf16 v[128:143], v[64:67], v[224:227], v[128:143]
    ds_read_b64_tr_b16 v[80:81], v4 offset:16384
    v_readlane_b32 s65, v13, 28
    s_lshl_b32 s66, s65, 10
    buffer_load_dwordx4 v[216:219], v6, s[16:19], s66 offen sc1
    v_mfma_f32_32x32x16_bf16 v[144:159], v[64:67], v[228:231], v[144:159]
    ds_read_b64_tr_b16 v[82:83], v4 offset:17408
    buffer_load_dwordx4 v[220:223], v7, s[16:19], s66 offen sc1
    v_mfma_f32_32x32x16_bf16 v[176:191], v[68:71], v[228:231], v[176:191]
    ds_read_b64_tr_b16 v[84:85], v5 offset:16384
    v_readlane_b32 s63, v13, 31
    s_add_u32 m0, s72, 0x2000
    s_lshl_b32 s64, s63, 14
    buffer_load_dwordx4 v14, s[28:31], s64 offen lds
    v_mfma_f32_32x32x16_bf16 v[160:175], v[68:71], v[224:227], v[160:175]
    ds_read_b64_tr_b16 v[86:87], v5 offset:17408
    buffer_load_dwordx4 v15, s[28:31], s64 offen offset:1024 lds
    s_waitcnt vmcnt(18)
    v_mfma_f32_32x32x16_bf16 v[128:143], v[72:75], v[192:195], v[128:143]
    ds_read_b64_tr_b16 v[88:89], v4 offset:24576
    v_readlane_b32 s65, v13, 29
    s_lshl_b32 s66, s65, 10
    buffer_load_dwordx4 v[224:227], v6, s[16:19], s66 offen sc1
    v_mfma_f32_32x32x16_bf16 v[144:159], v[72:75], v[196:199], v[144:159]
    ds_read_b64_tr_b16 v[90:91], v4 offset:25600
    buffer_load_dwordx4 v[228:231], v7, s[16:19], s66 offen sc1
    v_mfma_f32_32x32x16_bf16 v[176:191], v[76:79], v[196:199], v[176:191]
    ds_read_b64_tr_b16 v[92:93], v5 offset:24576
    v_readlane_b32 s63, v13, 32
    s_add_u32 m0, s62, 0x0
    s_lshl_b32 s64, s63, 14
    buffer_load_dwordx4 v14, s[28:31], s64 offen lds
    v_mfma_f32_32x32x16_bf16 v[160:175], v[76:79], v[192:195], v[160:175]
    ds_read_b64_tr_b16 v[94:95], v5 offset:25600
    buffer_load_dwordx4 v15, s[28:31], s64 offen offset:1024 lds
    s_waitcnt vmcnt(18)
    s_waitcnt lgkmcnt(6)
    v_mfma_f32_32x32x16_bf16 v[128:143], v[80:83], v[200:203], v[128:143]
    ds_read_b64_tr_b16 v[64:65], v4 offset:32768
    v_readlane_b32 s65, v13, 30
    s_lshl_b32 s66, s65, 10
    buffer_load_dwordx4 v[192:195], v6, s[16:19], s66 offen sc1
    v_mfma_f32_32x32x16_bf16 v[144:159], v[80:83], v[204:207], v[144:159]
    ds_read_b64_tr_b16 v[66:67], v4 offset:33792
    buffer_load_dwordx4 v[196:199], v7, s[16:19], s66 offen sc1
    s_waitcnt lgkmcnt(6)
    v_mfma_f32_32x32x16_bf16 v[176:191], v[84:87], v[204:207], v[176:191]
    ds_read_b64_tr_b16 v[68:69], v5 offset:32768
    v_readlane_b32 s63, v13, 33
    s_add_u32 m0, s62, 0x2000
    s_lshl_b32 s64, s63, 14
    buffer_load_dwordx4 v14, s[28:31], s64 offen lds
    v_mfma_f32_32x32x16_bf16 v[160:175], v[84:87], v[200:203], v[160:175]
    ds_read_b64_tr_b16 v[70:71], v5 offset:33792
    buffer_load_dwordx4 v15, s[28:31], s64 offen offset:1024 lds
    s_waitcnt vmcnt(18)
    s_waitcnt lgkmcnt(6)
    v_mfma_f32_32x32x16_bf16 v[128:143], v[88:91], v[208:211], v[128:143]
    ds_read_b64_tr_b16 v[72:73], v4 offset:40960
    v_readlane_b32 s65, v13, 31
    s_lshl_b32 s66, s65, 10
    buffer_load_dwordx4 v[200:203], v6, s[16:19], s66 offen sc1
    v_mfma_f32_32x32x16_bf16 v[144:159], v[88:91], v[212:215], v[144:159]
    ds_read_b64_tr_b16 v[74:75], v4 offset:41984
    buffer_load_dwordx4 v[204:207], v7, s[16:19], s66 offen sc1
    s_waitcnt lgkmcnt(6)
    v_mfma_f32_32x32x16_bf16 v[176:191], v[92:95], v[212:215], v[176:191]
    ds_read_b64_tr_b16 v[76:77], v5 offset:40960
    v_readlane_b32 s63, v13, 34
    s_add_u32 m0, s62, 0x4000
    s_lshl_b32 s64, s63, 14
    buffer_load_dwordx4 v14, s[28:31], s64 offen lds
    v_mfma_f32_32x32x16_bf16 v[160:175], v[92:95], v[208:211], v[160:175]
    ds_read_b64_tr_b16 v[78:79], v5 offset:41984
    buffer_load_dwordx4 v15, s[28:31], s64 offen offset:1024 lds
    s_waitcnt vmcnt(16)
    s_waitcnt vmcnt(14)
    s_waitcnt lgkmcnt(6)
    v_mfma_f32_32x32x16_bf16 v[16:31], v[64:67], v[216:219], 0
    ds_read_b64_tr_b16 v[80:81], v2 offset:0
    v_readlane_b32 s65, v13, 32
    s_lshl_b32 s66, s65, 10
    buffer_load_dwordx4 v[208:211], v6, s[16:19], s66 offen sc1
    v_mul_f32 v176, v245, v176
    v_mul_f32 v177, v245, v177
    v_mul_f32 v178, v245, v178
    v_mul_f32 v179, v245, v179
    v_mfma_f32_32x32x16_bf16 v[96:111], v[64:67], v[220:223], 0
    ds_read_b64_tr_b16 v[82:83], v2 offset:1024
    buffer_load_dwordx4 v[212:215], v7, s[16:19], s66 offen sc1
    v_mul_f32 v180, v245, v180
    v_mul_f32 v181, v245, v181
    v_mul_f32 v182, v245, v182
    v_mul_f32 v183, v245, v183
    s_waitcnt lgkmcnt(6)
    v_mfma_f32_32x32x16_bf16 v[48:63], v[68:71], v[220:223], 0
    ds_read_b64_tr_b16 v[84:85], v3 offset:0
    v_readlane_b32 s63, v13, 35
    s_add_u32 m0, s62, 0x6000
    s_lshl_b32 s64, s63, 14
    buffer_load_dwordx4 v14, s[28:31], s64 offen lds
    v_mul_f32 v184, v245, v184
    v_mul_f32 v185, v245, v185
    v_mul_f32 v186, v245, v186
    v_mul_f32 v187, v245, v187
    v_mfma_f32_32x32x16_bf16 v[112:127], v[68:71], v[216:219], 0
    ds_read_b64_tr_b16 v[86:87], v3 offset:1024
    buffer_load_dwordx4 v15, s[28:31], s64 offen offset:1024 lds
    v_mul_f32 v188, v245, v188
    v_mul_f32 v189, v245, v189
    v_mul_f32 v190, v245, v190
    v_mul_f32 v191, v245, v191
    s_waitcnt vmcnt(14)
    s_waitcnt lgkmcnt(6)
    v_mfma_f32_32x32x16_bf16 v[16:31], v[72:75], v[224:227], v[16:31]
    ds_read_b64_tr_b16 v[88:89], v2 offset:8192
    v_readlane_b32 s65, v13, 33
    s_lshl_b32 s66, s65, 10
    buffer_load_dwordx4 v[216:219], v6, s[16:19], s66 offen sc1
    v_mul_f32 v160, v244, v160
    v_mul_f32 v161, v244, v161
    v_mul_f32 v162, v244, v162
    v_mul_f32 v163, v244, v163
    v_mfma_f32_32x32x16_bf16 v[96:111], v[72:75], v[228:231], v[96:111]
    ds_read_b64_tr_b16 v[90:91], v2 offset:9216
    buffer_load_dwordx4 v[220:223], v7, s[16:19], s66 offen sc1
    v_mul_f32 v164, v244, v164
    v_mul_f32 v165, v244, v165
    v_mul_f32 v166, v244, v166
    v_mul_f32 v167, v244, v167
    s_waitcnt lgkmcnt(6)
    v_mfma_f32_32x32x16_bf16 v[48:63], v[76:79], v[228:231], v[48:63]
    ds_read_b64_tr_b16 v[92:93], v3 offset:8192
    v_mul_f32 v168, v244, v168
    v_mul_f32 v169, v244, v169
    v_mul_f32 v170, v244, v170
    v_mul_f32 v171, v244, v171
    v_mfma_f32_32x32x16_bf16 v[112:127], v[76:79], v[224:227], v[112:127]
    ds_read_b64_tr_b16 v[94:95], v3 offset:9216
    v_mul_f32 v172, v244, v172
    v_mul_f32 v173, v244, v173
    v_mul_f32 v174, v244, v174
    v_mul_f32 v175, v244, v175
    s_waitcnt vmcnt(12)
    s_waitcnt lgkmcnt(6)
    v_mfma_f32_32x32x16_bf16 v[16:31], v[80:83], v[192:195], v[16:31]
    ds_read_b64_tr_b16 v[64:65], v4 offset:0
    v_readlane_b32 s65, v13, 34
    s_lshl_b32 s66, s65, 10
    buffer_load_dwordx4 v[224:227], v6, s[16:19], s66 offen sc1
    v_mul_f32 v144, v245, v144
    v_mul_f32 v145, v245, v145
    v_mul_f32 v146, v245, v146
    v_mul_f32 v147, v245, v147
    v_mfma_f32_32x32x16_bf16 v[96:111], v[80:83], v[196:199], v[96:111]
    ds_read_b64_tr_b16 v[66:67], v4 offset:1024
    buffer_load_dwordx4 v[228:231], v7, s[16:19], s66 offen sc1
    v_mul_f32 v148, v245, v148
    v_mul_f32 v149, v245, v149
    v_mul_f32 v150, v245, v150
    v_mul_f32 v151, v245, v151
    s_waitcnt lgkmcnt(6)
    v_mfma_f32_32x32x16_bf16 v[48:63], v[84:87], v[196:199], v[48:63]
    ds_read_b64_tr_b16 v[68:69], v5 offset:0
    v_mul_f32 v152, v245, v152
    v_mul_f32 v153, v245, v153
    v_mul_f32 v154, v245, v154
    v_mul_f32 v155, v245, v155
    v_mfma_f32_32x32x16_bf16 v[112:127], v[84:87], v[192:195], v[112:127]
    ds_read_b64_tr_b16 v[70:71], v5 offset:1024
    v_mul_f32 v156, v245, v156
    v_mul_f32 v157, v245, v157
    v_mul_f32 v158, v245, v158
    v_mul_f32 v159, v245, v159
    s_waitcnt vmcnt(10)
    s_waitcnt lgkmcnt(6)
    v_mfma_f32_32x32x16_bf16 v[16:31], v[88:91], v[200:203], v[16:31]
    ds_read_b64_tr_b16 v[72:73], v4 offset:8192
    v_readlane_b32 s65, v13, 35
    s_lshl_b32 s66, s65, 10
    buffer_load_dwordx4 v[192:195], v6, s[16:19], s66 offen sc1
    v_mul_f32 v128, v244, v128
    v_mul_f32 v129, v244, v129
    v_mul_f32 v130, v244, v130
    v_mul_f32 v131, v244, v131
    v_mfma_f32_32x32x16_bf16 v[96:111], v[88:91], v[204:207], v[96:111]
    ds_read_b64_tr_b16 v[74:75], v4 offset:9216
    buffer_load_dwordx4 v[196:199], v7, s[16:19], s66 offen sc1
    v_mul_f32 v132, v244, v132
    v_mul_f32 v133, v244, v133
    v_mul_f32 v134, v244, v134
    v_mul_f32 v135, v244, v135
    s_waitcnt lgkmcnt(6)
    v_mfma_f32_32x32x16_bf16 v[48:63], v[92:95], v[204:207], v[48:63]
    ds_read_b64_tr_b16 v[76:77], v5 offset:8192
    v_mul_f32 v136, v244, v136
    v_mul_f32 v137, v244, v137
    v_mul_f32 v138, v244, v138
    v_mul_f32 v139, v244, v139
    v_mfma_f32_32x32x16_bf16 v[112:127], v[92:95], v[200:203], v[112:127]
    ds_read_b64_tr_b16 v[78:79], v5 offset:9216
    v_mul_f32 v140, v244, v140
    v_mul_f32 v141, v244, v141
    v_mul_f32 v142, v244, v142
    v_mul_f32 v143, v244, v143
    v_mov_b32 v34, 0x24c0c
    ds_read_b32 v35, v34
    s_waitcnt vmcnt(8)
    s_waitcnt lgkmcnt(7)
    v_mfma_f32_32x32x16_bf16 v[16:31], v[64:67], v[208:211], v[16:31]
    ds_read_b64_tr_b16 v[80:81], v4 offset:16384
    v_mfma_f32_32x32x16_bf16 v[96:111], v[64:67], v[212:215], v[96:111]
    ds_read_b64_tr_b16 v[82:83], v4 offset:17408
    s_waitcnt lgkmcnt(7)
    v_mfma_f32_32x32x16_bf16 v[48:63], v[68:71], v[212:215], v[48:63]
    ds_read_b64_tr_b16 v[84:85], v5 offset:16384
    v_mfma_f32_32x32x16_bf16 v[112:127], v[68:71], v[208:211], v[112:127]
    ds_read_b64_tr_b16 v[86:87], v5 offset:17408
    s_waitcnt vmcnt(4)
    s_waitcnt lgkmcnt(7)
    v_mfma_f32_32x32x16_bf16 v[16:31], v[72:75], v[216:219], v[16:31]
    ds_read_b64_tr_b16 v[88:89], v4 offset:24576
    v_mfma_f32_32x32x16_bf16 v[96:111], v[72:75], v[220:223], v[96:111]
    ds_read_b64_tr_b16 v[90:91], v4 offset:25600
    s_waitcnt lgkmcnt(7)
    v_mfma_f32_32x32x16_bf16 v[48:63], v[76:79], v[220:223], v[48:63]
    ds_read_b64_tr_b16 v[92:93], v5 offset:24576
    v_mfma_f32_32x32x16_bf16 v[112:127], v[76:79], v[216:219], v[112:127]
    ds_read_b64_tr_b16 v[94:95], v5 offset:25600
    s_waitcnt lgkmcnt(8)
    v_readfirstlane_b32 s83, v35
    s_cmp_ge_u32 s83, 8
    s_cbranch_scc1 L_qda_done
    v_mov_b32 v34, 0x24c0c
    s_mov_b32 s84, 0x80000
L_qda_spin:
    ds_read_b32 v35, v34
    s_waitcnt lgkmcnt(0)
    v_readfirstlane_b32 s83, v35
    s_cmp_ge_u32 s83, 8
    s_cbranch_scc1 L_qda_done
    s_sub_u32 s84, s84, 1
    s_cbranch_scc0 L_qda_spin
L_qda_done:
    s_xor_b32 s83, s81, 1
    s_mul_i32 s83, s83, 0x3000
    s_add_u32 s83, s83, s73
    s_add_u32 s83, s83, 0x0
    v_add_u32 v37, s83, v11
    s_xor_b32 s83, s81, 2
    s_mul_i32 s83, s83, 0x3000
    s_add_u32 s83, s83, s73
    s_add_u32 s83, s83, 0x1000
    v_add_u32 v38, s83, v11
    s_xor_b32 s83, s81, 3
    s_mul_i32 s83, s83, 0x3000
    s_add_u32 s83, s83, s73
    s_add_u32 s83, s83, 0x2000
    v_add_u32 v39, s83, v11
    s_mul_i32 s83, s81, 0x3000
    s_add_u32 s83, s83, s73
    v_add_u32 v36, s83, v11
    s_waitcnt vmcnt(2) lgkmcnt(4)
    v_mfma_f32_32x32x16_bf16 v[48:63], v[84:87], v[228:231], v[48:63]
    s_waitcnt vmcnt(0) lgkmcnt(0)
    v_mfma_f32_32x32x16_bf16 v[48:63], v[92:95], v[196:199], v[48:63]
    v_mfma_f32_32x32x16_bf16 v[112:127], v[84:87], v[224:227], v[112:127]
    s_mov_b32 s32, s54
    s_mov_b32 s33, s55
    s_mov_b32 s34, 0x200000
    s_mov_b32 s35, 0x20000
    v_and_b32 v32, 31, v0
    v_lshrrev_b32 v33, 5, v0
    v_lshlrev_b32 v32, 10, v32
    v_mfma_f32_32x32x16_bf16 v[112:127], v[92:95], v[192:195], v[112:127]
    v_lshl_add_u32 v32, v33, 4, v32
    s_and_b32 s84, s81, 1
    s_lshl1_add_u32 s83, s97, s84
    s_lshl_b32 s83, s83, 15
    s_lshr_b32 s84, s81, 1
    s_lshl1_add_u32 s84, s98, s84
    s_lshl_b32 s84, s84, 6
    s_add_u32 s83, s83, s84
    v_fmac_f32 v176, v247, v48
    v_fmac_f32 v177, v247, v49
    v_fmac_f32 v178, v247, v50
    v_fmac_f32 v179, v247, v51
    ds_write_b128 v39, v[176:179] offset:0
    v_fmac_f32 v180, v247, v52
    v_fmac_f32 v181, v247, v53
    v_fmac_f32 v182, v247, v54
    v_fmac_f32 v183, v247, v55
    ds_write_b128 v39, v[180:183] offset:1024
    v_fmac_f32 v184, v247, v56
    v_fmac_f32 v185, v247, v57
    v_fmac_f32 v186, v247, v58
    v_fmac_f32 v187, v247, v59
    ds_write_b128 v39, v[184:187] offset:2048
    v_fmac_f32 v188, v247, v60
    v_fmac_f32 v189, v247, v61
    v_fmac_f32 v190, v247, v62
    v_fmac_f32 v191, v247, v63
    ds_write_b128 v39, v[188:191] offset:3072
    v_mfma_f32_32x32x16_bf16 v[96:111], v[80:83], v[228:231], v[96:111]
    v_mfma_f32_32x32x16_bf16 v[96:111], v[88:91], v[196:199], v[96:111]
    v_mfma_f32_32x32x16_bf16 v[16:31], v[80:83], v[224:227], v[16:31]
    v_fmac_f32 v160, v246, v112
    v_fmac_f32 v161, v246, v113
    v_fmac_f32 v162, v246, v114
    v_fmac_f32 v163, v246, v115
    ds_write_b128 v38, v[160:163] offset:0
    v_fmac_f32 v164, v246, v116
    v_fmac_f32 v165, v246, v117
    v_fmac_f32 v166, v246, v118
    v_fmac_f32 v167, v246, v119
    ds_write_b128 v38, v[164:167] offset:1024
    v_fmac_f32 v168, v246, v120
    v_fmac_f32 v169, v246, v121
    v_fmac_f32 v170, v246, v122
    v_fmac_f32 v171, v246, v123
    ds_write_b128 v38, v[168:171] offset:2048
    v_fmac_f32 v172, v246, v124
    v_fmac_f32 v173, v246, v125
    v_fmac_f32 v174, v246, v126
    v_fmac_f32 v175, v246, v127
    ds_write_b128 v38, v[172:175] offset:3072
    v_mfma_f32_32x32x16_bf16 v[16:31], v[88:91], v[192:195], v[16:31]
    v_fmac_f32 v144, v247, v96
    v_fmac_f32 v145, v247, v97
    v_fmac_f32 v146, v247, v98
    v_fmac_f32 v147, v247, v99
    ds_write_b128 v37, v[144:147] offset:0
    v_fmac_f32 v148, v247, v100
    v_fmac_f32 v149, v247, v101
    v_fmac_f32 v150, v247, v102
    v_fmac_f32 v151, v247, v103
    ds_write_b128 v37, v[148:151] offset:1024
    v_fmac_f32 v152, v247, v104
    v_fmac_f32 v153, v247, v105
    v_fmac_f32 v154, v247, v106
    v_fmac_f32 v155, v247, v107
    ds_write_b128 v37, v[152:155] offset:2048
    v_fmac_f32 v156, v247, v108
    v_fmac_f32 v157, v247, v109
    v_fmac_f32 v158, v247, v110
    v_fmac_f32 v159, v247, v111
    ds_write_b128 v37, v[156:159] offset:3072
    v_fmac_f32 v128, v246, v16
    v_fmac_f32 v129, v246, v17
    v_fmac_f32 v130, v246, v18
    v_fmac_f32 v131, v246, v19
    v_fmac_f32 v132, v246, v20
    v_fmac_f32 v133, v246, v21
    v_fmac_f32 v134, v246, v22
    v_fmac_f32 v135, v246, v23
    v_fmac_f32 v136, v246, v24
    v_fmac_f32 v137, v246, v25
    v_fmac_f32 v138, v246, v26
    v_fmac_f32 v139, v246, v27
    v_fmac_f32 v140, v246, v28
    v_fmac_f32 v141, v246, v29
    v_fmac_f32 v142, v246, v30
    v_fmac_f32 v143, v246, v31
    s_waitcnt lgkmcnt(0)
    s_barrier
    ds_read_b128 v[192:195], v36 offset:0
    ds_read_b128 v[208:211], v36 offset:4096
    ds_read_b128 v[224:227], v36 offset:8192
    ds_read_b128 v[196:199], v36 offset:1024
    ds_read_b128 v[212:215], v36 offset:5120
    ds_read_b128 v[228:231], v36 offset:9216
    ds_read_b128 v[200:203], v36 offset:2048
    ds_read_b128 v[216:219], v36 offset:6144
    ds_read_b128 v[232:235], v36 offset:10240
    ds_read_b128 v[204:207], v36 offset:3072
    ds_read_b128 v[220:223], v36 offset:7168
    ds_read_b128 v[236:239], v36 offset:11264
    s_waitcnt lgkmcnt(11)
    v_pk_add_f32 v[128:129], v[128:129], v[192:193]
    v_pk_add_f32 v[130:131], v[130:131], v[194:195]
    s_waitcnt lgkmcnt(9)
    v_pk_add_f32 v[208:209], v[208:209], v[224:225]
    v_pk_add_f32 v[210:211], v[210:211], v[226:227]
    v_pk_add_f32 v[128:129], v[128:129], v[208:209]
    v_pk_add_f32 v[130:131], v[130:131], v[210:211]
    v_cvt_pk_bf16_f32 v144, v128, v129
    v_cvt_pk_bf16_f32 v145, v130, v131
    s_waitcnt lgkmcnt(8)
    v_pk_add_f32 v[132:133], v[132:133], v[196:197]
    v_pk_add_f32 v[134:135], v[134:135], v[198:199]
    s_waitcnt lgkmcnt(6)
    v_pk_add_f32 v[212:213], v[212:213], v[228:229]
    v_pk_add_f32 v[214:215], v[214:215], v[230:231]
    v_pk_add_f32 v[132:133], v[132:133], v[212:213]
    v_pk_add_f32 v[134:135], v[134:135], v[214:215]
    v_cvt_pk_bf16_f32 v146, v132, v133
    v_cvt_pk_bf16_f32 v147, v134, v135
    s_nop 0
    v_permlane32_swap_b32 v144, v146
    v_permlane32_swap_b32 v145, v147
    buffer_store_dwordx4 v[144:147], v32, s[32:35], s83 offen offset:0
    s_waitcnt lgkmcnt(5)
    v_pk_add_f32 v[136:137], v[136:137], v[200:201]
    v_pk_add_f32 v[138:139], v[138:139], v[202:203]
    s_waitcnt lgkmcnt(3)
    v_pk_add_f32 v[216:217], v[216:217], v[232:233]
    v_pk_add_f32 v[218:219], v[218:219], v[234:235]
    v_pk_add_f32 v[136:137], v[136:137], v[216:217]
    v_pk_add_f32 v[138:139], v[138:139], v[218:219]
    v_cvt_pk_bf16_f32 v148, v136, v137
    v_cvt_pk_bf16_f32 v149, v138, v139
    s_waitcnt lgkmcnt(2)
    v_pk_add_f32 v[140:141], v[140:141], v[204:205]
    v_pk_add_f32 v[142:143], v[142:143], v[206:207]
    s_waitcnt lgkmcnt(0)
    v_pk_add_f32 v[220:221], v[220:221], v[236:237]
    v_pk_add_f32 v[222:223], v[222:223], v[238:239]
    v_pk_add_f32 v[140:141], v[140:141], v[220:221]
    v_pk_add_f32 v[142:143], v[142:143], v[222:223]
    v_cvt_pk_bf16_f32 v150, v140, v141
    v_cvt_pk_bf16_f32 v151, v142, v143
    s_nop 0
    v_permlane32_swap_b32 v148, v150
    v_permlane32_swap_b32 v149, v151
    buffer_store_dwordx4 v[148:151], v32, s[32:35], s83 offen offset:32
    s_branch L_fin
L_mlp:
    s_lshl3_add_u32 s83, s84, s80
    s_lshl_b32 s83, s83, 6
    s_add_u32 s83, s83, 0x24400
    v_lshl_add_u32 v24, v33, 1, s83
    s_lshl_b32 s83, s84, 6
    s_add_u32 s83, s83, 0x24580
    v_lshl_add_u32 v25, v33, 1, s83
    v_sub_u32 v20, 1, v32
    v_mul_u32_u24 v20, 0x3f80, v20
    v_mov_b32 v21, 0
    v_mov_b32 v22, 0
    v_mov_b32 v23, 0
    s_add_u32 s83, s7, 4
    s_and_b32 s83, s83, 7
    s_mul_i32 s74, s83, s82
    s_lshl_b32 s83, s83, 7
    s_add_u32 s66, s83, s99
    v_and_b32 v76, 16, v11
    v_add_u32 v76, 0x24c00, v76
    ds_write_b128 v76, v[16:19]
    s_add_u32 s83, s7, 5
    s_and_b32 s83, s83, 7
    s_mul_i32 s75, s83, s82
    s_lshl_b32 s83, s83, 7
    s_add_u32 s67, s83, s99
    s_add_u32 s83, s7, 6
    s_and_b32 s83, s83, 7
    s_mul_i32 s76, s83, s82
    s_lshl_b32 s83, s83, 7
    s_add_u32 s68, s83, s99
    s_mov_b32 s89, 0x80
    s_mov_b32 s90, 0x80
    v_add_u32 v9, 0x14000, v8
    v_add_u32 v12, 0x10000, v8
    s_mov_b32 s87, 0x3fb8aa3b
    s_add_u32 s83, s7, 7
    s_and_b32 s83, s83, 7
    s_mul_i32 s77, s83, s82
    s_lshl_b32 s83, s83, 7
    s_add_u32 s69, s83, s99
    s_bfe_u32 s98, s2, 0x30004
    s_add_u32 s83, s98, s4
    s_and_b32 s83, s83, 1
    s_bfe_u32 s84, s2, 0x10003
    s_lshl1_add_u32 s83, s84, s83
    s_and_b32 s97, s2, 7
    s_lshl2_add_u32 s97, s97, s83
    s_mov_b32 s20, s56
    s_mov_b32 s21, s57
    s_mov_b32 s22, 4
    s_mov_b32 s23, 0x20000
    s_mov_b32 s24, s50
    s_mov_b32 s25, s51
    s_mov_b32 s26, 0x1c0000
    s_mov_b32 s27, 0x20000
    s_sub_u32 s28, s42, 0x1c0000
    s_subb_u32 s29, s43, 0
    s_mov_b32 s30, 0x240000
    s_mov_b32 s31, 0x20000
    s_and_b32 s84, s6, 1
    s_lshl_b32 s85, s91, 12
    s_add_u32 s85, s85, 0x100000
    s_lshl_b32 s86, s84, 11
    s_add_u32 s86, s86, s85
    s_add_u32 s95, s86, 0x3000
    s_lshl3_add_u32 s84, s84, s80
    s_lshl_b32 s84, s84, 11
    s_add_u32 s92, s84, s85
    s_add_u32 s93, s92, 0x1000
    s_add_u32 s94, s92, 0x2000
    v_lshrrev_b32 v72, 3, v0
    v_bfe_u32 v73, v0, 4, 1
    v_lshlrev_b32 v73, 2, v73
    v_and_b32 v14, 7, v0
    v_xor_b32 v14, v14, v73
    v_lshlrev_b32 v14, 4, v14
    v_lshl_add_u32 v14, v72, 10, v14
    s_lshl_b32 s83, s98, 7
    v_add_u32 v14, s83, v14
    v_add_u32 v15, 0x1c00, v14
    s_lshl_b32 s62, s81, 11
    s_and_b32 s83, s97, 3
    s_lshl1_add_u32 s83, s83, s98
    s_and_b32 s83, s83, 7
    v_add_u32 v72, s83, v0
    v_and_b32 v72, 7, v72
    v_lshrrev_b32 v73, 2, v72
    v_mad_u32_u24 v72, v73, 12, v72
    v_lshrrev_b32 v73, 3, v0
    v_lshl_add_u32 v13, v73, 2, v72
    v_add_u32 v72, s83, v0
    v_and_b32 v72, 3, v72
    v_add_u32 v72, 12, v72
    v_cmp_gt_u32 vcc, 24, v0
    s_mul_i32 s84, s81, 28
    s_nop 0
    v_cndmask_b32 v13, v72, v13, vcc
    v_add_u32 v13, s84, v13
    s_add_u32 s83, s83, 4
    v_add_u32 v72, s83, v0
    v_and_b32 v72, 7, v72
    s_lshl3_add_u32 s84, s81, 0x70
    v_add_u32 v72, s84, v72
    v_cmp_gt_u32 vcc, 28, v0
    s_nop 1
    v_cndmask_b32 v13, v72, v13, vcc
    s_lshr_b32 s83, s6, 1
    s_mul_i32 s83, s83, 0x380
    s_and_b32 s84, s6, 1
    s_lshl_b32 s84, s84, 6
    s_add_u32 s83, s83, s84
    s_mul_i32 s84, s81, 0xe000
    s_add_u32 s83, s83, s84
    s_add_u32 s83, s83, 0x180
    v_lshrrev_b32 v72, 2, v0
    v_mul_u32_u24 v72, 0xe00, v72
    v_and_b32 v27, 3, v0
    v_lshl_add_u32 v27, v27, 4, v72
    v_add_u32 v27, s83, v27
    s_lshl_b32 s91, s81, 10
    s_add_u32 m0, s78, 0x4000
    s_nop 0
    buffer_load_dwordx4 v1, s[8:11], s63 offen lds
    buffer_load_dwordx4 v2, s[8:11], s63 offen offset:1024 lds
    s_cmp_eq_u32 s4, 0
    s_movk_i32 s83, 0x80
    s_cmov_b32 s83, 0x400
    s_add_u32 s83, s83, s70
    s_add_u32 m0, s79, 0x10000
    s_nop 0
    buffer_load_dwordx4 v3, s[12:15], s83 offen lds
    s_add_u32 s83, s7, 2
    s_and_b32 s83, s83, 7
    s_mul_i32 s72, s83, s82
    s_lshl_b32 s83, s83, 7
    s_add_u32 s64, s83, s99
    s_add_u32 m0, s78, 0x8000
    s_nop 0
    buffer_load_dwordx4 v1, s[8:11], s64 offen lds
    buffer_load_dwordx4 v2, s[8:11], s64 offen offset:1024 lds
    s_add_u32 m0, s79, 0x4000
    s_nop 0
    buffer_load_dwordx4 v3, s[12:15], s72 offen lds
    s_waitcnt vmcnt(7)
    s_barrier
    ds_read_b128 v[128:131], v4 offset:0
    ds_read_b128 v[132:135], v5 offset:0
    ds_read_b128 v[136:139], v6 offset:0
    ds_read_b128 v[140:143], v7 offset:0
    ds_read_u16 v16, v24
    ds_read_u16 v28, v24 offset:128
    ds_read_u16 v29, v24 offset:256
    ds_read_u16 v30, v25
    ds_read_b64_tr_b16 v[80:81], v8 offset:0
    ds_read_b64_tr_b16 v[82:83], v8 offset:512
    ds_read_b64_tr_b16 v[84:85], v8 offset:2048
    ds_read_b64_tr_b16 v[86:87], v8 offset:2560
    ds_read_b64_tr_b16 v[88:89], v8 offset:4096
    s_waitcnt lgkmcnt(11)
    ds_read_b64_tr_b16 v[90:91], v8 offset:4608
    s_add_u32 m0, s78, 0xc000
    s_nop 0
    buffer_load_dwordx4 v1, s[8:11], s65 offen lds
    buffer_load_dwordx4 v2, s[8:11], s65 offen offset:1024 lds
    s_waitcnt lgkmcnt(6)
    v_mfma_f32_32x32x16_bf16 v[96:111], v[16:19], v[20:23], 0
    ds_read_b64_tr_b16 v[92:93], v8 offset:6144
    ds_read_b64_tr_b16 v[94:95], v8 offset:6656
    s_waitcnt lgkmcnt(6)
    v_mfma_f32_32x32x16_bf16 v[96:111], v[80:83], v[128:131], v[96:111]
    s_add_u32 m0, s79, 0x6000
    s_nop 0
    buffer_load_dwordx4 v3, s[12:15], s73 offen lds
    s_waitcnt vmcnt(7)
    s_barrier
    s_or_b32 s83, s61, s3
    s_cbranch_scc1 L_nosig0
    s_mov_b32 s60, 1
    s_atomic_add s60, s[56:57], 0
L_nosig0:
    ds_read_b128 v[144:147], v4 offset:16384
    ds_read_b128 v[148:151], v5 offset:16384
    ds_read_b128 v[152:155], v6 offset:16384
    ds_read_b128 v[156:159], v7 offset:16384
    ds_read_b64_tr_b16 v[80:81], v8 offset:8192
    ds_read_b64_tr_b16 v[82:83], v8 offset:8704
    s_waitcnt lgkmcnt(10)
    v_mfma_f32_32x32x16_bf16 v[96:111], v[84:87], v[132:135], v[96:111]
    s_add_u32 m0, s78, 0x0
    s_nop 0
    buffer_load_dwordx4 v1, s[8:11], s66 offen lds
    buffer_load_dwordx4 v2, s[8:11], s66 offen offset:1024 lds
    ds_read_b64_tr_b16 v[84:85], v8 offset:10240
    ds_read_b64_tr_b16 v[86:87], v8 offset:10752
    s_waitcnt lgkmcnt(10)
    v_mfma_f32_32x32x16_bf16 v[96:111], v[88:91], v[136:139], v[96:111]
    s_add_u32 m0, s79, 0x8000
    s_nop 0
    buffer_load_dwordx4 v3, s[12:15], s74 offen lds
    ds_read_b64_tr_b16 v[88:89], v8 offset:12288
    ds_read_b64_tr_b16 v[90:91], v8 offset:12800
    s_waitcnt lgkmcnt(10)
    v_mfma_f32_32x32x16_bf16 v[96:111], v[92:95], v[140:143], v[96:111]
    ds_read_b64_tr_b16 v[92:93], v8 offset:14336
    ds_read_b64_tr_b16 v[94:95], v8 offset:14848
    s_waitcnt lgkmcnt(6)
    v_mfma_f32_32x32x16_bf16 v[96:111], v[80:83], v[144:147], v[96:111]
    s_waitcnt vmcnt(6)
    s_barrier
    ds_read_b128 v[160:163], v4 offset:32768
    ds_read_b128 v[164:167], v5 offset:32768
    ds_read_b128 v[168:171], v6 offset:32768
    ds_read_b128 v[172:175], v7 offset:32768
    ds_read_b64_tr_b16 v[80:81], v8 offset:16384
    ds_read_b64_tr_b16 v[82:83], v8 offset:16896
    s_waitcnt lgkmcnt(10)
    v_mfma_f32_32x32x16_bf16 v[96:111], v[84:87], v[148:151], v[96:111]
    s_add_u32 m0, s78, 0x4000
    s_nop 0
    buffer_load_dwordx4 v1, s[8:11], s67 offen lds
    buffer_load_dwordx4 v2, s[8:11], s67 offen offset:1024 lds
    ds_read_b64_tr_b16 v[84:85], v8 offset:18432
    ds_read_b64_tr_b16 v[86:87], v8 offset:18944
    s_waitcnt lgkmcnt(10)
    v_mfma_f32_32x32x16_bf16 v[96:111], v[88:91], v[152:155], v[96:111]
    s_add_u32 m0, s79, 0xa000
    s_nop 0
    buffer_load_dwordx4 v3, s[12:15], s75 offen lds
    ds_read_b64_tr_b16 v[88:89], v8 offset:20480
    ds_read_b64_tr_b16 v[90:91], v8 offset:20992
    s_waitcnt lgkmcnt(10)
    v_mfma_f32_32x32x16_bf16 v[96:111], v[92:95], v[156:159], v[96:111]
    ds_read_b64_tr_b16 v[92:93], v8 offset:22528
    ds_read_b64_tr_b16 v[94:95], v8 offset:23040
    s_waitcnt lgkmcnt(6)
    v_mfma_f32_32x32x16_bf16 v[96:111], v[80:83], v[160:163], v[96:111]
    s_waitcnt vmcnt(6)
    s_barrier
    ds_read_b128 v[176:179], v4 offset:49152
    ds_read_b128 v[180:183], v5 offset:49152
    ds_read_b128 v[184:187], v6 offset:49152
    ds_read_b128 v[188:191], v7 offset:49152
    ds_read_b64_tr_b16 v[80:81], v8 offset:24576
    ds_read_b64_tr_b16 v[82:83], v8 offset:25088
    s_waitcnt lgkmcnt(10)
    v_mfma_f32_32x32x16_bf16 v[96:111], v[84:87], v[164:167], v[96:111]
    s_add_u32 m0, s78, 0x8000
    s_nop 0
    buffer_load_dwordx4 v1, s[8:11], s68 offen lds
    buffer_load_dwordx4 v2, s[8:11], s68 offen offset:1024 lds
    ds_read_b64_tr_b16 v[84:85], v8 offset:26624
    ds_read_b64_tr_b16 v[86:87], v8 offset:27136
    s_waitcnt lgkmcnt(10)
    v_mfma_f32_32x32x16_bf16 v[96:111], v[88:91], v[168:171], v[96:111]
    s_add_u32 m0, s79, 0xc000
    s_nop 0
    buffer_load_dwordx4 v3, s[12:15], s76 offen lds
    ds_read_b64_tr_b16 v[88:89], v8 offset:28672
    ds_read_b64_tr_b16 v[90:91], v8 offset:29184
    s_waitcnt lgkmcnt(10)
    v_mfma_f32_32x32x16_bf16 v[96:111], v[92:95], v[172:175], v[96:111]
    ds_read_b64_tr_b16 v[92:93], v8 offset:30720
    ds_read_b64_tr_b16 v[94:95], v8 offset:31232
    s_waitcnt lgkmcnt(6)
    v_mfma_f32_32x32x16_bf16 v[96:111], v[80:83], v[176:179], v[96:111]
    s_waitcnt vmcnt(6)
    s_barrier
    ds_read_b128 v[192:195], v4 offset:0
    ds_read_b128 v[196:199], v5 offset:0
    ds_read_b128 v[200:203], v6 offset:0
    ds_read_b128 v[204:207], v7 offset:0
    ds_read_b64_tr_b16 v[80:81], v8 offset:32768
    ds_read_b64_tr_b16 v[82:83], v8 offset:33280
    s_waitcnt lgkmcnt(10)
    v_mfma_f32_32x32x16_bf16 v[96:111], v[84:87], v[180:183], v[96:111]
    s_add_u32 m0, s78, 0xc000
    s_nop 0
    buffer_load_dwordx4 v1, s[8:11], s69 offen lds
    buffer_load_dwordx4 v2, s[8:11], s69 offen offset:1024 lds
    ds_read_b64_tr_b16 v[84:85], v8 offset:34816
    ds_read_b64_tr_b16 v[86:87], v8 offset:35328
    s_waitcnt lgkmcnt(10)
    v_mfma_f32_32x32x16_bf16 v[96:111], v[88:91], v[184:187], v[96:111]
    s_add_u32 m0, s79, 0xe000
    s_nop 0
    buffer_load_dwordx4 v3, s[12:15], s77 offen lds
    ds_read_b64_tr_b16 v[88:89], v8 offset:36864
    ds_read_b64_tr_b16 v[90:91], v8 offset:37376
    s_waitcnt lgkmcnt(10)
    v_mfma_f32_32x32x16_bf16 v[96:111], v[92:95], v[188:191], v[96:111]
    ds_read_b64_tr_b16 v[92:93], v8 offset:38912
    ds_read_b64_tr_b16 v[94:95], v8 offset:39424
    s_waitcnt lgkmcnt(6)
    v_mfma_f32_32x32x16_bf16 v[96:111], v[80:83], v[192:195], v[96:111]
    s_waitcnt vmcnt(6)
    s_barrier
    ds_read_b128 v[208:211], v4 offset:16384
    ds_read_b128 v[212:215], v5 offset:16384
    ds_read_b128 v[216:219], v6 offset:16384
    ds_read_b128 v[220:223], v7 offset:16384
    ds_read_b64_tr_b16 v[80:81], v8 offset:40960
    ds_read_b64_tr_b16 v[82:83], v8 offset:41472
    s_waitcnt lgkmcnt(10)
    v_mfma_f32_32x32x16_bf16 v[96:111], v[84:87], v[196:199], v[96:111]
    v_add_u32 v3, s89, v3
    s_add_u32 m0, s79, 0x12000
    s_nop 0
    buffer_load_dwordx4 v3, s[12:15], s71 offen lds
    ds_read_b64_tr_b16 v[84:85], v8 offset:43008
    ds_read_b64_tr_b16 v[86:87], v8 offset:43520
    s_waitcnt lgkmcnt(10)
    v_mfma_f32_32x32x16_bf16 v[96:111], v[88:91], v[200:203], v[96:111]
    s_add_u32 m0, s79, 0x0
    s_nop 0
    buffer_load_dwordx4 v3, s[12:15], s72 offen lds
    ds_read_b64_tr_b16 v[88:89], v8 offset:45056
    ds_read_b64_tr_b16 v[90:91], v8 offset:45568
    s_waitcnt lgkmcnt(10)
    v_mfma_f32_32x32x16_bf16 v[96:111], v[92:95], v[204:207], v[96:111]
    s_add_u32 m0, s79, 0x2000
    s_nop 0
    buffer_load_dwordx4 v3, s[12:15], s73 offen lds
    ds_read_b64_tr_b16 v[92:93], v8 offset:47104
    ds_read_b64_tr_b16 v[94:95], v8 offset:47616
    s_waitcnt lgkmcnt(6)
    v_mfma_f32_32x32x16_bf16 v[96:111], v[80:83], v[208:211], v[96:111]
    s_waitcnt vmcnt(6)
    s_barrier
    ds_read_b128 v[224:227], v4 offset:32768
    ds_read_b128 v[228:231], v5 offset:32768
    ds_read_b128 v[232:235], v6 offset:32768
    ds_read_b128 v[236:239], v7 offset:32768
    ds_read_b64_tr_b16 v[80:81], v8 offset:49152
    ds_read_b64_tr_b16 v[82:83], v8 offset:49664
    s_waitcnt lgkmcnt(10)
    v_mfma_f32_32x32x16_bf16 v[96:111], v[84:87], v[212:215], v[96:111]
    s_add_u32 m0, s79, 0x4000
    s_nop 0
    buffer_load_dwordx4 v3, s[12:15], s74 offen lds
    ds_read_b64_tr_b16 v[84:85], v8 offset:51200
    ds_read_b64_tr_b16 v[86:87], v8 offset:51712
    s_waitcnt lgkmcnt(10)
    v_mfma_f32_32x32x16_bf16 v[96:111], v[88:91], v[216:219], v[96:111]
    s_add_u32 m0, s79, 0x6000
    s_nop 0
    buffer_load_dwordx4 v3, s[12:15], s75 offen lds
    ds_read_b64_tr_b16 v[88:89], v8 offset:53248
    ds_read_b64_tr_b16 v[90:91], v8 offset:53760
    s_waitcnt lgkmcnt(10)
    v_mfma_f32_32x32x16_bf16 v[96:111], v[92:95], v[220:223], v[96:111]
    s_add_u32 m0, s79, 0x8000
    s_nop 0
    buffer_load_dwordx4 v3, s[12:15], s76 offen lds
    ds_read_b64_tr_b16 v[92:93], v8 offset:55296
    ds_read_b64_tr_b16 v[94:95], v8 offset:55808
    s_waitcnt lgkmcnt(6)
    v_mfma_f32_32x32x16_bf16 v[96:111], v[80:83], v[224:227], v[96:111]
    s_waitcnt vmcnt(6)
    s_barrier
    ds_read_b128 v[240:243], v4 offset:49152
    ds_read_b128 v[244:247], v5 offset:49152
    ds_read_b128 v[248:251], v6 offset:49152
    ds_read_b128 v[252:255], v7 offset:49152
    ds_read_b64_tr_b16 v[80:81], v8 offset:57344
    ds_read_b64_tr_b16 v[82:83], v8 offset:57856
    s_waitcnt lgkmcnt(10)
    v_mfma_f32_32x32x16_bf16 v[96:111], v[84:87], v[228:231], v[96:111]
    s_add_u32 m0, s79, 0xa000
    s_nop 0
    buffer_load_dwordx4 v3, s[12:15], s77 offen lds
    ds_read_b64_tr_b16 v[84:85], v8 offset:59392
    ds_read_b64_tr_b16 v[86:87], v8 offset:59904
    s_waitcnt lgkmcnt(10)
    v_mfma_f32_32x32x16_bf16 v[96:111], v[88:91], v[232:235], v[96:111]
    ds_read_b64_tr_b16 v[88:89], v8 offset:61440
    ds_read_b64_tr_b16 v[90:91], v8 offset:61952
    s_waitcnt lgkmcnt(10)
    v_mfma_f32_32x32x16_bf16 v[96:111], v[92:95], v[236:239], v[96:111]
    ds_read_b64_tr_b16 v[92:93], v8 offset:63488
    ds_read_b64_tr_b16 v[94:95], v8 offset:64000
    s_waitcnt lgkmcnt(6)
    v_mfma_f32_32x32x16_bf16 v[96:111], v[80:83], v[240:243], v[96:111]
    s_waitcnt lgkmcnt(4)
    v_mfma_f32_32x32x16_bf16 v[96:111], v[84:87], v[244:247], v[96:111]
    s_waitcnt lgkmcnt(2)
    v_mfma_f32_32x32x16_bf16 v[96:111], v[88:91], v[248:251], v[96:111]
    s_waitcnt lgkmcnt(0)
    v_mfma_f32_32x32x16_bf16 v[96:111], v[92:95], v[252:255], v[96:111]
    s_lshl_b32 s83, s81, 1
    s_sub_u32 s83, s83, s3
    s_mul_i32 s83, s83, s96
    s_add_u32 s83, s83, s90
    v_add_u32 v6, s83, v3
    s_sub_u32 s83, s96, 0x400
    v_add_u32 v7, s83, v6
    s_lshl_b32 s88, s81, 11
    s_lshl2_add_u32 s83, s5, s81
    s_mul_i32 s83, s83, 0x24000
    v_add_u32 v1, s83, v11
    s_waitcnt vmcnt(4)
    s_barrier
    buffer_load_dword v2, off, s[20:23], 0 sc1
    s_cmp_lg_u32 s80, 0
    s_cbranch_scc1 L_mlpp
    ds_read_b64_tr_b16 v[80:81], v12 offset:0
    ds_read_b64_tr_b16 v[82:83], v12 offset:512
    ds_read_b64_tr_b16 v[84:85], v12 offset:2048
    ds_read_b64_tr_b16 v[86:87], v12 offset:2560
    ds_read_b64_tr_b16 v[88:89], v12 offset:4096
    ds_read_b64_tr_b16 v[90:91], v12 offset:4608
    v_mov_b32 v16, v28
    s_nop 1
    v_mfma_f32_32x32x16_bf16 v[112:127], v[16:19], v[20:23], 0
    ds_read_b64_tr_b16 v[92:93], v12 offset:6144
    ds_read_b64_tr_b16 v[94:95], v12 offset:6656
    s_waitcnt lgkmcnt(6)
    v_mfma_f32_32x32x16_bf16 v[112:127], v[80:83], v[128:131], v[112:127]
    ds_read_b64_tr_b16 v[80:81], v12 offset:8192
    ds_read_b64_tr_b16 v[82:83], v12 offset:8704
    s_waitcnt lgkmcnt(6)
    v_mfma_f32_32x32x16_bf16 v[112:127], v[84:87], v[132:135], v[112:127]
    ds_read_b64_tr_b16 v[84:85], v12 offset:10240
    ds_read_b64_tr_b16 v[86:87], v12 offset:10752
    s_waitcnt lgkmcnt(6)
    v_mfma_f32_32x32x16_bf16 v[112:127], v[88:91], v[136:139], v[112:127]
    ds_read_b64_tr_b16 v[88:89], v12 offset:12288
    ds_read_b64_tr_b16 v[90:91], v12 offset:12800
    s_waitcnt lgkmcnt(6)
    v_mfma_f32_32x32x16_bf16 v[112:127], v[92:95], v[140:143], v[112:127]
    ds_read_b64_tr_b16 v[92:93], v12 offset:14336
    ds_read_b64_tr_b16 v[94:95], v12 offset:14848
    s_waitcnt lgkmcnt(6)
    v_mfma_f32_32x32x16_bf16 v[112:127], v[80:83], v[144:147], v[112:127]
    ds_read_b64_tr_b16 v[80:81], v8 offset:0
    ds_read_b64_tr_b16 v[82:83], v8 offset:512
    s_waitcnt lgkmcnt(6)
    v_mfma_f32_32x32x16_bf16 v[112:127], v[84:87], v[148:151], v[112:127]
    ds_read_b64_tr_b16 v[84:85], v8 offset:2048
    ds_read_b64_tr_b16 v[86:87], v8 offset:2560
    s_waitcnt lgkmcnt(6)
    v_mfma_f32_32x32x16_bf16 v[112:127], v[88:91], v[152:155], v[112:127]
    ds_read_b64_tr_b16 v[88:89], v8 offset:4096
    ds_read_b64_tr_b16 v[90:91], v8 offset:4608
    s_waitcnt lgkmcnt(6)
    v_mfma_f32_32x32x16_bf16 v[112:127], v[92:95], v[156:159], v[112:127]
    ds_read_b64_tr_b16 v[92:93], v8 offset:6144
    ds_read_b64_tr_b16 v[94:95], v8 offset:6656
    s_waitcnt lgkmcnt(6)
    v_mfma_f32_32x32x16_bf16 v[112:127], v[80:83], v[160:163], v[112:127]
    ds_read_b64_tr_b16 v[80:81], v8 offset:8192
    ds_read_b64_tr_b16 v[82:83], v8 offset:8704
    s_waitcnt lgkmcnt(6)
    v_mfma_f32_32x32x16_bf16 v[112:127], v[84:87], v[164:167], v[112:127]
    ds_read_b64_tr_b16 v[84:85], v8 offset:10240
    ds_read_b64_tr_b16 v[86:87], v8 offset:10752
    s_waitcnt lgkmcnt(6)
    v_mfma_f32_32x32x16_bf16 v[112:127], v[88:91], v[168:171], v[112:127]
    ds_read_b64_tr_b16 v[88:89], v8 offset:12288
    ds_read_b64_tr_b16 v[90:91], v8 offset:12800
    s_waitcnt lgkmcnt(6)
    v_mfma_f32_32x32x16_bf16 v[112:127], v[92:95], v[172:175], v[112:127]
    ds_read_b64_tr_b16 v[92:93], v8 offset:14336
    ds_read_b64_tr_b16 v[94:95], v8 offset:14848
    s_waitcnt lgkmcnt(6)
    v_mfma_f32_32x32x16_bf16 v[112:127], v[80:83], v[176:179], v[112:127]
    s_waitcnt vmcnt(1)
    s_barrier
    ds_read_b64_tr_b16 v[80:81], v8 offset:16384
    ds_read_b64_tr_b16 v[82:83], v8 offset:16896
    s_waitcnt lgkmcnt(6)
    v_mfma_f32_32x32x16_bf16 v[112:127], v[84:87], v[180:183], v[112:127]
    ds_read_b64_tr_b16 v[84:85], v8 offset:18432
    ds_read_b64_tr_b16 v[86:87], v8 offset:18944
    s_waitcnt lgkmcnt(6)
    v_mfma_f32_32x32x16_bf16 v[112:127], v[88:91], v[184:187], v[112:127]
    ds_read_b64_tr_b16 v[88:89], v8 offset:20480
    ds_read_b64_tr_b16 v[90:91], v8 offset:20992
    s_waitcnt lgkmcnt(6)
    v_mfma_f32_32x32x16_bf16 v[112:127], v[92:95], v[188:191], v[112:127]
    ds_read_b64_tr_b16 v[92:93], v8 offset:22528
    ds_read_b64_tr_b16 v[94:95], v8 offset:23040
    s_waitcnt lgkmcnt(6)
    v_mfma_f32_32x32x16_bf16 v[112:127], v[80:83], v[192:195], v[112:127]
    ds_read_b64_tr_b16 v[80:81], v8 offset:24576
    ds_read_b64_tr_b16 v[82:83], v8 offset:25088
    s_waitcnt lgkmcnt(6)
    v_mfma_f32_32x32x16_bf16 v[112:127], v[84:87], v[196:199], v[112:127]
    ds_read_b64_tr_b16 v[84:85], v8 offset:26624
    ds_read_b64_tr_b16 v[86:87], v8 offset:27136
    s_waitcnt lgkmcnt(6)
    v_mfma_f32_32x32x16_bf16 v[112:127], v[88:91], v[200:203], v[112:127]
    ds_read_b64_tr_b16 v[88:89], v8 offset:28672
    ds_read_b64_tr_b16 v[90:91], v8 offset:29184
    s_waitcnt lgkmcnt(6)
    v_mfma_f32_32x32x16_bf16 v[112:127], v[92:95], v[204:207], v[112:127]
    ds_read_b64_tr_b16 v[92:93], v8 offset:30720
    ds_read_b64_tr_b16 v[94:95], v8 offset:31232
    s_waitcnt lgkmcnt(6)
    v_mfma_f32_32x32x16_bf16 v[112:127], v[80:83], v[208:211], v[112:127]
    ds_read_b64_tr_b16 v[80:81], v8 offset:32768
    ds_read_b64_tr_b16 v[82:83], v8 offset:33280
    s_waitcnt lgkmcnt(6)
    v_mfma_f32_32x32x16_bf16 v[112:127], v[84:87], v[212:215], v[112:127]
    ds_read_b64_tr_b16 v[84:85], v8 offset:34816
    ds_read_b64_tr_b16 v[86:87], v8 offset:35328
    s_waitcnt lgkmcnt(6)
    v_mfma_f32_32x32x16_bf16 v[112:127], v[88:91], v[216:219], v[112:127]
    ds_read_b64_tr_b16 v[88:89], v8 offset:36864
    ds_read_b64_tr_b16 v[90:91], v8 offset:37376
    s_waitcnt lgkmcnt(6)
    v_mfma_f32_32x32x16_bf16 v[112:127], v[92:95], v[220:223], v[112:127]
    ds_read_b64_tr_b16 v[92:93], v8 offset:38912
    ds_read_b64_tr_b16 v[94:95], v8 offset:39424
    s_waitcnt lgkmcnt(6)
    v_mfma_f32_32x32x16_bf16 v[112:127], v[80:83], v[224:227], v[112:127]
    ds_read_b64_tr_b16 v[80:81], v8 offset:40960
    ds_read_b64_tr_b16 v[82:83], v8 offset:41472
    s_waitcnt lgkmcnt(6)
    v_mfma_f32_32x32x16_bf16 v[112:127], v[84:87], v[228:231], v[112:127]
    ds_read_b64_tr_b16 v[84:85], v8 offset:43008
    ds_read_b64_tr_b16 v[86:87], v8 offset:43520
    s_waitcnt lgkmcnt(6)
    v_mfma_f32_32x32x16_bf16 v[112:127], v[88:91], v[232:235], v[112:127]
    ds_read_b64_tr_b16 v[88:89], v8 offset:45056
    ds_read_b64_tr_b16 v[90:91], v8 offset:45568
    s_waitcnt lgkmcnt(6)
    v_mfma_f32_32x32x16_bf16 v[112:127], v[92:95], v[236:239], v[112:127]
    ds_read_b64_tr_b16 v[92:93], v8 offset:47104
    ds_read_b64_tr_b16 v[94:95], v8 offset:47616
    s_waitcnt lgkmcnt(6)
    v_mfma_f32_32x32x16_bf16 v[112:127], v[80:83], v[240:243], v[112:127]
    s_waitcnt lgkmcnt(4)
    v_mfma_f32_32x32x16_bf16 v[112:127], v[84:87], v[244:247], v[112:127]
    s_waitcnt lgkmcnt(2)
    v_mfma_f32_32x32x16_bf16 v[112:127], v[88:91], v[248:251], v[112:127]
    s_waitcnt lgkmcnt(0)
    v_mfma_f32_32x32x16_bf16 v[112:127], v[92:95], v[252:255], v[112:127]
    s_add_u32 m0, s88, 0x1c000
    s_nop 0
    buffer_load_dwordx4 v6, s[12:15], s74 offen lds
    v_mul_f32 v32, s87, v96
    v_mul_f32 v33, s87, v97
    v_mul_f32 v34, s87, v98
    v_mul_f32 v35, s87, v99
    v_exp_f32 v32, v32
    v_exp_f32 v33, v33
    v_exp_f32 v34, v34
    v_exp_f32 v35, v35
    v_add_f32 v32, 1.0, v32
    v_add_f32 v33, 1.0, v33
    v_add_f32 v34, 1.0, v34
    v_add_f32 v35, 1.0, v35
    v_fma_f32 v32, v32, v32, 1.0
    v_fma_f32 v33, v33, v33, 1.0
    v_fma_f32 v34, v34, v34, 1.0
    v_fma_f32 v35, v35, v35, 1.0
    buffer_load_dwordx4 v7, s[12:15], s74 offen offset:1024 lds
    v_rcp_f32 v32, v32
    v_rcp_f32 v33, v33
    v_rcp_f32 v34, v34
    v_rcp_f32 v35, v35
    v_fma_f32 v32, v32, -2.0, 1.0
    v_fma_f32 v33, v33, -2.0, 1.0
    v_fma_f32 v34, v34, -2.0, 1.0
    v_fma_f32 v35, v35, -2.0, 1.0
    v_mul_f32 v32, v96, v32
    v_mul_f32 v33, v97, v33
    v_mul_f32 v34, v98, v34
    v_mul_f32 v35, v99, v35
    v_cvt_pk_bf16_f32 v40, v32, v33
    v_cvt_pk_bf16_f32 v41, v34, v35
    v_mul_f32 v36, s87, v100
    s_add_u32 m0, s88, 0x1e000
    s_nop 0
    buffer_load_dwordx4 v6, s[12:15], s75 offen lds
    v_mul_f32 v37, s87, v101
    v_mul_f32 v38, s87, v102
    v_mul_f32 v39, s87, v103
    v_exp_f32 v36, v36
    v_exp_f32 v37, v37
    v_exp_f32 v38, v38
    v_exp_f32 v39, v39
    v_add_f32 v36, 1.0, v36
    v_add_f32 v37, 1.0, v37
    v_add_f32 v38, 1.0, v38
    v_add_f32 v39, 1.0, v39
    v_fma_f32 v36, v36, v36, 1.0
    v_fma_f32 v37, v37, v37, 1.0
    v_fma_f32 v38, v38, v38, 1.0
    v_fma_f32 v39, v39, v39, 1.0
    buffer_load_dwordx4 v7, s[12:15], s75 offen offset:1024 lds
    v_rcp_f32 v36, v36
    v_rcp_f32 v37, v37
    v_rcp_f32 v38, v38
    v_rcp_f32 v39, v39
    v_fma_f32 v36, v36, -2.0, 1.0
    v_fma_f32 v37, v37, -2.0, 1.0
    v_fma_f32 v38, v38, -2.0, 1.0
    v_fma_f32 v39, v39, -2.0, 1.0
    v_mul_f32 v36, v100, v36
    v_mul_f32 v37, v101, v37
    v_mul_f32 v38, v102, v38
    v_mul_f32 v39, v103, v39
    v_cvt_pk_bf16_f32 v42, v36, v37
    v_cvt_pk_bf16_f32 v43, v38, v39
    buffer_store_dwordx4 v[40:43], v1, s[16:19], s92 offen offset:0 sc1
    s_add_u32 m0, s88, 0x20000
    s_nop 0
    buffer_load_dwordx4 v6, s[12:15], s76 offen lds
    v_mul_f32 v32, s87, v104
    v_mul_f32 v33, s87, v105
    v_mul_f32 v34, s87, v106
    v_mul_f32 v35, s87, v107
    v_exp_f32 v32, v32
    v_exp_f32 v33, v33
    v_exp_f32 v34, v34
    v_exp_f32 v35, v35
    v_add_f32 v32, 1.0, v32
    v_add_f32 v33, 1.0, v33
    v_add_f32 v34, 1.0, v34
    v_add_f32 v35, 1.0, v35
    v_fma_f32 v32, v32, v32, 1.0
    v_fma_f32 v33, v33, v33, 1.0
    buffer_load_dwordx4 v7, s[12:15], s76 offen offset:1024 lds
    v_fma_f32 v34, v34, v34, 1.0
    v_fma_f32 v35, v35, v35, 1.0
    v_rcp_f32 v32, v32
    v_rcp_f32 v33, v33
    v_rcp_f32 v34, v34
    v_rcp_f32 v35, v35
    v_fma_f32 v32, v32, -2.0, 1.0
    v_fma_f32 v33, v33, -2.0, 1.0
    v_fma_f32 v34, v34, -2.0, 1.0
    v_fma_f32 v35, v35, -2.0, 1.0
    v_mul_f32 v32, v104, v32
    v_mul_f32 v33, v105, v33
    v_mul_f32 v34, v106, v34
    v_mul_f32 v35, v107, v35
    s_add_u32 m0, s88, 0x22000
    s_nop 0
    buffer_load_dwordx4 v6, s[12:15], s77 offen lds
    v_cvt_pk_bf16_f32 v44, v32, v33
    v_cvt_pk_bf16_f32 v45, v34, v35
    v_mul_f32 v36, s87, v108
    v_mul_f32 v37, s87, v109
    v_mul_f32 v38, s87, v110
    v_mul_f32 v39, s87, v111
    v_exp_f32 v36, v36
    v_exp_f32 v37, v37
    v_exp_f32 v38, v38
    v_exp_f32 v39, v39
    v_add_f32 v36, 1.0, v36
    v_add_f32 v37, 1.0, v37
    v_add_f32 v38, 1.0, v38
    v_add_f32 v39, 1.0, v39
    buffer_load_dwordx4 v7, s[12:15], s77 offen offset:1024 lds
    v_fma_f32 v36, v36, v36, 1.0
    v_fma_f32 v37, v37, v37, 1.0
    v_fma_f32 v38, v38, v38, 1.0
    v_fma_f32 v39, v39, v39, 1.0
    v_rcp_f32 v36, v36
    v_rcp_f32 v37, v37
    v_rcp_f32 v38, v38
    v_rcp_f32 v39, v39
    v_fma_f32 v36, v36, -2.0, 1.0
    v_fma_f32 v37, v37, -2.0, 1.0
    v_fma_f32 v38, v38, -2.0, 1.0
    v_fma_f32 v39, v39, -2.0, 1.0
    v_mul_f32 v36, v108, v36
    v_mul_f32 v37, v109, v37
    v_mul_f32 v38, v110, v38
    v_mul_f32 v39, v111, v39
    v_cvt_pk_bf16_f32 v46, v36, v37
    v_cvt_pk_bf16_f32 v47, v38, v39
    buffer_store_dwordx4 v[44:47], v1, s[16:19], s92 offen offset:1024 sc1
    s_barrier
    ds_read_b64_tr_b16 v[80:81], v9 offset:0
    ds_read_b64_tr_b16 v[82:83], v9 offset:512
    ds_read_b64_tr_b16 v[84:85], v9 offset:2048
    ds_read_b64_tr_b16 v[86:87], v9 offset:2560
    ds_read_b64_tr_b16 v[88:89], v9 offset:4096
    ds_read_b64_tr_b16 v[90:91], v9 offset:4608
    v_mov_b32 v16, v29
    s_nop 1
    v_mfma_f32_32x32x16_bf16 v[96:111], v[16:19], v[20:23], 0
    ds_read_b64_tr_b16 v[92:93], v9 offset:6144
    ds_read_b64_tr_b16 v[94:95], v9 offset:6656
    s_waitcnt lgkmcnt(6)
    v_mfma_f32_32x32x16_bf16 v[96:111], v[80:83], v[128:131], v[96:111]
    ds_read_b64_tr_b16 v[80:81], v9 offset:8192
    ds_read_b64_tr_b16 v[82:83], v9 offset:8704
    s_waitcnt lgkmcnt(6)
    v_mfma_f32_32x32x16_bf16 v[96:111], v[84:87], v[132:135], v[96:111]
    ds_read_b64_tr_b16 v[84:85], v9 offset:10240
    ds_read_b64_tr_b16 v[86:87], v9 offset:10752
    s_waitcnt lgkmcnt(6)
    v_mfma_f32_32x32x16_bf16 v[96:111], v[88:91], v[136:139], v[96:111]
    ds_read_b64_tr_b16 v[88:89], v9 offset:12288
    ds_read_b64_tr_b16 v[90:91], v9 offset:12800
    s_waitcnt lgkmcnt(6)
    v_mfma_f32_32x32x16_bf16 v[96:111], v[92:95], v[140:143], v[96:111]
    ds_read_b64_tr_b16 v[92:93], v9 offset:14336
    ds_read_b64_tr_b16 v[94:95], v9 offset:14848
    s_waitcnt lgkmcnt(6)
    v_mfma_f32_32x32x16_bf16 v[96:111], v[80:83], v[144:147], v[96:111]
    ds_read_b64_tr_b16 v[80:81], v9 offset:16384
    ds_read_b64_tr_b16 v[82:83], v9 offset:16896
    s_waitcnt lgkmcnt(6)
    v_mfma_f32_32x32x16_bf16 v[96:111], v[84:87], v[148:151], v[96:111]
    ds_read_b64_tr_b16 v[84:85], v9 offset:18432
    ds_read_b64_tr_b16 v[86:87], v9 offset:18944
    s_waitcnt lgkmcnt(6)
    v_mfma_f32_32x32x16_bf16 v[96:111], v[88:91], v[152:155], v[96:111]
    ds_read_b64_tr_b16 v[88:89], v9 offset:20480
    ds_read_b64_tr_b16 v[90:91], v9 offset:20992
    s_waitcnt lgkmcnt(6)
    v_mfma_f32_32x32x16_bf16 v[96:111], v[92:95], v[156:159], v[96:111]
    ds_read_b64_tr_b16 v[92:93], v9 offset:22528
    ds_read_b64_tr_b16 v[94:95], v9 offset:23040
    s_waitcnt lgkmcnt(6)
    v_mfma_f32_32x32x16_bf16 v[96:111], v[80:83], v[160:163], v[96:111]
    ds_read_b64_tr_b16 v[80:81], v9 offset:24576
    ds_read_b64_tr_b16 v[82:83], v9 offset:25088
    s_waitcnt lgkmcnt(6)
    v_mfma_f32_32x32x16_bf16 v[96:111], v[84:87], v[164:167], v[96:111]
    ds_read_b64_tr_b16 v[84:85], v9 offset:26624
    ds_read_b64_tr_b16 v[86:87], v9 offset:27136
    s_waitcnt lgkmcnt(6)
    v_mfma_f32_32x32x16_bf16 v[96:111], v[88:91], v[168:171], v[96:111]
    ds_read_b64_tr_b16 v[88:89], v9 offset:28672
    ds_read_b64_tr_b16 v[90:91], v9 offset:29184
    s_waitcnt lgkmcnt(6)
    v_mfma_f32_32x32x16_bf16 v[96:111], v[92:95], v[172:175], v[96:111]
    ds_read_b64_tr_b16 v[92:93], v9 offset:30720
    ds_read_b64_tr_b16 v[94:95], v9 offset:31232
    s_waitcnt lgkmcnt(6)
    v_mfma_f32_32x32x16_bf16 v[96:111], v[80:83], v[176:179], v[96:111]
    s_waitcnt vmcnt(1)
    s_barrier
    ds_read_b64_tr_b16 v[80:81], v9 offset:32768
    ds_read_b64_tr_b16 v[82:83], v9 offset:33280
    s_waitcnt lgkmcnt(6)
    v_mfma_f32_32x32x16_bf16 v[96:111], v[84:87], v[180:183], v[96:111]
    ds_read_b64_tr_b16 v[84:85], v9 offset:34816
    ds_read_b64_tr_b16 v[86:87], v9 offset:35328
    s_waitcnt lgkmcnt(6)
    v_mfma_f32_32x32x16_bf16 v[96:111], v[88:91], v[184:187], v[96:111]
    ds_read_b64_tr_b16 v[88:89], v9 offset:36864
    ds_read_b64_tr_b16 v[90:91], v9 offset:37376
    s_waitcnt lgkmcnt(6)
    v_mfma_f32_32x32x16_bf16 v[96:111], v[92:95], v[188:191], v[96:111]
    ds_read_b64_tr_b16 v[92:93], v9 offset:38912
    ds_read_b64_tr_b16 v[94:95], v9 offset:39424
    s_waitcnt lgkmcnt(6)
    v_mfma_f32_32x32x16_bf16 v[96:111], v[80:83], v[192:195], v[96:111]
    ds_read_b64_tr_b16 v[80:81], v9 offset:40960
    ds_read_b64_tr_b16 v[82:83], v9 offset:41472
    s_waitcnt lgkmcnt(6)
    v_mfma_f32_32x32x16_bf16 v[96:111], v[84:87], v[196:199], v[96:111]
    ds_read_b64_tr_b16 v[84:85], v9 offset:43008
    ds_read_b64_tr_b16 v[86:87], v9 offset:43520
    s_waitcnt lgkmcnt(6)
    v_mfma_f32_32x32x16_bf16 v[96:111], v[88:91], v[200:203], v[96:111]
    ds_read_b64_tr_b16 v[88:89], v9 offset:45056
    ds_read_b64_tr_b16 v[90:91], v9 offset:45568
    s_waitcnt lgkmcnt(6)
    v_mfma_f32_32x32x16_bf16 v[96:111], v[92:95], v[204:207], v[96:111]
    ds_read_b64_tr_b16 v[92:93], v9 offset:47104
    ds_read_b64_tr_b16 v[94:95], v9 offset:47616
    s_waitcnt lgkmcnt(6)
    v_mfma_f32_32x32x16_bf16 v[96:111], v[80:83], v[208:211], v[96:111]
    ds_read_b64_tr_b16 v[80:81], v9 offset:49152
    ds_read_b64_tr_b16 v[82:83], v9 offset:49664
    s_waitcnt lgkmcnt(6)
    v_mfma_f32_32x32x16_bf16 v[96:111], v[84:87], v[212:215], v[96:111]
    v_readfirstlane_b32 s83, v2
    s_movk_i32 s84, 0x7fff
L_m0_chk:
    s_cmp_ge_u32 s83, 8
    s_cbranch_scc1 L_m0_ok
    s_sub_u32 s84, s84, 1
    s_cbranch_scc1 L_m0_ok
    buffer_load_dword v2, off, s[20:23], 0 sc1
    s_waitcnt vmcnt(0)
    v_readfirstlane_b32 s83, v2
    s_branch L_m0_chk
L_m0_ok:
    s_waitcnt vmcnt(0)
    v_mov_b32 v76, 0x24c14
    v_mov_b32 v77, 1
    s_mov_b64 exec, 1
    ds_add_rtn_u32 v77, v76, v77
    s_mov_b64 exec, -1
    s_waitcnt lgkmcnt(0)
    v_readfirstlane_b32 s83, v77
    s_cmp_lg_u32 s83, 3
    s_cbranch_scc1 L_m0a_skip
    s_lshr_b32 s85, s6, 1
    s_lshl2_add_u32 s85, s5, s85
    s_lshl_b32 s85, s85, 5
    s_and_b32 s86, s6, 1
    s_add_u32 s85, s85, s86
    s_add_u32 s85, s85, 0
    s_lshl_b32 s85, s85, 2
    s_mov_b32 s99, 1
    s_atomic_add s99, s[58:59], s85
L_m0a_skip:
    ds_read_b64_tr_b16 v[84:85], v9 offset:51200
    ds_read_b64_tr_b16 v[86:87], v9 offset:51712
    v_mfma_f32_32x32x16_bf16 v[96:111], v[88:91], v[216:219], v[96:111]
    ds_read_b64_tr_b16 v[88:89], v9 offset:53248
    ds_read_b64_tr_b16 v[90:91], v9 offset:53760
    v_mfma_f32_32x32x16_bf16 v[96:111], v[92:95], v[220:223], v[96:111]
    ds_read_b64_tr_b16 v[92:93], v9 offset:55296
    ds_read_b64_tr_b16 v[94:95], v9 offset:55808
    v_mfma_f32_32x32x16_bf16 v[96:111], v[80:83], v[224:227], v[96:111]
    ds_read_b64_tr_b16 v[80:81], v9 offset:57344
    ds_read_b64_tr_b16 v[82:83], v9 offset:57856
    s_waitcnt lgkmcnt(6)
    v_mfma_f32_32x32x16_bf16 v[96:111], v[84:87], v[228:231], v[96:111]
    ds_read_b64_tr_b16 v[84:85], v9 offset:59392
    ds_read_b64_tr_b16 v[86:87], v9 offset:59904
    s_waitcnt lgkmcnt(6)
    v_mfma_f32_32x32x16_bf16 v[96:111], v[88:91], v[232:235], v[96:111]
    ds_read_b64_tr_b16 v[88:89], v9 offset:61440
    ds_read_b64_tr_b16 v[90:91], v9 offset:61952
    s_waitcnt lgkmcnt(6)
    v_mfma_f32_32x32x16_bf16 v[96:111], v[92:95], v[236:239], v[96:111]
    ds_read_b64_tr_b16 v[92:93], v9 offset:63488
    ds_read_b64_tr_b16 v[94:95], v9 offset:64000
    s_waitcnt lgkmcnt(6)
    v_mfma_f32_32x32x16_bf16 v[96:111], v[80:83], v[240:243], v[96:111]
    s_waitcnt lgkmcnt(4)
    v_mfma_f32_32x32x16_bf16 v[96:111], v[84:87], v[244:247], v[96:111]
    s_waitcnt lgkmcnt(2)
    v_mfma_f32_32x32x16_bf16 v[96:111], v[88:91], v[248:251], v[96:111]
    s_waitcnt lgkmcnt(0)
    v_mfma_f32_32x32x16_bf16 v[96:111], v[92:95], v[252:255], v[96:111]
    v_mov_b32 v16, v30
    v_readlane_b32 s63, v13, 2
    s_add_u32 m0, s62, 0x4000
    s_lshl_b32 s64, s63, 14
    buffer_load_dwordx4 v14, s[24:27], s64 offen lds
    buffer_load_dwordx4 v15, s[24:27], s64 offen offset:1024 lds
    v_mul_f32 v32, s87, v112
    v_mul_f32 v33, s87, v113
    v_mul_f32 v34, s87, v114
    v_mul_f32 v35, s87, v115
    v_exp_f32 v32, v32
    v_exp_f32 v33, v33
    v_exp_f32 v34, v34
    v_exp_f32 v35, v35
    v_add_f32 v32, 1.0, v32
    v_add_f32 v33, 1.0, v33
    v_add_f32 v34, 1.0, v34
    v_add_f32 v35, 1.0, v35
    v_fma_f32 v32, v32, v32, 1.0
    v_fma_f32 v33, v33, v33, 1.0
    v_fma_f32 v34, v34, v34, 1.0
    v_fma_f32 v35, v35, v35, 1.0
    v_rcp_f32 v32, v32
    v_rcp_f32 v33, v33
    v_rcp_f32 v34, v34
    v_rcp_f32 v35, v35
    v_fma_f32 v32, v32, -2.0, 1.0
    v_fma_f32 v33, v33, -2.0, 1.0
    v_fma_f32 v34, v34, -2.0, 1.0
    v_fma_f32 v35, v35, -2.0, 1.0
    v_mul_f32 v32, v112, v32
    v_mul_f32 v33, v113, v33
    v_mul_f32 v34, v114, v34
    v_mul_f32 v35, v115, v35
    v_readlane_b32 s63, v13, 3
    s_add_u32 m0, s62, 0x6000
    s_lshl_b32 s64, s63, 14
    buffer_load_dwordx4 v14, s[24:27], s64 offen lds
    buffer_load_dwordx4 v15, s[24:27], s64 offen offset:1024 lds
    v_cvt_pk_bf16_f32 v40, v32, v33
    v_cvt_pk_bf16_f32 v41, v34, v35
    v_mul_f32 v36, s87, v116
    v_mul_f32 v37, s87, v117
    v_mul_f32 v38, s87, v118
    v_mul_f32 v39, s87, v119
    v_exp_f32 v36, v36
    v_exp_f32 v37, v37
    v_exp_f32 v38, v38
    v_exp_f32 v39, v39
    v_add_f32 v36, 1.0, v36
    v_add_f32 v37, 1.0, v37
    v_add_f32 v38, 1.0, v38
    v_add_f32 v39, 1.0, v39
    v_fma_f32 v36, v36, v36, 1.0
    v_fma_f32 v37, v37, v37, 1.0
    v_fma_f32 v38, v38, v38, 1.0
    v_fma_f32 v39, v39, v39, 1.0
    v_rcp_f32 v36, v36
    v_rcp_f32 v37, v37
    v_rcp_f32 v38, v38
    v_rcp_f32 v39, v39
    v_fma_f32 v36, v36, -2.0, 1.0
    v_fma_f32 v37, v37, -2.0, 1.0
    v_fma_f32 v38, v38, -2.0, 1.0
    v_fma_f32 v39, v39, -2.0, 1.0
    v_mul_f32 v36, v116, v36
    v_mul_f32 v37, v117, v37
    v_mul_f32 v38, v118, v38
    v_mul_f32 v39, v119, v39
    v_cvt_pk_bf16_f32 v42, v36, v37
    v_cvt_pk_bf16_f32 v43, v38, v39
    buffer_store_dwordx4 v[40:43], v1, s[16:19], s93 offen offset:0 sc1
    v_readlane_b32 s63, v13, 4
    s_add_u32 m0, s62, 0x8000
    s_lshl_b32 s64, s63, 14
    buffer_load_dwordx4 v14, s[24:27], s64 offen lds
    buffer_load_dwordx4 v15, s[24:27], s64 offen offset:1024 lds
    v_mul_f32 v32, s87, v120
    v_mul_f32 v33, s87, v121
    v_mul_f32 v34, s87, v122
    v_mul_f32 v35, s87, v123
    v_exp_f32 v32, v32
    v_exp_f32 v33, v33
    v_exp_f32 v34, v34
    v_exp_f32 v35, v35
    v_add_f32 v32, 1.0, v32
    v_add_f32 v33, 1.0, v33
    v_add_f32 v34, 1.0, v34
    v_add_f32 v35, 1.0, v35
    v_fma_f32 v32, v32, v32, 1.0
    v_fma_f32 v33, v33, v33, 1.0
    v_fma_f32 v34, v34, v34, 1.0
    v_fma_f32 v35, v35, v35, 1.0
    v_rcp_f32 v32, v32
    v_rcp_f32 v33, v33
    v_rcp_f32 v34, v34
    v_rcp_f32 v35, v35
    v_fma_f32 v32, v32, -2.0, 1.0
    v_fma_f32 v33, v33, -2.0, 1.0
    v_fma_f32 v34, v34, -2.0, 1.0
    v_fma_f32 v35, v35, -2.0, 1.0
    v_mul_f32 v32, v120, v32
    v_readlane_b32 s63, v13, 5
    s_add_u32 m0, s62, 0xa000
    s_lshl_b32 s64, s63, 14
    buffer_load_dwordx4 v14, s[24:27], s64 offen lds
    buffer_load_dwordx4 v15, s[24:27], s64 offen offset:1024 lds
    v_mul_f32 v33, v121, v33
    v_mul_f32 v34, v122, v34
    v_mul_f32 v35, v123, v35
    v_cvt_pk_bf16_f32 v44, v32, v33
    v_cvt_pk_bf16_f32 v45, v34, v35
    v_mul_f32 v36, s87, v124
    v_mul_f32 v37, s87, v125
    v_mul_f32 v38, s87, v126
    v_mul_f32 v39, s87, v127
    v_exp_f32 v36, v36
    v_exp_f32 v37, v37
    v_exp_f32 v38, v38
    v_exp_f32 v39, v39
    v_add_f32 v36, 1.0, v36
    v_add_f32 v37, 1.0, v37
    v_add_f32 v38, 1.0, v38
    v_add_f32 v39, 1.0, v39
    v_fma_f32 v36, v36, v36, 1.0
    v_fma_f32 v37, v37, v37, 1.0
    v_fma_f32 v38, v38, v38, 1.0
    v_fma_f32 v39, v39, v39, 1.0
    v_rcp_f32 v36, v36
    v_rcp_f32 v37, v37
    v_rcp_f32 v38, v38
    v_rcp_f32 v39, v39
    v_fma_f32 v36, v36, -2.0, 1.0
    v_fma_f32 v37, v37, -2.0, 1.0
    v_fma_f32 v38, v38, -2.0, 1.0
    v_fma_f32 v39, v39, -2.0, 1.0
    v_mul_f32 v36, v124, v36
    v_mul_f32 v37, v125, v37
    v_mul_f32 v38, v126, v38
    v_mul_f32 v39, v127, v39
    v_cvt_pk_bf16_f32 v46, v36, v37
    v_cvt_pk_bf16_f32 v47, v38, v39
    buffer_store_dwordx4 v[44:47], v1, s[16:19], s93 offen offset:1024 sc1
    v_lshrrev_b32 v72, 5, v0
    v_bfe_u32 v73, v0, 2, 2
    v_lshl_add_u32 v72, v72, 3, v73
    v_lshlrev_b32 v72, 6, v72
    v_bfe_u32 v73, v0, 4, 1
    v_lshl_add_u32 v72, v73, 5, v72
    v_and_b32 v73, 3, v0
    v_lshl_add_u32 v72, v73, 3, v72
    v_add_u32 v8, 0xc000, v72
    s_barrier
    v_mul_f32 v32, s87, v96
    v_mul_f32 v33, s87, v97
    v_mul_f32 v34, s87, v98
    v_mul_f32 v35, s87, v99
    v_exp_f32 v32, v32
    v_exp_f32 v33, v33
    v_exp_f32 v34, v34
    v_exp_f32 v35, v35
    v_add_f32 v32, 1.0, v32
    v_add_f32 v33, 1.0, v33
    v_add_f32 v34, 1.0, v34
    v_add_f32 v35, 1.0, v35
    v_fma_f32 v32, v32, v32, 1.0
    v_fma_f32 v33, v33, v33, 1.0
    v_fma_f32 v34, v34, v34, 1.0
    v_fma_f32 v35, v35, v35, 1.0
    v_rcp_f32 v32, v32
    v_rcp_f32 v33, v33
    v_rcp_f32 v34, v34
    v_rcp_f32 v35, v35
    v_fma_f32 v32, v32, -2.0, 1.0
    v_fma_f32 v33, v33, -2.0, 1.0
    v_fma_f32 v34, v34, -2.0, 1.0
    v_fma_f32 v35, v35, -2.0, 1.0
    v_mul_f32 v32, v96, v32
    v_mul_f32 v33, v97, v33
    v_mul_f32 v34, v98, v34
    v_mul_f32 v35, v99, v35
    v_cvt_pk_bf16_f32 v40, v32, v33
    v_cvt_pk_bf16_f32 v41, v34, v35
    v_mul_f32 v36, s87, v100
    v_mul_f32 v37, s87, v101
    v_mul_f32 v38, s87, v102
    v_mul_f32 v39, s87, v103
    v_exp_f32 v36, v36
    v_exp_f32 v37, v37
    v_exp_f32 v38, v38
    v_exp_f32 v39, v39
    v_add_f32 v36, 1.0, v36
    v_add_f32 v37, 1.0, v37
    v_add_f32 v38, 1.0, v38
    v_add_f32 v39, 1.0, v39
    v_fma_f32 v36, v36, v36, 1.0
    v_fma_f32 v37, v37, v37, 1.0
    v_fma_f32 v38, v38, v38, 1.0
    v_fma_f32 v39, v39, v39, 1.0
    v_rcp_f32 v36, v36
    v_rcp_f32 v37, v37
    v_rcp_f32 v38, v38
    v_rcp_f32 v39, v39
    v_fma_f32 v36, v36, -2.0, 1.0
    v_fma_f32 v37, v37, -2.0, 1.0
    v_fma_f32 v38, v38, -2.0, 1.0
    v_fma_f32 v39, v39, -2.0, 1.0
    v_mul_f32 v36, v100, v36
    v_mul_f32 v37, v101, v37
    v_mul_f32 v38, v102, v38
    v_mul_f32 v39, v103, v39
    v_cvt_pk_bf16_f32 v42, v36, v37
    v_cvt_pk_bf16_f32 v43, v38, v39
    buffer_store_dwordx4 v[40:43], v1, s[16:19], s94 offen offset:0 sc1
    s_waitcnt vmcnt(1)
    v_mov_b32 v76, 0x24c08
    v_mov_b32 v77, 1
    s_mov_b64 exec, 1
    ds_add_rtn_u32 v77, v76, v77
    s_mov_b64 exec, -1
    s_waitcnt lgkmcnt(0)
    v_readfirstlane_b32 s83, v77
    s_cmp_lg_u32 s83, 3
    s_cbranch_scc1 L_m1_skip
    s_lshr_b32 s85, s6, 1
    s_lshl2_add_u32 s85, s5, s85
    s_lshl_b32 s85, s85, 5
    s_and_b32 s86, s6, 1
    s_add_u32 s85, s85, s86
    s_add_u32 s85, s85, 0
    s_lshl_b32 s85, s85, 2
    s_mov_b32 s99, 1
    s_atomic_add s99, s[58:59], s85
L_m1_skip:
    v_mul_f32 v32, s87, v104
    v_mul_f32 v33, s87, v105
    v_mul_f32 v34, s87, v106
    v_mul_f32 v35, s87, v107
    v_exp_f32 v32, v32
    v_exp_f32 v33, v33
    v_exp_f32 v34, v34
    v_exp_f32 v35, v35
    v_add_f32 v32, 1.0, v32
    v_add_f32 v33, 1.0, v33
    v_add_f32 v34, 1.0, v34
    v_add_f32 v35, 1.0, v35
    v_fma_f32 v32, v32, v32, 1.0
    v_fma_f32 v33, v33, v33, 1.0
    v_fma_f32 v34, v34, v34, 1.0
    v_fma_f32 v35, v35, v35, 1.0
    v_rcp_f32 v32, v32
    v_rcp_f32 v33, v33
    v_rcp_f32 v34, v34
    v_rcp_f32 v35, v35
    v_fma_f32 v32, v32, -2.0, 1.0
    v_fma_f32 v33, v33, -2.0, 1.0
    v_fma_f32 v34, v34, -2.0, 1.0
    v_fma_f32 v35, v35, -2.0, 1.0
    v_mul_f32 v32, v104, v32
    v_mul_f32 v33, v105, v33
    v_mul_f32 v34, v106, v34
    v_mul_f32 v35, v107, v35
    v_cvt_pk_bf16_f32 v44, v32, v33
    v_cvt_pk_bf16_f32 v45, v34, v35
    v_mul_f32 v36, s87, v108
    v_mul_f32 v37, s87, v109
    v_mul_f32 v38, s87, v110
    v_mul_f32 v39, s87, v111
    v_exp_f32 v36, v36
    v_exp_f32 v37, v37
    v_exp_f32 v38, v38
    v_exp_f32 v39, v39
    v_add_f32 v36, 1.0, v36
    v_add_f32 v37, 1.0, v37
    v_add_f32 v38, 1.0, v38
    v_add_f32 v39, 1.0, v39
    v_fma_f32 v36, v36, v36, 1.0
    v_fma_f32 v37, v37, v37, 1.0
    v_fma_f32 v38, v38, v38, 1.0
    v_fma_f32 v39, v39, v39, 1.0
    v_rcp_f32 v36, v36
    v_rcp_f32 v37, v37
    v_rcp_f32 v38, v38
    v_rcp_f32 v39, v39
    v_fma_f32 v36, v36, -2.0, 1.0
    v_fma_f32 v37, v37, -2.0, 1.0
    v_fma_f32 v38, v38, -2.0, 1.0
    v_fma_f32 v39, v39, -2.0, 1.0
    v_mul_f32 v36, v108, v36
    v_mul_f32 v37, v109, v37
    v_mul_f32 v38, v110, v38
    v_mul_f32 v39, v111, v39
    v_cvt_pk_bf16_f32 v46, v36, v37
    v_cvt_pk_bf16_f32 v47, v38, v39
    buffer_store_dwordx4 v[44:47], v1, s[16:19], s94 offen offset:1024 sc1
    ds_read_b64_tr_b16 v[80:81], v8 offset:0
    ds_read_b64_tr_b16 v[82:83], v8 offset:256
    ds_read_b64_tr_b16 v[84:85], v8 offset:1024
    ds_read_b64_tr_b16 v[86:87], v8 offset:1280
    ds_read_b64_tr_b16 v[88:89], v8 offset:2048
    ds_read_b64_tr_b16 v[90:91], v8 offset:2304
    v_mfma_f32_32x32x16_bf16 v[112:127], v[16:19], v[20:23], 0
    ds_read_b64_tr_b16 v[92:93], v8 offset:3072
    ds_read_b64_tr_b16 v[94:95], v8 offset:3328
    s_waitcnt lgkmcnt(6)
    v_mfma_f32_32x32x16_bf16 v[112:127], v[80:83], v[128:131], v[112:127]
    ds_read_b64_tr_b16 v[80:81], v8 offset:4096
    ds_read_b64_tr_b16 v[82:83], v8 offset:4352
    s_waitcnt lgkmcnt(6)
    v_mfma_f32_32x32x16_bf16 v[112:127], v[84:87], v[132:135], v[112:127]
    ds_read_b64_tr_b16 v[84:85], v8 offset:5120
    ds_read_b64_tr_b16 v[86:87], v8 offset:5376
    s_waitcnt lgkmcnt(6)
    v_mfma_f32_32x32x16_bf16 v[112:127], v[88:91], v[136:139], v[112:127]
    ds_read_b64_tr_b16 v[88:89], v8 offset:6144
    ds_read_b64_tr_b16 v[90:91], v8 offset:6400
    s_waitcnt lgkmcnt(6)
    v_mfma_f32_32x32x16_bf16 v[112:127], v[92:95], v[140:143], v[112:127]
    ds_read_b64_tr_b16 v[92:93], v8 offset:7168
    ds_read_b64_tr_b16 v[94:95], v8 offset:7424
    s_waitcnt lgkmcnt(6)
    v_mfma_f32_32x32x16_bf16 v[112:127], v[80:83], v[144:147], v[112:127]
    ds_read_b64_tr_b16 v[80:81], v8 offset:8192
    ds_read_b64_tr_b16 v[82:83], v8 offset:8448
    s_waitcnt lgkmcnt(6)
    v_mfma_f32_32x32x16_bf16 v[112:127], v[84:87], v[148:151], v[112:127]
    ds_read_b64_tr_b16 v[84:85], v8 offset:9216
    ds_read_b64_tr_b16 v[86:87], v8 offset:9472
    s_waitcnt lgkmcnt(6)
    v_mfma_f32_32x32x16_bf16 v[112:127], v[88:91], v[152:155], v[112:127]
    ds_read_b64_tr_b16 v[88:89], v8 offset:10240
    ds_read_b64_tr_b16 v[90:91], v8 offset:10496
    s_waitcnt lgkmcnt(6)
    v_mfma_f32_32x32x16_bf16 v[112:127], v[92:95], v[156:159], v[112:127]
    ds_read_b64_tr_b16 v[92:93], v8 offset:11264
    ds_read_b64_tr_b16 v[94:95], v8 offset:11520
    s_waitcnt lgkmcnt(6)
    v_mfma_f32_32x32x16_bf16 v[112:127], v[80:83], v[160:163], v[112:127]
    ds_read_b64_tr_b16 v[80:81], v8 offset:12288
    ds_read_b64_tr_b16 v[82:83], v8 offset:12544
    s_waitcnt lgkmcnt(6)
    v_mfma_f32_32x32x16_bf16 v[112:127], v[84:87], v[164:167], v[112:127]
    ds_read_b64_tr_b16 v[84:85], v8 offset:13312
    ds_read_b64_tr_b16 v[86:87], v8 offset:13568
    s_waitcnt lgkmcnt(6)
    v_mfma_f32_32x32x16_bf16 v[112:127], v[88:91], v[168:171], v[112:127]
    ds_read_b64_tr_b16 v[88:89], v8 offset:14336
    ds_read_b64_tr_b16 v[90:91], v8 offset:14592
    s_waitcnt lgkmcnt(6)
    v_mfma_f32_32x32x16_bf16 v[112:127], v[92:95], v[172:175], v[112:127]
    ds_read_b64_tr_b16 v[92:93], v8 offset:15360
    ds_read_b64_tr_b16 v[94:95], v8 offset:15616
    s_waitcnt lgkmcnt(6)
    v_mfma_f32_32x32x16_bf16 v[112:127], v[80:83], v[176:179], v[112:127]
    ds_read_b64_tr_b16 v[80:81], v8 offset:16384
    ds_read_b64_tr_b16 v[82:83], v8 offset:16640
    s_waitcnt lgkmcnt(6)
    v_mfma_f32_32x32x16_bf16 v[112:127], v[84:87], v[180:183], v[112:127]
    ds_read_b64_tr_b16 v[84:85], v8 offset:17408
    ds_read_b64_tr_b16 v[86:87], v8 offset:17664
    s_waitcnt lgkmcnt(6)
    v_mfma_f32_32x32x16_bf16 v[112:127], v[88:91], v[184:187], v[112:127]
    ds_read_b64_tr_b16 v[88:89], v8 offset:18432
    ds_read_b64_tr_b16 v[90:91], v8 offset:18688
    s_waitcnt lgkmcnt(6)
    v_mfma_f32_32x32x16_bf16 v[112:127], v[92:95], v[188:191], v[112:127]
    s_waitcnt vmcnt(0)
    v_mov_b32 v76, 0x24c00
    v_mov_b32 v77, 1
    s_mov_b64 exec, 1
    ds_add_rtn_u32 v77, v76, v77
    s_mov_b64 exec, -1
    s_waitcnt lgkmcnt(0)
    v_readfirstlane_b32 s83, v77
    s_cmp_lg_u32 s83, 7
    s_cbranch_scc1 L_m2_skip
    s_lshr_b32 s85, s6, 1
    s_lshl2_add_u32 s85, s5, s85
    s_lshl_b32 s85, s85, 5
    s_and_b32 s86, s6, 1
    s_add_u32 s85, s85, s86
    s_add_u32 s85, s85, 0
    s_lshl_b32 s85, s85, 2
    s_mov_b32 s99, 1
    s_atomic_add s99, s[58:59], s85
L_m2_skip:
    s_mov_b32 s32, s52
    s_mov_b32 s33, s53
    s_mov_b32 s34, 0x400
    s_mov_b32 s35, 0x20000
    s_lshl_b32 s83, s7, 7
    v_add_u32 v72, s83, v11
    v_and_b32 v72, 0x3ff, v72
    s_lshl_b32 s83, s81, 10
    s_add_u32 m0, s83, 0x26000
    s_nop 0
    buffer_load_dwordx4 v72, s[32:35], 0 offen lds
    ds_read_b64_tr_b16 v[92:93], v8 offset:19456
    ds_read_b64_tr_b16 v[94:95], v8 offset:19712
    v_mfma_f32_32x32x16_bf16 v[112:127], v[80:83], v[192:195], v[112:127]
    ds_read_b64_tr_b16 v[80:81], v8 offset:20480
    ds_read_b64_tr_b16 v[82:83], v8 offset:20736
    v_mfma_f32_32x32x16_bf16 v[112:127], v[84:87], v[196:199], v[112:127]
    ds_read_b64_tr_b16 v[84:85], v8 offset:21504
    ds_read_b64_tr_b16 v[86:87], v8 offset:21760
    v_mfma_f32_32x32x16_bf16 v[112:127], v[88:91], v[200:203], v[112:127]
    ds_read_b64_tr_b16 v[88:89], v8 offset:22528
    ds_read_b64_tr_b16 v[90:91], v8 offset:22784
    s_waitcnt lgkmcnt(6)
    v_mfma_f32_32x32x16_bf16 v[112:127], v[92:95], v[204:207], v[112:127]
    ds_read_b64_tr_b16 v[92:93], v8 offset:23552
    ds_read_b64_tr_b16 v[94:95], v8 offset:23808
    s_waitcnt lgkmcnt(6)
    v_mfma_f32_32x32x16_bf16 v[112:127], v[80:83], v[208:211], v[112:127]
    ds_read_b64_tr_b16 v[80:81], v8 offset:24576
    ds_read_b64_tr_b16 v[82:83], v8 offset:24832
    s_waitcnt lgkmcnt(6)
    v_mfma_f32_32x32x16_bf16 v[112:127], v[84:87], v[212:215], v[112:127]
    ds_read_b64_tr_b16 v[84:85], v8 offset:25600
    ds_read_b64_tr_b16 v[86:87], v8 offset:25856
    s_waitcnt lgkmcnt(6)
    v_mfma_f32_32x32x16_bf16 v[112:127], v[88:91], v[216:219], v[112:127]
    ds_read_b64_tr_b16 v[88:89], v8 offset:26624
    ds_read_b64_tr_b16 v[90:91], v8 offset:26880
    s_waitcnt lgkmcnt(6)
    v_mfma_f32_32x32x16_bf16 v[112:127], v[92:95], v[220:223], v[112:127]
    ds_read_b64_tr_b16 v[92:93], v8 offset:27648
    ds_read_b64_tr_b16 v[94:95], v8 offset:27904
    s_waitcnt lgkmcnt(6)
    v_mfma_f32_32x32x16_bf16 v[112:127], v[80:83], v[224:227], v[112:127]
    ds_read_b64_tr_b16 v[80:81], v8 offset:28672
    ds_read_b64_tr_b16 v[82:83], v8 offset:28928
    s_waitcnt lgkmcnt(6)
    v_mfma_f32_32x32x16_bf16 v[112:127], v[84:87], v[228:231], v[112:127]
    ds_read_b64_tr_b16 v[84:85], v8 offset:29696
    ds_read_b64_tr_b16 v[86:87], v8 offset:29952
    s_waitcnt lgkmcnt(6)
    v_mfma_f32_32x32x16_bf16 v[112:127], v[88:91], v[232:235], v[112:127]
    ds_read_b64_tr_b16 v[88:89], v8 offset:30720
    ds_read_b64_tr_b16 v[90:91], v8 offset:30976
    s_waitcnt lgkmcnt(6)
    v_mfma_f32_32x32x16_bf16 v[112:127], v[92:95], v[236:239], v[112:127]
    ds_read_b64_tr_b16 v[92:93], v8 offset:31744
    ds_read_b64_tr_b16 v[94:95], v8 offset:32000
    s_waitcnt lgkmcnt(6)
    v_mfma_f32_32x32x16_bf16 v[112:127], v[80:83], v[240:243], v[112:127]
    s_waitcnt lgkmcnt(4)
    v_mfma_f32_32x32x16_bf16 v[112:127], v[84:87], v[244:247], v[112:127]
    s_waitcnt lgkmcnt(2)
    v_mfma_f32_32x32x16_bf16 v[112:127], v[88:91], v[248:251], v[112:127]
    s_waitcnt lgkmcnt(0)
    v_mfma_f32_32x32x16_bf16 v[112:127], v[92:95], v[252:255], v[112:127]
    v_mov_b32 v76, 0x24c0c
    v_mov_b32 v77, 1
    s_mov_b64 exec, 1
    ds_add_u32 v76, v77
    s_mov_b64 exec, -1
    s_nop 6
    v_mul_f32 v32, s87, v112
    v_mul_f32 v33, s87, v113
    v_mul_f32 v34, s87, v114
    v_mul_f32 v35, s87, v115
    v_exp_f32 v32, v32
    v_exp_f32 v33, v33
    v_exp_f32 v34, v34
    v_exp_f32 v35, v35
    v_add_f32 v32, 1.0, v32
    v_add_f32 v33, 1.0, v33
    v_add_f32 v34, 1.0, v34
    v_add_f32 v35, 1.0, v35
    v_fma_f32 v32, v32, v32, 1.0
    v_fma_f32 v33, v33, v33, 1.0
    v_fma_f32 v34, v34, v34, 1.0
    v_fma_f32 v35, v35, v35, 1.0
    v_rcp_f32 v32, v32
    v_rcp_f32 v33, v33
    v_rcp_f32 v34, v34
    v_rcp_f32 v35, v35
    v_fma_f32 v32, v32, -2.0, 1.0
    v_fma_f32 v33, v33, -2.0, 1.0
    v_fma_f32 v34, v34, -2.0, 1.0
    v_fma_f32 v35, v35, -2.0, 1.0
    v_mul_f32 v32, v112, v32
    v_mul_f32 v33, v113, v33
    v_mul_f32 v34, v114, v34
    v_mul_f32 v35, v115, v35
    v_cvt_pk_bf16_f32 v40, v32, v33
    v_cvt_pk_bf16_f32 v41, v34, v35
    v_mul_f32 v36, s87, v116
    v_mul_f32 v37, s87, v117
    v_mul_f32 v38, s87, v118
    v_mul_f32 v39, s87, v119
    v_exp_f32 v36, v36
    v_exp_f32 v37, v37
    v_exp_f32 v38, v38
    v_exp_f32 v39, v39
    v_add_f32 v36, 1.0, v36
    v_add_f32 v37, 1.0, v37
    v_add_f32 v38, 1.0, v38
    v_add_f32 v39, 1.0, v39
    v_fma_f32 v36, v36, v36, 1.0
    v_fma_f32 v37, v37, v37, 1.0
    v_fma_f32 v38, v38, v38, 1.0
    v_fma_f32 v39, v39, v39, 1.0
    v_rcp_f32 v36, v36
    v_rcp_f32 v37, v37
    v_rcp_f32 v38, v38
    v_rcp_f32 v39, v39
    v_fma_f32 v36, v36, -2.0, 1.0
    v_fma_f32 v37, v37, -2.0, 1.0
    v_fma_f32 v38, v38, -2.0, 1.0
    v_fma_f32 v39, v39, -2.0, 1.0
    v_mul_f32 v36, v116, v36
    v_mul_f32 v37, v117, v37
    v_mul_f32 v38, v118, v38
    v_mul_f32 v39, v119, v39
    v_cvt_pk_bf16_f32 v42, v36, v37
    v_cvt_pk_bf16_f32 v43, v38, v39
    buffer_store_dwordx4 v[40:43], v1, s[16:19], s95 offen offset:0 sc1
    v_mul_f32 v32, s87, v120
    v_mul_f32 v33, s87, v121
    v_mul_f32 v34, s87, v122
    v_mul_f32 v35, s87, v123
    v_exp_f32 v32, v32
    v_exp_f32 v33, v33
    v_exp_f32 v34, v34
    v_exp_f32 v35, v35
    v_add_f32 v32, 1.0, v32
    v_add_f32 v33, 1.0, v33
    v_add_f32 v34, 1.0, v34
    v_add_f32 v35, 1.0, v35
    v_fma_f32 v32, v32, v32, 1.0
    v_fma_f32 v33, v33, v33, 1.0
    v_fma_f32 v34, v34, v34, 1.0
    v_fma_f32 v35, v35, v35, 1.0
    v_rcp_f32 v32, v32
    v_rcp_f32 v33, v33
    v_rcp_f32 v34, v34
    v_rcp_f32 v35, v35
    v_fma_f32 v32, v32, -2.0, 1.0
    v_fma_f32 v33, v33, -2.0, 1.0
    v_fma_f32 v34, v34, -2.0, 1.0
    v_fma_f32 v35, v35, -2.0, 1.0
    v_mul_f32 v32, v120, v32
    v_mul_f32 v33, v121, v33
    v_mul_f32 v34, v122, v34
    v_mul_f32 v35, v123, v35
    v_cvt_pk_bf16_f32 v44, v32, v33
    v_cvt_pk_bf16_f32 v45, v34, v35
    v_mul_f32 v36, s87, v124
    v_mul_f32 v37, s87, v125
    v_mul_f32 v38, s87, v126
    v_mul_f32 v39, s87, v127
    v_exp_f32 v36, v36
    v_exp_f32 v37, v37
    v_exp_f32 v38, v38
    v_exp_f32 v39, v39
    v_add_f32 v36, 1.0, v36
    v_add_f32 v37, 1.0, v37
    v_add_f32 v38, 1.0, v38
    v_add_f32 v39, 1.0, v39
    v_fma_f32 v36, v36, v36, 1.0
    v_fma_f32 v37, v37, v37, 1.0
    v_fma_f32 v38, v38, v38, 1.0
    v_fma_f32 v39, v39, v39, 1.0
    v_rcp_f32 v36, v36
    v_rcp_f32 v37, v37
    v_rcp_f32 v38, v38
    v_rcp_f32 v39, v39
    v_fma_f32 v36, v36, -2.0, 1.0
    v_fma_f32 v37, v37, -2.0, 1.0
    v_fma_f32 v38, v38, -2.0, 1.0
    v_fma_f32 v39, v39, -2.0, 1.0
    v_mul_f32 v36, v124, v36
    v_mul_f32 v37, v125, v37
    v_mul_f32 v38, v126, v38
    v_mul_f32 v39, v127, v39
    v_cvt_pk_bf16_f32 v46, v36, v37
    v_cvt_pk_bf16_f32 v47, v38, v39
    buffer_store_dwordx4 v[44:47], v1, s[16:19], s95 offen offset:1024 sc1
    s_waitcnt vmcnt(2)
    v_lshrrev_b32 v72, 5, v0
    s_lshl_b32 s83, s81, 10
    s_add_u32 s83, s83, 0x26000
    v_lshl_add_u32 v72, v72, 4, s83
    v_mov_b32 v12, 0
    v_mov_b32 v73, 0
    ds_read_b128 v[96:99], v72 offset:0
    ds_read_b128 v[100:103], v72 offset:32
    ds_read_b128 v[104:107], v72 offset:64
    ds_read_b128 v[108:111], v72 offset:96
    ds_read_b128 v[112:115], v72 offset:128
    ds_read_b128 v[116:119], v72 offset:160
    ds_read_b128 v[120:123], v72 offset:192
    ds_read_b128 v[124:127], v72 offset:224
    s_waitcnt lgkmcnt(7)
    v_dot2c_f32_bf16 v73, v128, v96
    v_dot2c_f32_bf16 v12, v129, v97
    v_dot2c_f32_bf16 v73, v130, v98
    v_dot2c_f32_bf16 v12, v131, v99
    ds_read_b128 v[96:99], v72 offset:256
    s_waitcnt lgkmcnt(7)
    v_dot2c_f32_bf16 v73, v132, v100
    v_dot2c_f32_bf16 v12, v133, v101
    v_dot2c_f32_bf16 v73, v134, v102
    v_dot2c_f32_bf16 v12, v135, v103
    ds_read_b128 v[100:103], v72 offset:288
    s_waitcnt lgkmcnt(7)
    v_dot2c_f32_bf16 v73, v136, v104
    v_dot2c_f32_bf16 v12, v137, v105
    v_dot2c_f32_bf16 v73, v138, v106
    v_dot2c_f32_bf16 v12, v139, v107
    ds_read_b128 v[104:107], v72 offset:320
    s_waitcnt lgkmcnt(7)
    v_dot2c_f32_bf16 v73, v140, v108
    v_dot2c_f32_bf16 v12, v141, v109
    v_dot2c_f32_bf16 v73, v142, v110
    v_dot2c_f32_bf16 v12, v143, v111
    ds_read_b128 v[108:111], v72 offset:352
    s_waitcnt lgkmcnt(7)
    v_dot2c_f32_bf16 v73, v144, v112
    v_dot2c_f32_bf16 v12, v145, v113
    v_dot2c_f32_bf16 v73, v146, v114
    v_dot2c_f32_bf16 v12, v147, v115
    ds_read_b128 v[112:115], v72 offset:384
    s_waitcnt lgkmcnt(7)
    v_dot2c_f32_bf16 v73, v148, v116
    v_dot2c_f32_bf16 v12, v149, v117
    v_dot2c_f32_bf16 v73, v150, v118
    v_dot2c_f32_bf16 v12, v151, v119
    ds_read_b128 v[116:119], v72 offset:416
    s_waitcnt lgkmcnt(7)
    v_dot2c_f32_bf16 v73, v152, v120
    v_dot2c_f32_bf16 v12, v153, v121
    v_dot2c_f32_bf16 v73, v154, v122
    v_dot2c_f32_bf16 v12, v155, v123
    ds_read_b128 v[120:123], v72 offset:448
    s_waitcnt lgkmcnt(7)
    v_dot2c_f32_bf16 v73, v156, v124
    v_dot2c_f32_bf16 v12, v157, v125
    v_dot2c_f32_bf16 v73, v158, v126
    v_dot2c_f32_bf16 v12, v159, v127
    ds_read_b128 v[124:127], v72 offset:480
    s_waitcnt lgkmcnt(7)
    v_dot2c_f32_bf16 v73, v160, v96
    v_dot2c_f32_bf16 v12, v161, v97
    v_dot2c_f32_bf16 v73, v162, v98
    v_dot2c_f32_bf16 v12, v163, v99
    ds_read_b128 v[96:99], v72 offset:512
    s_waitcnt lgkmcnt(7)
    v_dot2c_f32_bf16 v73, v164, v100
    v_dot2c_f32_bf16 v12, v165, v101
    v_dot2c_f32_bf16 v73, v166, v102
    v_dot2c_f32_bf16 v12, v167, v103
    ds_read_b128 v[100:103], v72 offset:544
    s_waitcnt lgkmcnt(7)
    v_dot2c_f32_bf16 v73, v168, v104
    v_dot2c_f32_bf16 v12, v169, v105
    v_dot2c_f32_bf16 v73, v170, v106
    v_dot2c_f32_bf16 v12, v171, v107
    ds_read_b128 v[104:107], v72 offset:576
    s_waitcnt lgkmcnt(7)
    v_dot2c_f32_bf16 v73, v172, v108
    v_dot2c_f32_bf16 v12, v173, v109
    v_dot2c_f32_bf16 v73, v174, v110
    v_dot2c_f32_bf16 v12, v175, v111
    ds_read_b128 v[108:111], v72 offset:608
    s_waitcnt lgkmcnt(7)
    v_dot2c_f32_bf16 v73, v176, v112
    v_dot2c_f32_bf16 v12, v177, v113
    v_dot2c_f32_bf16 v73, v178, v114
    v_dot2c_f32_bf16 v12, v179, v115
    ds_read_b128 v[112:115], v72 offset:640
    s_waitcnt lgkmcnt(7)
    v_dot2c_f32_bf16 v73, v180, v116
    v_dot2c_f32_bf16 v12, v181, v117
    v_dot2c_f32_bf16 v73, v182, v118
    v_dot2c_f32_bf16 v12, v183, v119
    ds_read_b128 v[116:119], v72 offset:672
    s_waitcnt lgkmcnt(7)
    v_dot2c_f32_bf16 v73, v184, v120
    s_waitcnt vmcnt(0)
    v_mov_b32 v74, 0x24c10
    v_mov_b32 v75, 1
    s_mov_b64 exec, 1
    ds_add_rtn_u32 v75, v74, v75
    s_mov_b64 exec, -1
    s_waitcnt lgkmcnt(0)
    v_readfirstlane_b32 s83, v75
    s_cmp_lg_u32 s83, 3
    s_cbranch_scc1 L_m3_skip
    s_lshr_b32 s85, s6, 1
    s_lshl2_add_u32 s85, s5, s85
    s_lshl_b32 s85, s85, 5
    s_and_b32 s86, s6, 1
    s_add_u32 s85, s85, s86
    s_add_u32 s85, s85, 6
    s_lshl_b32 s85, s85, 2
    s_mov_b32 s99, 1
    s_atomic_add s99, s[58:59], s85
L_m3_skip:
    v_dot2c_f32_bf16 v12, v185, v121
    v_dot2c_f32_bf16 v73, v186, v122
    v_dot2c_f32_bf16 v12, v187, v123
    ds_read_b128 v[120:123], v72 offset:704
    v_dot2c_f32_bf16 v73, v188, v124
    v_dot2c_f32_bf16 v12, v189, v125
    v_dot2c_f32_bf16 v73, v190, v126
    v_dot2c_f32_bf16 v12, v191, v127
    ds_read_b128 v[124:127], v72 offset:736
    v_dot2c_f32_bf16 v73, v192, v96
    v_dot2c_f32_bf16 v12, v193, v97
    v_dot2c_f32_bf16 v73, v194, v98
    v_dot2c_f32_bf16 v12, v195, v99
    ds_read_b128 v[96:99], v72 offset:768
    v_dot2c_f32_bf16 v73, v196, v100
    v_dot2c_f32_bf16 v12, v197, v101
    v_dot2c_f32_bf16 v73, v198, v102
    v_dot2c_f32_bf16 v12, v199, v103
    ds_read_b128 v[100:103], v72 offset:800
    v_dot2c_f32_bf16 v73, v200, v104
    v_dot2c_f32_bf16 v12, v201, v105
    v_dot2c_f32_bf16 v73, v202, v106
    v_dot2c_f32_bf16 v12, v203, v107
    ds_read_b128 v[104:107], v72 offset:832
    v_dot2c_f32_bf16 v73, v204, v108
    v_dot2c_f32_bf16 v12, v205, v109
    v_dot2c_f32_bf16 v73, v206, v110
    v_dot2c_f32_bf16 v12, v207, v111
    ds_read_b128 v[108:111], v72 offset:864
    v_dot2c_f32_bf16 v73, v208, v112
    v_dot2c_f32_bf16 v12, v209, v113
    v_dot2c_f32_bf16 v73, v210, v114
    v_dot2c_f32_bf16 v12, v211, v115
    ds_read_b128 v[112:115], v72 offset:896
    v_dot2c_f32_bf16 v73, v212, v116
    v_dot2c_f32_bf16 v12, v213, v117
    v_dot2c_f32_bf16 v73, v214, v118
    v_dot2c_f32_bf16 v12, v215, v119
    ds_read_b128 v[116:119], v72 offset:928
    s_waitcnt lgkmcnt(7)
    v_dot2c_f32_bf16 v73, v216, v120
    v_dot2c_f32_bf16 v12, v217, v121
    v_dot2c_f32_bf16 v73, v218, v122
    v_dot2c_f32_bf16 v12, v219, v123
    ds_read_b128 v[120:123], v72 offset:960
    s_waitcnt lgkmcnt(7)
    v_dot2c_f32_bf16 v73, v220, v124
    v_dot2c_f32_bf16 v12, v221, v125
    v_dot2c_f32_bf16 v73, v222, v126
    v_dot2c_f32_bf16 v12, v223, v127
    ds_read_b128 v[124:127], v72 offset:992
    s_waitcnt lgkmcnt(7)
    v_dot2c_f32_bf16 v73, v224, v96
    v_dot2c_f32_bf16 v12, v225, v97
    v_dot2c_f32_bf16 v73, v226, v98
    v_dot2c_f32_bf16 v12, v227, v99
    s_waitcnt lgkmcnt(6)
    v_dot2c_f32_bf16 v73, v228, v100
    v_dot2c_f32_bf16 v12, v229, v101
    v_dot2c_f32_bf16 v73, v230, v102
    v_dot2c_f32_bf16 v12, v231, v103
    s_waitcnt lgkmcnt(5)
    v_dot2c_f32_bf16 v73, v232, v104
    v_dot2c_f32_bf16 v12, v233, v105
    v_dot2c_f32_bf16 v73, v234, v106
    v_dot2c_f32_bf16 v12, v235, v107
    s_waitcnt lgkmcnt(4)
    v_dot2c_f32_bf16 v73, v236, v108
    v_dot2c_f32_bf16 v12, v237, v109
    v_dot2c_f32_bf16 v73, v238, v110
    v_dot2c_f32_bf16 v12, v239, v111
    s_waitcnt lgkmcnt(3)
    v_dot2c_f32_bf16 v73, v240, v112
    v_dot2c_f32_bf16 v12, v241, v113
    v_dot2c_f32_bf16 v73, v242, v114
    v_dot2c_f32_bf16 v12, v243, v115
    s_waitcnt lgkmcnt(2)
    v_dot2c_f32_bf16 v73, v244, v116
    v_dot2c_f32_bf16 v12, v245, v117
    v_dot2c_f32_bf16 v73, v246, v118
    v_dot2c_f32_bf16 v12, v247, v119
    s_waitcnt lgkmcnt(1)
    v_dot2c_f32_bf16 v73, v248, v120
    v_dot2c_f32_bf16 v12, v249, v121
    v_dot2c_f32_bf16 v73, v250, v122
    v_dot2c_f32_bf16 v12, v251, v123
    s_waitcnt lgkmcnt(0)
    v_dot2c_f32_bf16 v73, v252, v124
    v_dot2c_f32_bf16 v12, v253, v125
    v_dot2c_f32_bf16 v73, v254, v126
    v_dot2c_f32_bf16 v12, v255, v127
    s_nop 2
    v_add_f32 v32, v12, v73
    v_mov_b32 v33, v32
    s_nop 1
    v_permlane32_swap_b32 v32, v33
    v_add_f32 v32, v32, v33
    v_mul_f32 v32, s87, v32
    v_lshrrev_b32 v33, 5, v0
    v_lshlrev_b32 v33, 31, v33
    v_xor_b32 v32, v33, v32
    v_exp_f32 v32, v32
    s_lshl_b32 s83, s6, 14
    v_add_f32 v32, 1.0, v32
    v_rcp_f32 v32, v32
    s_lshl2_add_u32 s86, s5, s81
    s_lshl_b32 s86, s86, 8
    s_add_u32 s83, s83, s86
    s_add_u32 s83, s83, 0x40000
    v_lshlrev_b32 v72, 2, v0
    buffer_store_dword v32, v72, s[16:19], s83 offen sc1
    s_waitcnt vmcnt(0)
    v_mov_b32 v76, 0x24c04
    v_mov_b32 v77, 1
    s_mov_b64 exec, 1
    ds_add_rtn_u32 v77, v76, v77
    s_mov_b64 exec, -1
    s_waitcnt lgkmcnt(0)
    v_readfirstlane_b32 s83, v77
    s_cmp_lg_u32 s83, 3
    s_cbranch_scc1 L_m4_skip
    s_lshr_b32 s85, s6, 1
    s_lshl2_add_u32 s85, s5, s85
    s_lshl_b32 s85, s85, 5
    s_and_b32 s86, s6, 1
    s_add_u32 s85, s85, s86
    s_add_u32 s85, s85, 4
    s_lshl_b32 s85, s85, 2
    s_mov_b32 s99, 1
    s_atomic_add s99, s[58:59], s85
L_m4_skip:
    s_branch L_fin
L_mlpp:
    s_add_u32 m0, s88, 0x14000
    s_nop 0
    buffer_load_dwordx4 v6, s[12:15], s70 offen lds
    v_mul_f32 v32, s87, v96
    v_mul_f32 v33, s87, v97
    v_mul_f32 v34, s87, v98
    v_mul_f32 v35, s87, v99
    v_exp_f32 v32, v32
    v_exp_f32 v33, v33
    v_exp_f32 v34, v34
    v_exp_f32 v35, v35
    v_add_f32 v32, 1.0, v32
    v_add_f32 v33, 1.0, v33
    v_add_f32 v34, 1.0, v34
    buffer_load_dwordx4 v7, s[12:15], s70 offen offset:1024 lds
    v_add_f32 v35, 1.0, v35
    v_fma_f32 v32, v32, v32, 1.0
    v_fma_f32 v33, v33, v33, 1.0
    v_fma_f32 v34, v34, v34, 1.0
    v_fma_f32 v35, v35, v35, 1.0
    v_rcp_f32 v32, v32
    v_rcp_f32 v33, v33
    v_rcp_f32 v34, v34
    v_rcp_f32 v35, v35
    v_fma_f32 v32, v32, -2.0, 1.0
    s_add_u32 m0, s91, 0xc000
    s_nop 0
    buffer_load_dwordx4 v27, s[12:15], s70 offen lds
    v_fma_f32 v33, v33, -2.0, 1.0
    v_fma_f32 v34, v34, -2.0, 1.0
    v_fma_f32 v35, v35, -2.0, 1.0
    v_mul_f32 v32, v96, v32
    v_mul_f32 v33, v97, v33
    v_mul_f32 v34, v98, v34
    v_mul_f32 v35, v99, v35
    v_cvt_pk_bf16_f32 v40, v32, v33
    v_cvt_pk_bf16_f32 v41, v34, v35
    v_mul_f32 v36, s87, v100
    v_mul_f32 v37, s87, v101
    v_mul_f32 v38, s87, v102
    v_mul_f32 v39, s87, v103
    v_exp_f32 v36, v36
    v_exp_f32 v37, v37
    v_exp_f32 v38, v38
    v_exp_f32 v39, v39
    v_add_f32 v36, 1.0, v36
    v_add_f32 v37, 1.0, v37
    v_add_f32 v38, 1.0, v38
    s_add_u32 m0, s88, 0x16000
    s_nop 0
    buffer_load_dwordx4 v6, s[12:15], s71 offen lds
    v_add_f32 v39, 1.0, v39
    v_fma_f32 v36, v36, v36, 1.0
    v_fma_f32 v37, v37, v37, 1.0
    v_fma_f32 v38, v38, v38, 1.0
    v_fma_f32 v39, v39, v39, 1.0
    v_rcp_f32 v36, v36
    v_rcp_f32 v37, v37
    v_rcp_f32 v38, v38
    v_rcp_f32 v39, v39
    v_fma_f32 v36, v36, -2.0, 1.0
    buffer_load_dwordx4 v7, s[12:15], s71 offen offset:1024 lds
    v_fma_f32 v37, v37, -2.0, 1.0
    v_fma_f32 v38, v38, -2.0, 1.0
    v_fma_f32 v39, v39, -2.0, 1.0
    v_mul_f32 v36, v100, v36
    v_mul_f32 v37, v101, v37
    v_mul_f32 v38, v102, v38
    v_mul_f32 v39, v103, v39
    v_cvt_pk_bf16_f32 v42, v36, v37
    v_cvt_pk_bf16_f32 v43, v38, v39
    buffer_store_dwordx4 v[40:43], v1, s[16:19], s92 offen offset:0 sc1
    s_waitcnt vmcnt(7)
    s_barrier
    s_add_u32 m0, s88, 0x18000
    s_nop 0
    buffer_load_dwordx4 v6, s[12:15], s72 offen lds
    v_mul_f32 v32, s87, v104
    v_mul_f32 v33, s87, v105
    v_mul_f32 v34, s87, v106
    v_mul_f32 v35, s87, v107
    v_exp_f32 v32, v32
    v_exp_f32 v33, v33
    v_exp_f32 v34, v34
    v_exp_f32 v35, v35
    v_add_f32 v32, 1.0, v32
    v_add_f32 v33, 1.0, v33
    v_add_f32 v34, 1.0, v34
    v_add_f32 v35, 1.0, v35
    v_fma_f32 v32, v32, v32, 1.0
    v_fma_f32 v33, v33, v33, 1.0
    buffer_load_dwordx4 v7, s[12:15], s72 offen offset:1024 lds
    v_fma_f32 v34, v34, v34, 1.0
    v_fma_f32 v35, v35, v35, 1.0
    v_rcp_f32 v32, v32
    v_rcp_f32 v33, v33
    v_rcp_f32 v34, v34
    v_rcp_f32 v35, v35
    v_fma_f32 v32, v32, -2.0, 1.0
    v_fma_f32 v33, v33, -2.0, 1.0
    v_fma_f32 v34, v34, -2.0, 1.0
    v_fma_f32 v35, v35, -2.0, 1.0
    v_mul_f32 v32, v104, v32
    v_mul_f32 v33, v105, v33
    v_mul_f32 v34, v106, v34
    v_mul_f32 v35, v107, v35
    s_add_u32 m0, s88, 0x1a000
    s_nop 0
    buffer_load_dwordx4 v6, s[12:15], s73 offen lds
    v_cvt_pk_bf16_f32 v44, v32, v33
    v_cvt_pk_bf16_f32 v45, v34, v35
    v_mul_f32 v36, s87, v108
    v_mul_f32 v37, s87, v109
    v_mul_f32 v38, s87, v110
    v_mul_f32 v39, s87, v111
    v_exp_f32 v36, v36
    v_exp_f32 v37, v37
    v_exp_f32 v38, v38
    v_exp_f32 v39, v39
    v_add_f32 v36, 1.0, v36
    v_add_f32 v37, 1.0, v37
    v_add_f32 v38, 1.0, v38
    v_add_f32 v39, 1.0, v39
    buffer_load_dwordx4 v7, s[12:15], s73 offen offset:1024 lds
    v_fma_f32 v36, v36, v36, 1.0
    v_fma_f32 v37, v37, v37, 1.0
    v_fma_f32 v38, v38, v38, 1.0
    v_fma_f32 v39, v39, v39, 1.0
    v_rcp_f32 v36, v36
    v_rcp_f32 v37, v37
    v_rcp_f32 v38, v38
    v_rcp_f32 v39, v39
    v_fma_f32 v36, v36, -2.0, 1.0
    v_fma_f32 v37, v37, -2.0, 1.0
    v_fma_f32 v38, v38, -2.0, 1.0
    v_fma_f32 v39, v39, -2.0, 1.0
    v_mul_f32 v36, v108, v36
    v_mul_f32 v37, v109, v37
    v_mul_f32 v38, v110, v38
    v_mul_f32 v39, v111, v39
    v_cvt_pk_bf16_f32 v46, v36, v37
    v_cvt_pk_bf16_f32 v47, v38, v39
    buffer_store_dwordx4 v[44:47], v1, s[16:19], s92 offen offset:1024 sc1
    ds_read_b64_tr_b16 v[80:81], v12 offset:0
    ds_read_b64_tr_b16 v[82:83], v12 offset:512
    ds_read_b64_tr_b16 v[84:85], v12 offset:2048
    ds_read_b64_tr_b16 v[86:87], v12 offset:2560
    ds_read_b64_tr_b16 v[88:89], v12 offset:4096
    ds_read_b64_tr_b16 v[90:91], v12 offset:4608
    v_mov_b32 v16, v28
    s_nop 1
    v_mfma_f32_32x32x16_bf16 v[96:111], v[16:19], v[20:23], 0
    ds_read_b64_tr_b16 v[92:93], v12 offset:6144
    ds_read_b64_tr_b16 v[94:95], v12 offset:6656
    s_waitcnt lgkmcnt(6)
    v_mfma_f32_32x32x16_bf16 v[96:111], v[80:83], v[128:131], v[96:111]
    ds_read_b64_tr_b16 v[80:81], v12 offset:8192
    ds_read_b64_tr_b16 v[82:83], v12 offset:8704
    s_waitcnt lgkmcnt(6)
    v_mfma_f32_32x32x16_bf16 v[96:111], v[84:87], v[132:135], v[96:111]
    ds_read_b64_tr_b16 v[84:85], v12 offset:10240
    ds_read_b64_tr_b16 v[86:87], v12 offset:10752
    s_waitcnt lgkmcnt(6)
    v_mfma_f32_32x32x16_bf16 v[96:111], v[88:91], v[136:139], v[96:111]
    ds_read_b64_tr_b16 v[88:89], v12 offset:12288
    ds_read_b64_tr_b16 v[90:91], v12 offset:12800
    s_waitcnt lgkmcnt(6)
    v_mfma_f32_32x32x16_bf16 v[96:111], v[92:95], v[140:143], v[96:111]
    ds_read_b64_tr_b16 v[92:93], v12 offset:14336
    ds_read_b64_tr_b16 v[94:95], v12 offset:14848
    s_waitcnt lgkmcnt(6)
    v_mfma_f32_32x32x16_bf16 v[96:111], v[80:83], v[144:147], v[96:111]
    ds_read_b64_tr_b16 v[80:81], v8 offset:0
    ds_read_b64_tr_b16 v[82:83], v8 offset:512
    s_waitcnt lgkmcnt(6)
    v_mfma_f32_32x32x16_bf16 v[96:111], v[84:87], v[148:151], v[96:111]
    ds_read_b64_tr_b16 v[84:85], v8 offset:2048
    ds_read_b64_tr_b16 v[86:87], v8 offset:2560
    s_waitcnt lgkmcnt(6)
    v_mfma_f32_32x32x16_bf16 v[96:111], v[88:91], v[152:155], v[96:111]
    ds_read_b64_tr_b16 v[88:89], v8 offset:4096
    ds_read_b64_tr_b16 v[90:91], v8 offset:4608
    s_waitcnt lgkmcnt(6)
    v_mfma_f32_32x32x16_bf16 v[96:111], v[92:95], v[156:159], v[96:111]
    ds_read_b64_tr_b16 v[92:93], v8 offset:6144
    ds_read_b64_tr_b16 v[94:95], v8 offset:6656
    s_waitcnt lgkmcnt(6)
    v_mfma_f32_32x32x16_bf16 v[96:111], v[80:83], v[160:163], v[96:111]
    ds_read_b64_tr_b16 v[80:81], v8 offset:8192
    ds_read_b64_tr_b16 v[82:83], v8 offset:8704
    s_waitcnt lgkmcnt(6)
    v_mfma_f32_32x32x16_bf16 v[96:111], v[84:87], v[164:167], v[96:111]
    ds_read_b64_tr_b16 v[84:85], v8 offset:10240
    ds_read_b64_tr_b16 v[86:87], v8 offset:10752
    s_waitcnt lgkmcnt(6)
    v_mfma_f32_32x32x16_bf16 v[96:111], v[88:91], v[168:171], v[96:111]
    ds_read_b64_tr_b16 v[88:89], v8 offset:12288
    ds_read_b64_tr_b16 v[90:91], v8 offset:12800
    s_waitcnt lgkmcnt(6)
    v_mfma_f32_32x32x16_bf16 v[96:111], v[92:95], v[172:175], v[96:111]
    ds_read_b64_tr_b16 v[92:93], v8 offset:14336
    ds_read_b64_tr_b16 v[94:95], v8 offset:14848
    s_waitcnt lgkmcnt(6)
    v_mfma_f32_32x32x16_bf16 v[96:111], v[80:83], v[176:179], v[96:111]
    ds_read_b64_tr_b16 v[80:81], v8 offset:16384
    ds_read_b64_tr_b16 v[82:83], v8 offset:16896
    s_waitcnt lgkmcnt(6)
    v_mfma_f32_32x32x16_bf16 v[96:111], v[84:87], v[180:183], v[96:111]
    ds_read_b64_tr_b16 v[84:85], v8 offset:18432
    ds_read_b64_tr_b16 v[86:87], v8 offset:18944
    s_waitcnt lgkmcnt(6)
    v_mfma_f32_32x32x16_bf16 v[96:111], v[88:91], v[184:187], v[96:111]
    ds_read_b64_tr_b16 v[88:89], v8 offset:20480
    ds_read_b64_tr_b16 v[90:91], v8 offset:20992
    s_waitcnt lgkmcnt(6)
    v_mfma_f32_32x32x16_bf16 v[96:111], v[92:95], v[188:191], v[96:111]
    ds_read_b64_tr_b16 v[92:93], v8 offset:22528
    ds_read_b64_tr_b16 v[94:95], v8 offset:23040
    s_waitcnt lgkmcnt(6)
    v_mfma_f32_32x32x16_bf16 v[96:111], v[80:83], v[192:195], v[96:111]
    ds_read_b64_tr_b16 v[80:81], v8 offset:24576
    ds_read_b64_tr_b16 v[82:83], v8 offset:25088
    s_waitcnt lgkmcnt(6)
    v_mfma_f32_32x32x16_bf16 v[96:111], v[84:87], v[196:199], v[96:111]
    ds_read_b64_tr_b16 v[84:85], v8 offset:26624
    ds_read_b64_tr_b16 v[86:87], v8 offset:27136
    s_waitcnt lgkmcnt(6)
    v_mfma_f32_32x32x16_bf16 v[96:111], v[88:91], v[200:203], v[96:111]
    ds_read_b64_tr_b16 v[88:89], v8 offset:28672
    ds_read_b64_tr_b16 v[90:91], v8 offset:29184
    s_waitcnt lgkmcnt(6)
    v_mfma_f32_32x32x16_bf16 v[96:111], v[92:95], v[204:207], v[96:111]
    ds_read_b64_tr_b16 v[92:93], v8 offset:30720
    ds_read_b64_tr_b16 v[94:95], v8 offset:31232
    s_waitcnt lgkmcnt(6)
    v_mfma_f32_32x32x16_bf16 v[96:111], v[80:83], v[208:211], v[96:111]
    ds_read_b64_tr_b16 v[80:81], v8 offset:32768
    ds_read_b64_tr_b16 v[82:83], v8 offset:33280
    s_waitcnt lgkmcnt(6)
    v_mfma_f32_32x32x16_bf16 v[96:111], v[84:87], v[212:215], v[96:111]
    ds_read_b64_tr_b16 v[84:85], v8 offset:34816
    ds_read_b64_tr_b16 v[86:87], v8 offset:35328
    s_waitcnt lgkmcnt(6)
    v_mfma_f32_32x32x16_bf16 v[96:111], v[88:91], v[216:219], v[96:111]
    ds_read_b64_tr_b16 v[88:89], v8 offset:36864
    ds_read_b64_tr_b16 v[90:91], v8 offset:37376
    s_waitcnt lgkmcnt(6)
    v_mfma_f32_32x32x16_bf16 v[96:111], v[92:95], v[220:223], v[96:111]
    ds_read_b64_tr_b16 v[92:93], v8 offset:38912
    ds_read_b64_tr_b16 v[94:95], v8 offset:39424
    s_waitcnt lgkmcnt(6)
    v_mfma_f32_32x32x16_bf16 v[96:111], v[80:83], v[224:227], v[96:111]
    ds_read_b64_tr_b16 v[80:81], v8 offset:40960
    ds_read_b64_tr_b16 v[82:83], v8 offset:41472
    s_waitcnt lgkmcnt(6)
    v_mfma_f32_32x32x16_bf16 v[96:111], v[84:87], v[228:231], v[96:111]
    ds_read_b64_tr_b16 v[84:85], v8 offset:43008
    ds_read_b64_tr_b16 v[86:87], v8 offset:43520
    s_waitcnt lgkmcnt(6)
    v_mfma_f32_32x32x16_bf16 v[96:111], v[88:91], v[232:235], v[96:111]
    ds_read_b64_tr_b16 v[88:89], v8 offset:45056
    ds_read_b64_tr_b16 v[90:91], v8 offset:45568
    s_waitcnt lgkmcnt(6)
    v_mfma_f32_32x32x16_bf16 v[96:111], v[92:95], v[236:239], v[96:111]
    ds_read_b64_tr_b16 v[92:93], v8 offset:47104
    ds_read_b64_tr_b16 v[94:95], v8 offset:47616
    s_waitcnt lgkmcnt(6)
    v_mfma_f32_32x32x16_bf16 v[96:111], v[80:83], v[240:243], v[96:111]
    s_waitcnt vmcnt(0)
    s_barrier
    s_waitcnt lgkmcnt(4)
    v_mfma_f32_32x32x16_bf16 v[96:111], v[84:87], v[244:247], v[96:111]
    s_waitcnt lgkmcnt(2)
    v_mfma_f32_32x32x16_bf16 v[96:111], v[88:91], v[248:251], v[96:111]
    s_waitcnt lgkmcnt(0)
    v_mfma_f32_32x32x16_bf16 v[96:111], v[92:95], v[252:255], v[96:111]
    s_nop 7
    s_nop 3
    s_add_u32 m0, s91, 0xd000
    s_nop 0
    buffer_load_dwordx4 v27, s[12:15], s71 offen lds
    v_mul_f32 v32, s87, v96
    v_mul_f32 v33, s87, v97
    v_mul_f32 v34, s87, v98
    v_mul_f32 v35, s87, v99
    v_exp_f32 v32, v32
    v_exp_f32 v33, v33
    v_exp_f32 v34, v34
    v_exp_f32 v35, v35
    v_add_f32 v32, 1.0, v32
    s_add_u32 m0, s91, 0xe000
    s_nop 0
    buffer_load_dwordx4 v27, s[12:15], s72 offen lds
    v_add_f32 v33, 1.0, v33
    v_add_f32 v34, 1.0, v34
    v_add_f32 v35, 1.0, v35
    v_fma_f32 v32, v32, v32, 1.0
    v_fma_f32 v33, v33, v33, 1.0
    v_fma_f32 v34, v34, v34, 1.0
    v_fma_f32 v35, v35, v35, 1.0
    v_rcp_f32 v32, v32
    v_rcp_f32 v33, v33
    s_add_u32 m0, s91, 0xf000
    s_nop 0
    buffer_load_dwordx4 v27, s[12:15], s73 offen lds
    v_rcp_f32 v34, v34
    v_rcp_f32 v35, v35
    v_fma_f32 v32, v32, -2.0, 1.0
    v_fma_f32 v33, v33, -2.0, 1.0
    v_fma_f32 v34, v34, -2.0, 1.0
    v_fma_f32 v35, v35, -2.0, 1.0
    v_mul_f32 v32, v96, v32
    v_mul_f32 v33, v97, v33
    v_mul_f32 v34, v98, v34
    s_add_u32 m0, s91, 0x10000
    s_nop 0
    buffer_load_dwordx4 v27, s[12:15], s74 offen lds
    v_mul_f32 v35, v99, v35
    v_cvt_pk_bf16_f32 v40, v32, v33
    v_cvt_pk_bf16_f32 v41, v34, v35
    v_mul_f32 v36, s87, v100
    v_mul_f32 v37, s87, v101
    v_mul_f32 v38, s87, v102
    v_mul_f32 v39, s87, v103
    v_exp_f32 v36, v36
    s_add_u32 m0, s91, 0x11000
    s_nop 0
    buffer_load_dwordx4 v27, s[12:15], s75 offen lds
    v_exp_f32 v37, v37
    v_exp_f32 v38, v38
    v_exp_f32 v39, v39
    v_add_f32 v36, 1.0, v36
    v_add_f32 v37, 1.0, v37
    v_add_f32 v38, 1.0, v38
    v_add_f32 v39, 1.0, v39
    v_fma_f32 v36, v36, v36, 1.0
    v_fma_f32 v37, v37, v37, 1.0
    s_add_u32 m0, s91, 0x12000
    s_nop 0
    buffer_load_dwordx4 v27, s[12:15], s76 offen lds
    v_fma_f32 v38, v38, v38, 1.0
    v_fma_f32 v39, v39, v39, 1.0
    v_rcp_f32 v36, v36
    v_rcp_f32 v37, v37
    v_rcp_f32 v38, v38
    v_rcp_f32 v39, v39
    v_fma_f32 v36, v36, -2.0, 1.0
    v_fma_f32 v37, v37, -2.0, 1.0
    v_fma_f32 v38, v38, -2.0, 1.0
    s_add_u32 m0, s91, 0x13000
    s_nop 0
    buffer_load_dwordx4 v27, s[12:15], s77 offen lds
    v_fma_f32 v39, v39, -2.0, 1.0
    v_mul_f32 v36, v100, v36
    v_mul_f32 v37, v101, v37
    v_mul_f32 v38, v102, v38
    v_mul_f32 v39, v103, v39
    v_cvt_pk_bf16_f32 v42, v36, v37
    v_cvt_pk_bf16_f32 v43, v38, v39
    buffer_store_dwordx4 v[40:43], v1, s[16:19], s93 offen offset:0 sc1
    s_barrier
    v_readlane_b32 s63, v13, 0
    s_add_u32 m0, s62, 0x0
    s_lshl_b32 s64, s63, 14
    buffer_load_dwordx4 v14, s[24:27], s64 offen lds
    buffer_load_dwordx4 v15, s[24:27], s64 offen offset:1024 lds
    v_mul_f32 v32, s87, v104
    v_mul_f32 v33, s87, v105
    v_mul_f32 v34, s87, v106
    v_mul_f32 v35, s87, v107
    v_exp_f32 v32, v32
    v_exp_f32 v33, v33
    v_exp_f32 v34, v34
    v_exp_f32 v35, v35
    v_add_f32 v32, 1.0, v32
    v_add_f32 v33, 1.0, v33
    v_add_f32 v34, 1.0, v34
    v_add_f32 v35, 1.0, v35
    v_fma_f32 v32, v32, v32, 1.0
    v_fma_f32 v33, v33, v33, 1.0
    v_fma_f32 v34, v34, v34, 1.0
    v_fma_f32 v35, v35, v35, 1.0
    v_rcp_f32 v32, v32
    v_rcp_f32 v33, v33
    v_rcp_f32 v34, v34
    v_readlane_b32 s63, v13, 1
    s_add_u32 m0, s62, 0x2000
    s_lshl_b32 s64, s63, 14
    buffer_load_dwordx4 v14, s[24:27], s64 offen lds
    buffer_load_dwordx4 v15, s[24:27], s64 offen offset:1024 lds
    v_rcp_f32 v35, v35
    v_fma_f32 v32, v32, -2.0, 1.0
    v_fma_f32 v33, v33, -2.0, 1.0
    v_fma_f32 v34, v34, -2.0, 1.0
    v_fma_f32 v35, v35, -2.0, 1.0
    v_mul_f32 v32, v104, v32
    v_mul_f32 v33, v105, v33
    v_mul_f32 v34, v106, v34
    v_mul_f32 v35, v107, v35
    v_cvt_pk_bf16_f32 v44, v32, v33
    v_cvt_pk_bf16_f32 v45, v34, v35
    v_mul_f32 v36, s87, v108
    v_mul_f32 v37, s87, v109
    v_mul_f32 v38, s87, v110
    v_mul_f32 v39, s87, v111
    v_exp_f32 v36, v36
    v_exp_f32 v37, v37
    v_exp_f32 v38, v38
    v_exp_f32 v39, v39
    v_add_f32 v36, 1.0, v36
    v_add_f32 v37, 1.0, v37
    v_add_f32 v38, 1.0, v38
    v_add_f32 v39, 1.0, v39
    v_fma_f32 v36, v36, v36, 1.0
    v_fma_f32 v37, v37, v37, 1.0
    v_fma_f32 v38, v38, v38, 1.0
    v_fma_f32 v39, v39, v39, 1.0
    v_rcp_f32 v36, v36
    v_rcp_f32 v37, v37
    v_rcp_f32 v38, v38
    v_rcp_f32 v39, v39
    v_fma_f32 v36, v36, -2.0, 1.0
    v_fma_f32 v37, v37, -2.0, 1.0
    v_fma_f32 v38, v38, -2.0, 1.0
    v_fma_f32 v39, v39, -2.0, 1.0
    v_mul_f32 v36, v108, v36
    v_mul_f32 v37, v109, v37
    v_mul_f32 v38, v110, v38
    v_mul_f32 v39, v111, v39
    v_cvt_pk_bf16_f32 v46, v36, v37
    v_cvt_pk_bf16_f32 v47, v38, v39
    buffer_store_dwordx4 v[44:47], v1, s[16:19], s93 offen offset:1024 sc1
    v_mov_b32 v16, v29
    ds_read_b64_tr_b16 v[80:81], v9 offset:0
    ds_read_b64_tr_b16 v[82:83], v9 offset:512
    ds_read_b64_tr_b16 v[84:85], v9 offset:2048
    ds_read_b64_tr_b16 v[86:87], v9 offset:2560
    ds_read_b64_tr_b16 v[88:89], v9 offset:4096
    ds_read_b64_tr_b16 v[90:91], v9 offset:4608
    v_mfma_f32_32x32x16_bf16 v[96:111], v[16:19], v[20:23], 0
    ds_read_b64_tr_b16 v[92:93], v9 offset:6144
    ds_read_b64_tr_b16 v[94:95], v9 offset:6656
    s_waitcnt lgkmcnt(6)
    v_mfma_f32_32x32x16_bf16 v[96:111], v[80:83], v[128:131], v[96:111]
    ds_read_b64_tr_b16 v[80:81], v9 offset:8192
    ds_read_b64_tr_b16 v[82:83], v9 offset:8704
    s_waitcnt lgkmcnt(6)
    v_mfma_f32_32x32x16_bf16 v[96:111], v[84:87], v[132:135], v[96:111]
    ds_read_b64_tr_b16 v[84:85], v9 offset:10240
    ds_read_b64_tr_b16 v[86:87], v9 offset:10752
    s_waitcnt lgkmcnt(6)
    v_mfma_f32_32x32x16_bf16 v[96:111], v[88:91], v[136:139], v[96:111]
    ds_read_b64_tr_b16 v[88:89], v9 offset:12288
    ds_read_b64_tr_b16 v[90:91], v9 offset:12800
    s_waitcnt lgkmcnt(6)
    v_mfma_f32_32x32x16_bf16 v[96:111], v[92:95], v[140:143], v[96:111]
    ds_read_b64_tr_b16 v[92:93], v9 offset:14336
    ds_read_b64_tr_b16 v[94:95], v9 offset:14848
    s_waitcnt lgkmcnt(6)
    v_mfma_f32_32x32x16_bf16 v[96:111], v[80:83], v[144:147], v[96:111]
    ds_read_b64_tr_b16 v[80:81], v9 offset:16384
    ds_read_b64_tr_b16 v[82:83], v9 offset:16896
    s_waitcnt lgkmcnt(6)
    v_mfma_f32_32x32x16_bf16 v[96:111], v[84:87], v[148:151], v[96:111]
    ds_read_b64_tr_b16 v[84:85], v9 offset:18432
    ds_read_b64_tr_b16 v[86:87], v9 offset:18944
    s_waitcnt lgkmcnt(6)
    v_mfma_f32_32x32x16_bf16 v[96:111], v[88:91], v[152:155], v[96:111]
    ds_read_b64_tr_b16 v[88:89], v9 offset:20480
    ds_read_b64_tr_b16 v[90:91], v9 offset:20992
    s_waitcnt lgkmcnt(6)
    v_mfma_f32_32x32x16_bf16 v[96:111], v[92:95], v[156:159], v[96:111]
    s_lshr_b32 s67, s97, 1
    s_lshl2_add_u32 s67, s67, s81
    s_lshl_b32 s67, s67, 7
    v_readfirstlane_b32 s83, v2
    s_movk_i32 s84, 0x7fff
L_pim_chk:
    s_cmp_ge_u32 s83, 8
    s_cbranch_scc1 L_pim_ok
    s_sub_u32 s84, s84, 1
    s_cbranch_scc1 L_pim_ok
    buffer_load_dword v2, off, s[20:23], 0 sc1
    s_waitcnt vmcnt(0)
    v_readfirstlane_b32 s83, v2
    s_branch L_pim_chk
L_pim_ok:
    s_load_dwordx2 s[68:69], s[58:59], s67 offset:0 glc
    ds_read_b64_tr_b16 v[92:93], v9 offset:22528
    ds_read_b64_tr_b16 v[94:95], v9 offset:23040
    s_waitcnt lgkmcnt(6)
    v_mfma_f32_32x32x16_bf16 v[96:111], v[80:83], v[160:163], v[96:111]
    ds_read_b64_tr_b16 v[80:81], v9 offset:24576
    ds_read_b64_tr_b16 v[82:83], v9 offset:25088
    s_waitcnt lgkmcnt(6)
    v_mfma_f32_32x32x16_bf16 v[96:111], v[84:87], v[164:167], v[96:111]
    ds_read_b64_tr_b16 v[84:85], v9 offset:26624
    ds_read_b64_tr_b16 v[86:87], v9 offset:27136
    s_waitcnt lgkmcnt(6)
    v_mfma_f32_32x32x16_bf16 v[96:111], v[88:91], v[168:171], v[96:111]
    ds_read_b64_tr_b16 v[88:89], v9 offset:28672
    ds_read_b64_tr_b16 v[90:91], v9 offset:29184
    s_waitcnt lgkmcnt(6)
    v_mfma_f32_32x32x16_bf16 v[96:111], v[92:95], v[172:175], v[96:111]
    ds_read_b64_tr_b16 v[92:93], v9 offset:30720
    ds_read_b64_tr_b16 v[94:95], v9 offset:31232
    s_waitcnt lgkmcnt(6)
    v_mfma_f32_32x32x16_bf16 v[96:111], v[80:83], v[176:179], v[96:111]
    ds_read_b64_tr_b16 v[80:81], v9 offset:32768
    ds_read_b64_tr_b16 v[82:83], v9 offset:33280
    s_waitcnt lgkmcnt(6)
    v_mfma_f32_32x32x16_bf16 v[96:111], v[84:87], v[180:183], v[96:111]
    ds_read_b64_tr_b16 v[84:85], v9 offset:34816
    ds_read_b64_tr_b16 v[86:87], v9 offset:35328
    s_waitcnt lgkmcnt(6)
    v_mfma_f32_32x32x16_bf16 v[96:111], v[88:91], v[184:187], v[96:111]
    s_add_u32 s72, s62, 0x14000
    s_mov_b32 s73, 0x18000
    v_lshrrev_b32 v72, 5, v0
    ds_read_b64_tr_b16 v[88:89], v9 offset:36864
    ds_read_b64_tr_b16 v[90:91], v9 offset:37376
    s_waitcnt lgkmcnt(6)
    v_mfma_f32_32x32x16_bf16 v[96:111], v[92:95], v[188:191], v[96:111]
    v_bfe_u32 v73, v0, 2, 2
    v_lshl_add_u32 v72, v72, 2, v73
    ds_read_b64_tr_b16 v[92:93], v9 offset:38912
    ds_read_b64_tr_b16 v[94:95], v9 offset:39424
    s_waitcnt lgkmcnt(6)
    v_mfma_f32_32x32x16_bf16 v[96:111], v[80:83], v[192:195], v[96:111]
    v_lshlrev_b32 v4, 7, v72
    ds_read_b64_tr_b16 v[80:81], v9 offset:40960
    ds_read_b64_tr_b16 v[82:83], v9 offset:41472
    s_waitcnt lgkmcnt(6)
    v_mfma_f32_32x32x16_bf16 v[96:111], v[84:87], v[196:199], v[96:111]
    v_lshrrev_b32 v73, 1, v73
    s_lshr_b32 s83, s81, 1
    ds_read_b64_tr_b16 v[84:85], v9 offset:43008
    ds_read_b64_tr_b16 v[86:87], v9 offset:43520
    s_waitcnt lgkmcnt(6)
    v_mfma_f32_32x32x16_bf16 v[96:111], v[88:91], v[200:203], v[96:111]
    v_xor_b32 v73, s83, v73
    v_lshl_add_u32 v4, v73, 6, v4
    ds_read_b64_tr_b16 v[88:89], v9 offset:45056
    ds_read_b64_tr_b16 v[90:91], v9 offset:45568
    s_waitcnt lgkmcnt(6)
    v_mfma_f32_32x32x16_bf16 v[96:111], v[92:95], v[204:207], v[96:111]
    v_bfe_u32 v73, v0, 4, 1
    ds_read_b64_tr_b16 v[92:93], v9 offset:47104
    ds_read_b64_tr_b16 v[94:95], v9 offset:47616
    s_waitcnt lgkmcnt(6)
    v_mfma_f32_32x32x16_bf16 v[96:111], v[80:83], v[208:211], v[96:111]
    v_lshl_add_u32 v4, v73, 5, v4
    v_and_b32 v73, 3, v0
    ds_read_b64_tr_b16 v[80:81], v9 offset:49152
    ds_read_b64_tr_b16 v[82:83], v9 offset:49664
    s_waitcnt lgkmcnt(6)
    v_mfma_f32_32x32x16_bf16 v[96:111], v[84:87], v[212:215], v[96:111]
    v_lshl_add_u32 v4, v73, 3, v4
    v_add_u32 v4, s62, v4
    ds_read_b64_tr_b16 v[84:85], v9 offset:51200
    ds_read_b64_tr_b16 v[86:87], v9 offset:51712
    s_waitcnt lgkmcnt(6)
    v_mfma_f32_32x32x16_bf16 v[96:111], v[88:91], v[216:219], v[96:111]
    v_xor_b32 v5, 64, v4
    ds_read_b64_tr_b16 v[88:89], v9 offset:53248
    ds_read_b64_tr_b16 v[90:91], v9 offset:53760
    s_waitcnt lgkmcnt(6)
    v_mfma_f32_32x32x16_bf16 v[96:111], v[92:95], v[220:223], v[96:111]
    v_add_u32 v2, 0x14000, v4
    v_add_u32 v3, 0x14000, v5
    ds_read_b64_tr_b16 v[92:93], v9 offset:55296
    ds_read_b64_tr_b16 v[94:95], v9 offset:55808
    s_waitcnt lgkmcnt(6)
    v_mfma_f32_32x32x16_bf16 v[96:111], v[80:83], v[224:227], v[96:111]
    s_and_b32 s84, s81, 1
    s_lshl1_add_u32 s83, s97, s84
    ds_read_b64_tr_b16 v[80:81], v9 offset:57344
    ds_read_b64_tr_b16 v[82:83], v9 offset:57856
    s_waitcnt lgkmcnt(6)
    v_mfma_f32_32x32x16_bf16 v[96:111], v[84:87], v[228:231], v[96:111]
    s_xor_b32 s84, s83, 1
    s_mul_i32 s83, s83, 0x24000
    s_mul_i32 s84, s84, 0x24000
    ds_read_b64_tr_b16 v[84:85], v9 offset:59392
    ds_read_b64_tr_b16 v[86:87], v9 offset:59904
    s_waitcnt lgkmcnt(6)
    v_mfma_f32_32x32x16_bf16 v[96:111], v[88:91], v[232:235], v[96:111]
    v_add_u32 v72, 0x100000, v11
    v_add_u32 v6, s83, v72
    ds_read_b64_tr_b16 v[88:89], v9 offset:61440
    ds_read_b64_tr_b16 v[90:91], v9 offset:61952
    s_waitcnt lgkmcnt(6)
    v_mfma_f32_32x32x16_bf16 v[96:111], v[92:95], v[236:239], v[96:111]
    v_add_u32 v7, s84, v72
    ds_read_b64_tr_b16 v[92:93], v9 offset:63488
    ds_read_b64_tr_b16 v[94:95], v9 offset:64000
    s_waitcnt lgkmcnt(6)
    v_mfma_f32_32x32x16_bf16 v[96:111], v[80:83], v[240:243], v[96:111]
    s_waitcnt vmcnt(0) lgkmcnt(0)
    s_barrier
    v_mfma_f32_32x32x16_bf16 v[96:111], v[84:87], v[244:247], v[96:111]
    v_mfma_f32_32x32x16_bf16 v[96:111], v[88:91], v[248:251], v[96:111]
    v_mfma_f32_32x32x16_bf16 v[96:111], v[92:95], v[252:255], v[96:111]
    s_setprio 1
    s_waitcnt lgkmcnt(0)
    s_min_u32 s83, s68, s69
    s_cmp_ge_u32 s83, 1
    s_cbranch_scc1 L_f0m_done
    s_mov_b32 s84, 0x8000
L_f0m_spin:
    s_load_dwordx2 s[68:69], s[58:59], s67 offset:0 glc
    s_waitcnt lgkmcnt(0)
    s_min_u32 s83, s68, s69
    s_cmp_ge_u32 s83, 1
    s_cbranch_scc1 L_f0m_done
    s_sleep 2
    s_sub_u32 s84, s84, 1
    s_cbranch_scc0 L_f0m_spin
L_f0m_done:
    v_readlane_b32 s65, v13, 0
    s_lshl_b32 s66, s65, 10
    buffer_load_dwordx4 v[192:195], v6, s[16:19], s66 offen sc1
    buffer_load_dwordx4 v[196:199], v7, s[16:19], s66 offen sc1
    v_readlane_b32 s65, v13, 1
    s_lshl_b32 s66, s65, 10
    buffer_load_dwordx4 v[200:203], v6, s[16:19], s66 offen sc1
    buffer_load_dwordx4 v[204:207], v7, s[16:19], s66 offen sc1
    v_mul_f32 v32, s87, v96
    v_mul_f32 v33, s87, v97
    v_mul_f32 v34, s87, v98
    v_mul_f32 v35, s87, v99
    v_exp_f32 v32, v32
    v_exp_f32 v33, v33
    v_exp_f32 v34, v34
    v_exp_f32 v35, v35
    v_add_f32 v32, 1.0, v32
    v_add_f32 v33, 1.0, v33
    v_add_f32 v34, 1.0, v34
    v_add_f32 v35, 1.0, v35
    v_fma_f32 v32, v32, v32, 1.0
    v_fma_f32 v33, v33, v33, 1.0
    v_fma_f32 v34, v34, v34, 1.0
    v_fma_f32 v35, v35, v35, 1.0
    v_rcp_f32 v32, v32
    v_rcp_f32 v33, v33
    v_rcp_f32 v34, v34
    v_rcp_f32 v35, v35
    v_fma_f32 v32, v32, -2.0, 1.0
    v_fma_f32 v33, v33, -2.0, 1.0
    v_fma_f32 v34, v34, -2.0, 1.0
    v_fma_f32 v35, v35, -2.0, 1.0
    v_mul_f32 v32, v96, v32
    v_mul_f32 v33, v97, v33
    v_mul_f32 v34, v98, v34
    v_mul_f32 v35, v99, v35
    v_cvt_pk_bf16_f32 v40, v32, v33
    v_cvt_pk_bf16_f32 v41, v34, v35
    v_mul_f32 v36, s87, v100
    v_mul_f32 v37, s87, v101
    v_mul_f32 v38, s87, v102
    v_mul_f32 v39, s87, v103
    v_exp_f32 v36, v36
    v_exp_f32 v37, v37
    v_exp_f32 v38, v38
    v_exp_f32 v39, v39
    v_add_f32 v36, 1.0, v36
    v_add_f32 v37, 1.0, v37
    v_add_f32 v38, 1.0, v38
    v_add_f32 v39, 1.0, v39
    v_fma_f32 v36, v36, v36, 1.0
    v_fma_f32 v37, v37, v37, 1.0
    v_fma_f32 v38, v38, v38, 1.0
    v_fma_f32 v39, v39, v39, 1.0
    v_rcp_f32 v36, v36
    v_rcp_f32 v37, v37
    v_rcp_f32 v38, v38
    v_rcp_f32 v39, v39
    v_fma_f32 v36, v36, -2.0, 1.0
    v_fma_f32 v37, v37, -2.0, 1.0
    v_fma_f32 v38, v38, -2.0, 1.0
    v_fma_f32 v39, v39, -2.0, 1.0
    v_mul_f32 v36, v100, v36
    v_mul_f32 v37, v101, v37
    v_mul_f32 v38, v102, v38
    v_mul_f32 v39, v103, v39
    v_cvt_pk_bf16_f32 v42, v36, v37
    v_cvt_pk_bf16_f32 v43, v38, v39
    buffer_store_dwordx4 v[40:43], v1, s[16:19], s94 offen offset:0 sc1
    v_mul_f32 v32, s87, v104
    v_mul_f32 v33, s87, v105
    v_mul_f32 v34, s87, v106
    v_mul_f32 v35, s87, v107
    v_exp_f32 v32, v32
    v_exp_f32 v33, v33
    v_exp_f32 v34, v34
    v_exp_f32 v35, v35
    v_add_f32 v32, 1.0, v32
    v_add_f32 v33, 1.0, v33
    v_add_f32 v34, 1.0, v34
    v_add_f32 v35, 1.0, v35
    v_fma_f32 v32, v32, v32, 1.0
    v_fma_f32 v33, v33, v33, 1.0
    v_fma_f32 v34, v34, v34, 1.0
    v_fma_f32 v35, v35, v35, 1.0
    v_rcp_f32 v32, v32
    v_rcp_f32 v33, v33
    v_rcp_f32 v34, v34
    v_rcp_f32 v35, v35
    v_fma_f32 v32, v32, -2.0, 1.0
    v_fma_f32 v33, v33, -2.0, 1.0
    v_fma_f32 v34, v34, -2.0, 1.0
    v_fma_f32 v35, v35, -2.0, 1.0
    v_mul_f32 v32, v104, v32
    v_mul_f32 v33, v105, v33
    v_mul_f32 v34, v106, v34
    v_mul_f32 v35, v107, v35
    v_cvt_pk_bf16_f32 v44, v32, v33
    v_cvt_pk_bf16_f32 v45, v34, v35
    v_mul_f32 v36, s87, v108
    v_mul_f32 v37, s87, v109
    v_mul_f32 v38, s87, v110
    v_mul_f32 v39, s87, v111
    v_exp_f32 v36, v36
    v_exp_f32 v37, v37
    v_exp_f32 v38, v38
    v_exp_f32 v39, v39
    v_add_f32 v36, 1.0, v36
    v_add_f32 v37, 1.0, v37
    v_add_f32 v38, 1.0, v38
    v_add_f32 v39, 1.0, v39
    v_fma_f32 v36, v36, v36, 1.0
    v_fma_f32 v37, v37, v37, 1.0
    v_fma_f32 v38, v38, v38, 1.0
    v_fma_f32 v39, v39, v39, 1.0
    v_rcp_f32 v36, v36
    v_rcp_f32 v37, v37
    v_rcp_f32 v38, v38
    v_rcp_f32 v39, v39
    v_fma_f32 v36, v36, -2.0, 1.0
    v_fma_f32 v37, v37, -2.0, 1.0
    v_fma_f32 v38, v38, -2.0, 1.0
    v_fma_f32 v39, v39, -2.0, 1.0
    v_mul_f32 v36, v108, v36
    v_mul_f32 v37, v109, v37
    v_mul_f32 v38, v110, v38
    v_mul_f32 v39, v111, v39
    v_cvt_pk_bf16_f32 v46, v36, v37
    v_cvt_pk_bf16_f32 v47, v38, v39
    buffer_store_dwordx4 v[44:47], v1, s[16:19], s94 offen offset:1024 sc1
    s_setprio 0
    v_readlane_b32 s65, v13, 2
    s_lshl_b32 s66, s65, 10
    buffer_load_dwordx4 v[208:211], v6, s[16:19], s66 offen sc1
    buffer_load_dwordx4 v[212:215], v7, s[16:19], s66 offen sc1
    v_readlane_b32 s65, v13, 3
    s_lshl_b32 s66, s65, 10
    buffer_load_dwordx4 v[216:219], v6, s[16:19], s66 offen sc1
    buffer_load_dwordx4 v[220:223], v7, s[16:19], s66 offen sc1
    v_readlane_b32 s63, v13, 6
    s_add_u32 m0, s72, 0x0
    s_lshl_b32 s64, s63, 14
    buffer_load_dwordx4 v14, s[24:27], s64 offen lds
    buffer_load_dwordx4 v15, s[24:27], s64 offen offset:1024 lds
    v_mov_b32 v76, 0x24c08
    s_mov_b32 s84, 0x80000
L_wr_spin:
    ds_read_b32 v77, v76
    s_waitcnt lgkmcnt(0)
    v_readfirstlane_b32 s83, v77
    s_cmp_ge_u32 s83, 4
    s_cbranch_scc1 L_wr_done
    s_sub_u32 s84, s84, 1
    s_cbranch_scc0 L_wr_spin
L_wr_done:
    s_waitcnt lgkmcnt(0)
    ds_read_b64_tr_b16 v[64:65], v4 offset:0
    ds_read_b64_tr_b16 v[66:67], v4 offset:1024
    ds_read_b64_tr_b16 v[68:69], v5 offset:0
    ds_read_b64_tr_b16 v[70:71], v5 offset:1024
    ds_read_b64_tr_b16 v[72:73], v4 offset:8192
    ds_read_b64_tr_b16 v[74:75], v4 offset:9216
    ds_read_b64_tr_b16 v[76:77], v5 offset:8192
    ds_read_b64_tr_b16 v[78:79], v5 offset:9216
    s_load_dwordx2 s[68:69], s[58:59], s67 offset:0 glc
    s_waitcnt vmcnt(10)
    s_waitcnt lgkmcnt(6)
    s_setprio 2
    v_mfma_f32_32x32x16_bf16 v[128:143], v[64:67], v[192:195], 0
    s_setprio 0
    ds_read_b64_tr_b16 v[80:81], v4 offset:16384
    v_readlane_b32 s65, v13, 4
    s_lshl_b32 s66, s65, 10
    buffer_load_dwordx4 v[224:227], v6, s[16:19], s66 offen sc1
    s_setprio 2
    v_mfma_f32_32x32x16_bf16 v[144:159], v[64:67], v[196:199], 0
    s_setprio 0
    ds_read_b64_tr_b16 v[82:83], v4 offset:17408
    buffer_load_dwordx4 v[228:231], v7, s[16:19], s66 offen sc1
    s_waitcnt lgkmcnt(6)
    s_setprio 2
    v_mfma_f32_32x32x16_bf16 v[176:191], v[68:71], v[196:199], 0
    s_setprio 0
    ds_read_b64_tr_b16 v[84:85], v5 offset:16384
    v_readlane_b32 s63, v13, 7
    s_add_u32 m0, s72, 0x2000
    s_lshl_b32 s64, s63, 14
    buffer_load_dwordx4 v14, s[24:27], s64 offen lds
    s_setprio 2
    v_mfma_f32_32x32x16_bf16 v[160:175], v[68:71], v[192:195], 0
    s_setprio 0
    ds_read_b64_tr_b16 v[86:87], v5 offset:17408
    buffer_load_dwordx4 v15, s[24:27], s64 offen offset:1024 lds
    s_waitcnt vmcnt(12)
    s_waitcnt lgkmcnt(6)
    s_setprio 2
    v_mfma_f32_32x32x16_bf16 v[128:143], v[72:75], v[200:203], v[128:143]
    s_setprio 0
    ds_read_b64_tr_b16 v[88:89], v4 offset:24576
    v_readlane_b32 s65, v13, 5
    s_lshl_b32 s66, s65, 10
    buffer_load_dwordx4 v[192:195], v6, s[16:19], s66 offen sc1
    s_setprio 2
    v_mfma_f32_32x32x16_bf16 v[144:159], v[72:75], v[204:207], v[144:159]
    s_setprio 0
    ds_read_b64_tr_b16 v[90:91], v4 offset:25600
    buffer_load_dwordx4 v[196:199], v7, s[16:19], s66 offen sc1
    s_waitcnt lgkmcnt(6)
    s_setprio 2
    v_mfma_f32_32x32x16_bf16 v[176:191], v[76:79], v[204:207], v[176:191]
    s_setprio 0
    ds_read_b64_tr_b16 v[92:93], v5 offset:24576
    v_readlane_b32 s63, v13, 8
    s_add_u32 m0, s62, 0x0
    s_lshl_b32 s64, s63, 14
    buffer_load_dwordx4 v14, s[24:27], s64 offen lds
    s_setprio 2
    v_mfma_f32_32x32x16_bf16 v[160:175], v[76:79], v[200:203], v[160:175]
    s_setprio 0
    ds_read_b64_tr_b16 v[94:95], v5 offset:25600
    buffer_load_dwordx4 v15, s[24:27], s64 offen offset:1024 lds
    s_waitcnt vmcnt(12)
    s_waitcnt lgkmcnt(6)
    s_setprio 2
    v_mfma_f32_32x32x16_bf16 v[128:143], v[80:83], v[208:211], v[128:143]
    s_setprio 0
    ds_read_b64_tr_b16 v[64:65], v4 offset:32768
    v_readlane_b32 s65, v13, 6
    s_lshl_b32 s66, s65, 10
    buffer_load_dwordx4 v[200:203], v6, s[16:19], s66 offen sc1
    s_setprio 2
    v_mfma_f32_32x32x16_bf16 v[144:159], v[80:83], v[212:215], v[144:159]
    s_setprio 0
    ds_read_b64_tr_b16 v[66:67], v4 offset:33792
    buffer_load_dwordx4 v[204:207], v7, s[16:19], s66 offen sc1
    s_waitcnt lgkmcnt(6)
    s_setprio 2
    v_mfma_f32_32x32x16_bf16 v[176:191], v[84:87], v[212:215], v[176:191]
    s_setprio 0
    ds_read_b64_tr_b16 v[68:69], v5 offset:32768
    v_readlane_b32 s63, v13, 9
    s_add_u32 m0, s62, 0x2000
    s_lshl_b32 s64, s63, 14
    buffer_load_dwordx4 v14, s[24:27], s64 offen lds
    s_setprio 2
    v_mfma_f32_32x32x16_bf16 v[160:175], v[84:87], v[208:211], v[160:175]
    s_setprio 0
    ds_read_b64_tr_b16 v[70:71], v5 offset:33792
    buffer_load_dwordx4 v15, s[24:27], s64 offen offset:1024 lds
    s_waitcnt vmcnt(14)
    v_mov_b32 v34, 0x24c00
    v_mov_b32 v35, 1
    s_mov_b64 exec, 1
    ds_add_rtn_u32 v35, v34, v35
    s_mov_b64 exec, -1
    s_waitcnt lgkmcnt(0)
    v_readfirstlane_b32 s83, v35
    s_cmp_lg_u32 s83, 7
    s_cbranch_scc1 L_parr_skip
    s_lshr_b32 s85, s6, 1
    s_lshl2_add_u32 s85, s5, s85
    s_lshl_b32 s85, s85, 5
    s_and_b32 s86, s6, 1
    s_add_u32 s85, s85, s86
    s_add_u32 s85, s85, 0
    s_lshl_b32 s85, s85, 2
    s_mov_b32 s99, 1
    s_atomic_add s99, s[58:59], s85
L_parr_skip:
    s_setprio 2
    v_mfma_f32_32x32x16_bf16 v[128:143], v[88:91], v[216:219], v[128:143]
    s_setprio 0
    ds_read_b64_tr_b16 v[72:73], v4 offset:40960
    v_readlane_b32 s65, v13, 7
    s_lshl_b32 s66, s65, 10
    buffer_load_dwordx4 v[208:211], v6, s[16:19], s66 offen sc1
    s_setprio 2
    v_mfma_f32_32x32x16_bf16 v[144:159], v[88:91], v[220:223], v[144:159]
    s_setprio 0
    ds_read_b64_tr_b16 v[74:75], v4 offset:41984
    buffer_load_dwordx4 v[212:215], v7, s[16:19], s66 offen sc1
    s_setprio 2
    v_mfma_f32_32x32x16_bf16 v[176:191], v[92:95], v[220:223], v[176:191]
    s_setprio 0
    ds_read_b64_tr_b16 v[76:77], v5 offset:40960
    v_readlane_b32 s63, v13, 10
    s_add_u32 m0, s62, 0x4000
    s_lshl_b32 s64, s63, 14
    buffer_load_dwordx4 v14, s[24:27], s64 offen lds
    s_setprio 2
    v_mfma_f32_32x32x16_bf16 v[160:175], v[92:95], v[216:219], v[160:175]
    s_setprio 0
    ds_read_b64_tr_b16 v[78:79], v5 offset:41984
    buffer_load_dwordx4 v15, s[24:27], s64 offen offset:1024 lds
    s_waitcnt lgkmcnt(0)
    s_min_u32 s83, s68, s69
    s_cmp_ge_u32 s83, 2
    s_cbranch_scc1 L_f1m_done
    s_mov_b32 s84, 0x8000
L_f1m_spin:
    s_load_dwordx2 s[68:69], s[58:59], s67 offset:0 glc
    s_waitcnt lgkmcnt(0)
    s_min_u32 s83, s68, s69
    s_cmp_ge_u32 s83, 2
    s_cbranch_scc1 L_f1m_done
    s_sleep 2
    s_sub_u32 s84, s84, 1
    s_cbranch_scc0 L_f1m_spin
L_f1m_done:
    s_waitcnt vmcnt(14)
    s_setprio 2
    v_mfma_f32_32x32x16_bf16 v[128:143], v[64:67], v[224:227], v[128:143]
    s_setprio 0
    ds_read_b64_tr_b16 v[80:81], v2 offset:0
    v_readlane_b32 s65, v13, 8
    s_lshl_b32 s66, s65, 10
    buffer_load_dwordx4 v[216:219], v6, s[16:19], s66 offen sc1
    s_setprio 2
    v_mfma_f32_32x32x16_bf16 v[144:159], v[64:67], v[228:231], v[144:159]
    s_setprio 0
    ds_read_b64_tr_b16 v[82:83], v2 offset:1024
    buffer_load_dwordx4 v[220:223], v7, s[16:19], s66 offen sc1
    s_setprio 2
    v_mfma_f32_32x32x16_bf16 v[176:191], v[68:71], v[228:231], v[176:191]
    s_setprio 0
    ds_read_b64_tr_b16 v[84:85], v3 offset:0
    v_readlane_b32 s63, v13, 11
    s_add_u32 m0, s62, 0x6000
    s_lshl_b32 s64, s63, 14
    buffer_load_dwordx4 v14, s[24:27], s64 offen lds
    s_setprio 2
    v_mfma_f32_32x32x16_bf16 v[160:175], v[68:71], v[224:227], v[160:175]
    s_setprio 0
    ds_read_b64_tr_b16 v[86:87], v3 offset:1024
    buffer_load_dwordx4 v15, s[24:27], s64 offen offset:1024 lds
    s_waitcnt vmcnt(14)
    s_setprio 2
    v_mfma_f32_32x32x16_bf16 v[128:143], v[72:75], v[192:195], v[128:143]
    s_setprio 0
    ds_read_b64_tr_b16 v[88:89], v2 offset:8192
    v_readlane_b32 s65, v13, 9
    s_lshl_b32 s66, s65, 10
    buffer_load_dwordx4 v[224:227], v6, s[16:19], s66 offen sc1
    s_setprio 2
    v_mfma_f32_32x32x16_bf16 v[144:159], v[72:75], v[196:199], v[144:159]
    s_setprio 0
    ds_read_b64_tr_b16 v[90:91], v2 offset:9216
    buffer_load_dwordx4 v[228:231], v7, s[16:19], s66 offen sc1
    s_setprio 2
    v_mfma_f32_32x32x16_bf16 v[176:191], v[76:79], v[196:199], v[176:191]
    s_setprio 0
    ds_read_b64_tr_b16 v[92:93], v3 offset:8192
    v_readlane_b32 s63, v13, 12
    s_add_u32 m0, s62, 0x8000
    s_lshl_b32 s64, s63, 14
    buffer_load_dwordx4 v14, s[24:27], s64 offen lds
    s_setprio 2
    v_mfma_f32_32x32x16_bf16 v[160:175], v[76:79], v[192:195], v[160:175]
    s_setprio 0
    ds_read_b64_tr_b16 v[94:95], v3 offset:9216
    buffer_load_dwordx4 v15, s[24:27], s64 offen offset:1024 lds
    s_waitcnt vmcnt(14)
    s_waitcnt lgkmcnt(6)
    s_setprio 2
    v_mfma_f32_32x32x16_bf16 v[128:143], v[80:83], v[200:203], v[128:143]
    s_setprio 0
    ds_read_b64_tr_b16 v[64:65], v4 offset:0
    v_readlane_b32 s65, v13, 10
    s_lshl_b32 s66, s65, 10
    buffer_load_dwordx4 v[192:195], v6, s[16:19], s66 offen sc1
    s_setprio 2
    v_mfma_f32_32x32x16_bf16 v[144:159], v[80:83], v[204:207], v[144:159]
    s_setprio 0
    ds_read_b64_tr_b16 v[66:67], v4 offset:1024
    buffer_load_dwordx4 v[196:199], v7, s[16:19], s66 offen sc1
    s_waitcnt lgkmcnt(6)
    s_setprio 2
    v_mfma_f32_32x32x16_bf16 v[176:191], v[84:87], v[204:207], v[176:191]
    s_setprio 0
    ds_read_b64_tr_b16 v[68:69], v5 offset:0
    v_readlane_b32 s63, v13, 13
    s_add_u32 m0, s62, 0xa000
    s_lshl_b32 s64, s63, 14
    buffer_load_dwordx4 v14, s[24:27], s64 offen lds
    s_setprio 2
    v_mfma_f32_32x32x16_bf16 v[160:175], v[84:87], v[200:203], v[160:175]
    s_setprio 0
    ds_read_b64_tr_b16 v[70:71], v5 offset:1024
    buffer_load_dwordx4 v15, s[24:27], s64 offen offset:1024 lds
    s_load_dwordx2 s[68:69], s[58:59], s67 offset:0 glc
    s_waitcnt vmcnt(14)
    s_waitcnt lgkmcnt(6)
    s_setprio 2
    v_mfma_f32_32x32x16_bf16 v[128:143], v[88:91], v[208:211], v[128:143]
    s_setprio 0
    ds_read_b64_tr_b16 v[72:73], v4 offset:8192
    v_readlane_b32 s65, v13, 11
    s_lshl_b32 s66, s65, 10
    buffer_load_dwordx4 v[200:203], v6, s[16:19], s66 offen sc1
    s_setprio 2
    v_mfma_f32_32x32x16_bf16 v[144:159], v[88:91], v[212:215], v[144:159]
    s_setprio 0
    ds_read_b64_tr_b16 v[74:75], v4 offset:9216
    buffer_load_dwordx4 v[204:207], v7, s[16:19], s66 offen sc1
    s_waitcnt lgkmcnt(6)
    s_setprio 2
    v_mfma_f32_32x32x16_bf16 v[176:191], v[92:95], v[212:215], v[176:191]
    s_setprio 0
    ds_read_b64_tr_b16 v[76:77], v5 offset:8192
    v_readlane_b32 s63, v13, 14
    s_add_u32 m0, s72, 0x0
    s_lshl_b32 s64, s63, 14
    buffer_load_dwordx4 v14, s[24:27], s64 offen lds
    s_setprio 2
    v_mfma_f32_32x32x16_bf16 v[160:175], v[92:95], v[208:211], v[160:175]
    s_setprio 0
    ds_read_b64_tr_b16 v[78:79], v5 offset:9216
    buffer_load_dwordx4 v15, s[24:27], s64 offen offset:1024 lds
    s_waitcnt vmcnt(14)
    s_waitcnt lgkmcnt(6)
    s_setprio 2
    v_mfma_f32_32x32x16_bf16 v[128:143], v[64:67], v[216:219], v[128:143]
    s_setprio 0
    ds_read_b64_tr_b16 v[80:81], v4 offset:16384
    v_readlane_b32 s65, v13, 12
    s_lshl_b32 s66, s65, 10
    buffer_load_dwordx4 v[208:211], v6, s[16:19], s66 offen sc1
    s_setprio 2
    v_mfma_f32_32x32x16_bf16 v[144:159], v[64:67], v[220:223], v[144:159]
    s_setprio 0
    ds_read_b64_tr_b16 v[82:83], v4 offset:17408
    buffer_load_dwordx4 v[212:215], v7, s[16:19], s66 offen sc1
    s_waitcnt lgkmcnt(6)
    s_setprio 2
    v_mfma_f32_32x32x16_bf16 v[176:191], v[68:71], v[220:223], v[176:191]
    s_setprio 0
    ds_read_b64_tr_b16 v[84:85], v5 offset:16384
    v_readlane_b32 s63, v13, 15
    s_add_u32 m0, s72, 0x2000
    s_lshl_b32 s64, s63, 14
    buffer_load_dwordx4 v14, s[24:27], s64 offen lds
    s_setprio 2
    v_mfma_f32_32x32x16_bf16 v[160:175], v[68:71], v[216:219], v[160:175]
    s_setprio 0
    ds_read_b64_tr_b16 v[86:87], v5 offset:17408
    buffer_load_dwordx4 v15, s[24:27], s64 offen offset:1024 lds
    s_waitcnt vmcnt(14)
    s_waitcnt lgkmcnt(6)
    s_setprio 2
    v_mfma_f32_32x32x16_bf16 v[128:143], v[72:75], v[224:227], v[128:143]
    s_setprio 0
    ds_read_b64_tr_b16 v[88:89], v4 offset:24576
    v_readlane_b32 s65, v13, 13
    s_lshl_b32 s66, s65, 10
    buffer_load_dwordx4 v[216:219], v6, s[16:19], s66 offen sc1
    s_setprio 2
    v_mfma_f32_32x32x16_bf16 v[144:159], v[72:75], v[228:231], v[144:159]
    s_setprio 0
    ds_read_b64_tr_b16 v[90:91], v4 offset:25600
    buffer_load_dwordx4 v[220:223], v7, s[16:19], s66 offen sc1
    s_waitcnt lgkmcnt(6)
    s_setprio 2
    v_mfma_f32_32x32x16_bf16 v[176:191], v[76:79], v[228:231], v[176:191]
    s_setprio 0
    ds_read_b64_tr_b16 v[92:93], v5 offset:24576
    v_readlane_b32 s63, v13, 16
    s_add_u32 m0, s62, 0x0
    s_lshl_b32 s64, s63, 14
    buffer_load_dwordx4 v14, s[24:27], s64 offen lds
    s_setprio 2
    v_mfma_f32_32x32x16_bf16 v[160:175], v[76:79], v[224:227], v[160:175]
    s_setprio 0
    ds_read_b64_tr_b16 v[94:95], v5 offset:25600
    buffer_load_dwordx4 v15, s[24:27], s64 offen offset:1024 lds
    s_waitcnt vmcnt(14)
    s_waitcnt lgkmcnt(6)
    s_setprio 2
    v_mfma_f32_32x32x16_bf16 v[128:143], v[80:83], v[192:195], v[128:143]
    s_setprio 0
    ds_read_b64_tr_b16 v[64:65], v4 offset:32768
    v_readlane_b32 s65, v13, 14
    s_lshl_b32 s66, s65, 10
    buffer_load_dwordx4 v[224:227], v6, s[16:19], s66 offen sc1
    s_setprio 2
    v_mfma_f32_32x32x16_bf16 v[144:159], v[80:83], v[196:199], v[144:159]
    s_setprio 0
    ds_read_b64_tr_b16 v[66:67], v4 offset:33792
    buffer_load_dwordx4 v[228:231], v7, s[16:19], s66 offen sc1
    s_waitcnt lgkmcnt(6)
    s_setprio 2
    v_mfma_f32_32x32x16_bf16 v[176:191], v[84:87], v[196:199], v[176:191]
    s_setprio 0
    ds_read_b64_tr_b16 v[68:69], v5 offset:32768
    v_readlane_b32 s63, v13, 17
    s_add_u32 m0, s62, 0x2000
    s_lshl_b32 s64, s63, 14
    buffer_load_dwordx4 v14, s[24:27], s64 offen lds
    s_setprio 2
    v_mfma_f32_32x32x16_bf16 v[160:175], v[84:87], v[192:195], v[160:175]
    s_setprio 0
    ds_read_b64_tr_b16 v[70:71], v5 offset:33792
    buffer_load_dwordx4 v15, s[24:27], s64 offen offset:1024 lds
    s_waitcnt vmcnt(14)
    s_waitcnt lgkmcnt(6)
    s_setprio 2
    v_mfma_f32_32x32x16_bf16 v[128:143], v[88:91], v[200:203], v[128:143]
    s_setprio 0
    ds_read_b64_tr_b16 v[72:73], v4 offset:40960
    v_readlane_b32 s65, v13, 15
    s_lshl_b32 s66, s65, 10
    buffer_load_dwordx4 v[192:195], v6, s[16:19], s66 offen sc1
    s_setprio 2
    v_mfma_f32_32x32x16_bf16 v[144:159], v[88:91], v[204:207], v[144:159]
    s_setprio 0
    ds_read_b64_tr_b16 v[74:75], v4 offset:41984
    buffer_load_dwordx4 v[196:199], v7, s[16:19], s66 offen sc1
    s_waitcnt lgkmcnt(6)
    s_setprio 2
    v_mfma_f32_32x32x16_bf16 v[176:191], v[92:95], v[204:207], v[176:191]
    s_setprio 0
    ds_read_b64_tr_b16 v[76:77], v5 offset:40960
    v_readlane_b32 s63, v13, 18
    s_add_u32 m0, s62, 0x4000
    s_lshl_b32 s64, s63, 14
    buffer_load_dwordx4 v14, s[24:27], s64 offen lds
    s_setprio 2
    v_mfma_f32_32x32x16_bf16 v[160:175], v[92:95], v[200:203], v[160:175]
    s_setprio 0
    ds_read_b64_tr_b16 v[78:79], v5 offset:41984
    buffer_load_dwordx4 v15, s[24:27], s64 offen offset:1024 lds
    s_waitcnt lgkmcnt(0)
    s_min_u32 s83, s68, s69
    s_cmp_ge_u32 s83, 3
    s_cbranch_scc1 L_f2m_done
    s_mov_b32 s84, 0x8000
L_f2m_spin:
    s_load_dwordx2 s[68:69], s[58:59], s67 offset:0 glc
    s_waitcnt lgkmcnt(0)
    s_min_u32 s83, s68, s69
    s_cmp_ge_u32 s83, 3
    s_cbranch_scc1 L_f2m_done
    s_sleep 2
    s_sub_u32 s84, s84, 1
    s_cbranch_scc0 L_f2m_spin
L_f2m_done:
    s_waitcnt vmcnt(14)
    v_mfma_f32_32x32x16_bf16 v[128:143], v[64:67], v[208:211], v[128:143]
    ds_read_b64_tr_b16 v[80:81], v2 offset:0
    v_readlane_b32 s65, v13, 16
    s_lshl_b32 s66, s65, 10
    buffer_load_dwordx4 v[200:203], v6, s[16:19], s66 offen sc1
    v_mfma_f32_32x32x16_bf16 v[144:159], v[64:67], v[212:215], v[144:159]
    ds_read_b64_tr_b16 v[82:83], v2 offset:1024
    buffer_load_dwordx4 v[204:207], v7, s[16:19], s66 offen sc1
    v_mfma_f32_32x32x16_bf16 v[176:191], v[68:71], v[212:215], v[176:191]
    ds_read_b64_tr_b16 v[84:85], v3 offset:0
    v_readlane_b32 s63, v13, 19
    s_add_u32 m0, s62, 0x6000
    s_lshl_b32 s64, s63, 14
    buffer_load_dwordx4 v14, s[24:27], s64 offen lds
    v_mfma_f32_32x32x16_bf16 v[160:175], v[68:71], v[208:211], v[160:175]
    ds_read_b64_tr_b16 v[86:87], v3 offset:1024
    buffer_load_dwordx4 v15, s[24:27], s64 offen offset:1024 lds
    s_waitcnt vmcnt(14)
    v_mfma_f32_32x32x16_bf16 v[128:143], v[72:75], v[216:219], v[128:143]
    ds_read_b64_tr_b16 v[88:89], v2 offset:8192
    v_readlane_b32 s65, v13, 17
    s_lshl_b32 s66, s65, 10
    buffer_load_dwordx4 v[208:211], v6, s[16:19], s66 offen sc1
    v_mfma_f32_32x32x16_bf16 v[144:159], v[72:75], v[220:223], v[144:159]
    ds_read_b64_tr_b16 v[90:91], v2 offset:9216
    buffer_load_dwordx4 v[212:215], v7, s[16:19], s66 offen sc1
    v_mfma_f32_32x32x16_bf16 v[176:191], v[76:79], v[220:223], v[176:191]
    ds_read_b64_tr_b16 v[92:93], v3 offset:8192
    v_readlane_b32 s63, v13, 20
    s_add_u32 m0, s62, 0x8000
    s_lshl_b32 s64, s63, 14
    buffer_load_dwordx4 v14, s[24:27], s64 offen lds
    v_mfma_f32_32x32x16_bf16 v[160:175], v[76:79], v[216:219], v[160:175]
    ds_read_b64_tr_b16 v[94:95], v3 offset:9216
    buffer_load_dwordx4 v15, s[24:27], s64 offen offset:1024 lds
    s_waitcnt vmcnt(14)
    s_waitcnt lgkmcnt(6)
    v_mfma_f32_32x32x16_bf16 v[128:143], v[80:83], v[224:227], v[128:143]
    ds_read_b64_tr_b16 v[64:65], v4 offset:0
    v_readlane_b32 s65, v13, 18
    s_lshl_b32 s66, s65, 10
    buffer_load_dwordx4 v[216:219], v6, s[16:19], s66 offen sc1
    v_mfma_f32_32x32x16_bf16 v[144:159], v[80:83], v[228:231], v[144:159]
    ds_read_b64_tr_b16 v[66:67], v4 offset:1024
    buffer_load_dwordx4 v[220:223], v7, s[16:19], s66 offen sc1
    s_waitcnt lgkmcnt(6)
    v_mfma_f32_32x32x16_bf16 v[176:191], v[84:87], v[228:231], v[176:191]
    ds_read_b64_tr_b16 v[68:69], v5 offset:0
    v_readlane_b32 s63, v13, 21
    s_add_u32 m0, s62, 0xa000
    s_lshl_b32 s64, s63, 14
    buffer_load_dwordx4 v14, s[24:27], s64 offen lds
    v_mfma_f32_32x32x16_bf16 v[160:175], v[84:87], v[224:227], v[160:175]
    ds_read_b64_tr_b16 v[70:71], v5 offset:1024
    buffer_load_dwordx4 v15, s[24:27], s64 offen offset:1024 lds
    s_load_dwordx2 s[68:69], s[58:59], s67 offset:24 glc
    s_waitcnt vmcnt(14)
    s_waitcnt lgkmcnt(6)
    v_mfma_f32_32x32x16_bf16 v[128:143], v[88:91], v[192:195], v[128:143]
    ds_read_b64_tr_b16 v[72:73], v4 offset:8192
    v_readlane_b32 s65, v13, 19
    s_lshl_b32 s66, s65, 10
    buffer_load_dwordx4 v[224:227], v6, s[16:19], s66 offen sc1
    v_mfma_f32_32x32x16_bf16 v[144:159], v[88:91], v[196:199], v[144:159]
    ds_read_b64_tr_b16 v[74:75], v4 offset:9216
    buffer_load_dwordx4 v[228:231], v7, s[16:19], s66 offen sc1
    s_waitcnt lgkmcnt(6)
    v_mfma_f32_32x32x16_bf16 v[176:191], v[92:95], v[196:199], v[176:191]
    ds_read_b64_tr_b16 v[76:77], v5 offset:8192
    v_readlane_b32 s63, v13, 22
    s_add_u32 m0, s72, 0x0
    s_lshl_b32 s64, s63, 14
    buffer_load_dwordx4 v14, s[24:27], s64 offen lds
    v_mfma_f32_32x32x16_bf16 v[160:175], v[92:95], v[192:195], v[160:175]
    ds_read_b64_tr_b16 v[78:79], v5 offset:9216
    buffer_load_dwordx4 v15, s[24:27], s64 offen offset:1024 lds
    s_waitcnt vmcnt(14)
    s_waitcnt lgkmcnt(6)
    v_mfma_f32_32x32x16_bf16 v[128:143], v[64:67], v[200:203], v[128:143]
    ds_read_b64_tr_b16 v[80:81], v4 offset:16384
    v_readlane_b32 s65, v13, 20
    s_lshl_b32 s66, s65, 10
    buffer_load_dwordx4 v[192:195], v6, s[16:19], s66 offen sc1
    v_mfma_f32_32x32x16_bf16 v[144:159], v[64:67], v[204:207], v[144:159]
    ds_read_b64_tr_b16 v[82:83], v4 offset:17408
    buffer_load_dwordx4 v[196:199], v7, s[16:19], s66 offen sc1
    s_waitcnt lgkmcnt(6)
    v_mfma_f32_32x32x16_bf16 v[176:191], v[68:71], v[204:207], v[176:191]
    ds_read_b64_tr_b16 v[84:85], v5 offset:16384
    v_readlane_b32 s63, v13, 23
    s_add_u32 m0, s72, 0x2000
    s_lshl_b32 s64, s63, 14
    buffer_load_dwordx4 v14, s[24:27], s64 offen lds
    v_mfma_f32_32x32x16_bf16 v[160:175], v[68:71], v[200:203], v[160:175]
    ds_read_b64_tr_b16 v[86:87], v5 offset:17408
    buffer_load_dwordx4 v15, s[24:27], s64 offen offset:1024 lds
    s_waitcnt vmcnt(14)
    s_waitcnt lgkmcnt(6)
    v_mfma_f32_32x32x16_bf16 v[128:143], v[72:75], v[208:211], v[128:143]
    ds_read_b64_tr_b16 v[88:89], v4 offset:24576
    v_readlane_b32 s65, v13, 21
    s_lshl_b32 s66, s65, 10
    buffer_load_dwordx4 v[200:203], v6, s[16:19], s66 offen sc1
    v_mfma_f32_32x32x16_bf16 v[144:159], v[72:75], v[212:215], v[144:159]
    ds_read_b64_tr_b16 v[90:91], v4 offset:25600
    buffer_load_dwordx4 v[204:207], v7, s[16:19], s66 offen sc1
    s_waitcnt lgkmcnt(6)
    v_mfma_f32_32x32x16_bf16 v[176:191], v[76:79], v[212:215], v[176:191]
    ds_read_b64_tr_b16 v[92:93], v5 offset:24576
    v_readlane_b32 s63, v13, 24
    s_add_u32 m0, s62, 0x0
    s_lshl_b32 s64, s63, 14
    buffer_load_dwordx4 v14, s[24:27], s64 offen lds
    v_mfma_f32_32x32x16_bf16 v[160:175], v[76:79], v[208:211], v[160:175]
    ds_read_b64_tr_b16 v[94:95], v5 offset:25600
    buffer_load_dwordx4 v15, s[24:27], s64 offen offset:1024 lds
    s_waitcnt vmcnt(14)
    s_waitcnt lgkmcnt(6)
    v_mfma_f32_32x32x16_bf16 v[128:143], v[80:83], v[216:219], v[128:143]
    ds_read_b64_tr_b16 v[64:65], v4 offset:32768
    v_readlane_b32 s65, v13, 22
    s_lshl_b32 s66, s65, 10
    buffer_load_dwordx4 v[208:211], v6, s[16:19], s66 offen sc1
    v_mfma_f32_32x32x16_bf16 v[144:159], v[80:83], v[220:223], v[144:159]
    ds_read_b64_tr_b16 v[66:67], v4 offset:33792
    buffer_load_dwordx4 v[212:215], v7, s[16:19], s66 offen sc1
    s_waitcnt lgkmcnt(6)
    v_mfma_f32_32x32x16_bf16 v[176:191], v[84:87], v[220:223], v[176:191]
    ds_read_b64_tr_b16 v[68:69], v5 offset:32768
    v_readlane_b32 s63, v13, 25
    s_add_u32 m0, s62, 0x2000
    s_lshl_b32 s64, s63, 14
    buffer_load_dwordx4 v14, s[24:27], s64 offen lds
    v_mfma_f32_32x32x16_bf16 v[160:175], v[84:87], v[216:219], v[160:175]
    ds_read_b64_tr_b16 v[70:71], v5 offset:33792
    buffer_load_dwordx4 v15, s[24:27], s64 offen offset:1024 lds
    s_waitcnt vmcnt(14)
    s_waitcnt lgkmcnt(6)
    v_mfma_f32_32x32x16_bf16 v[128:143], v[88:91], v[224:227], v[128:143]
    ds_read_b64_tr_b16 v[72:73], v4 offset:40960
    v_readlane_b32 s65, v13, 23
    s_lshl_b32 s66, s65, 10
    buffer_load_dwordx4 v[216:219], v6, s[16:19], s66 offen sc1
    v_mfma_f32_32x32x16_bf16 v[144:159], v[88:91], v[228:231], v[144:159]
    ds_read_b64_tr_b16 v[74:75], v4 offset:41984
    buffer_load_dwordx4 v[220:223], v7, s[16:19], s66 offen sc1
    s_waitcnt lgkmcnt(6)
    v_mfma_f32_32x32x16_bf16 v[176:191], v[92:95], v[228:231], v[176:191]
    ds_read_b64_tr_b16 v[76:77], v5 offset:40960
    v_readlane_b32 s63, v13, 26
    s_add_u32 m0, s62, 0x4000
    s_lshl_b32 s64, s63, 14
    buffer_load_dwordx4 v14, s[24:27], s64 offen lds
    v_mfma_f32_32x32x16_bf16 v[160:175], v[92:95], v[224:227], v[160:175]
    ds_read_b64_tr_b16 v[78:79], v5 offset:41984
    buffer_load_dwordx4 v15, s[24:27], s64 offen offset:1024 lds
    s_waitcnt lgkmcnt(0)
    s_min_u32 s83, s68, s69
    s_cmp_ge_u32 s83, 1
    s_cbranch_scc1 L_f4m_done
    s_mov_b32 s84, 0x8000
L_f4m_spin:
    s_load_dwordx2 s[68:69], s[58:59], s67 offset:24 glc
    s_waitcnt lgkmcnt(0)
    s_min_u32 s83, s68, s69
    s_cmp_ge_u32 s83, 1
    s_cbranch_scc1 L_f4m_done
    s_sleep 2
    s_sub_u32 s84, s84, 1
    s_cbranch_scc0 L_f4m_spin
L_f4m_done:
    s_load_dwordx4 s[68:71], s[58:59], s67 offset:8 glc
    s_waitcnt vmcnt(14)
    v_mfma_f32_32x32x16_bf16 v[128:143], v[64:67], v[192:195], v[128:143]
    ds_read_b64_tr_b16 v[80:81], v2 offset:0
    v_readlane_b32 s65, v13, 24
    s_lshl_b32 s66, s65, 10
    buffer_load_dwordx4 v[224:227], v6, s[16:19], s66 offen sc1
    v_mfma_f32_32x32x16_bf16 v[144:159], v[64:67], v[196:199], v[144:159]
    ds_read_b64_tr_b16 v[82:83], v2 offset:1024
    buffer_load_dwordx4 v[228:231], v7, s[16:19], s66 offen sc1
    v_mfma_f32_32x32x16_bf16 v[176:191], v[68:71], v[196:199], v[176:191]
    ds_read_b64_tr_b16 v[84:85], v3 offset:0
    v_readlane_b32 s63, v13, 27
    s_add_u32 m0, s62, 0x6000
    s_lshl_b32 s64, s63, 14
    buffer_load_dwordx4 v14, s[24:27], s64 offen lds
    v_mfma_f32_32x32x16_bf16 v[160:175], v[68:71], v[192:195], v[160:175]
    ds_read_b64_tr_b16 v[86:87], v3 offset:1024
    buffer_load_dwordx4 v15, s[24:27], s64 offen offset:1024 lds
    s_waitcnt vmcnt(14)
    v_mfma_f32_32x32x16_bf16 v[128:143], v[72:75], v[200:203], v[128:143]
    ds_read_b64_tr_b16 v[88:89], v2 offset:8192
    v_readlane_b32 s65, v13, 25
    s_lshl_b32 s66, s65, 10
    buffer_load_dwordx4 v[192:195], v6, s[16:19], s66 offen sc1
    v_mfma_f32_32x32x16_bf16 v[144:159], v[72:75], v[204:207], v[144:159]
    ds_read_b64_tr_b16 v[90:91], v2 offset:9216
    buffer_load_dwordx4 v[196:199], v7, s[16:19], s66 offen sc1
    v_mfma_f32_32x32x16_bf16 v[176:191], v[76:79], v[204:207], v[176:191]
    ds_read_b64_tr_b16 v[92:93], v3 offset:8192
    v_readlane_b32 s63, v13, 28
    s_add_u32 m0, s62, 0x8000
    s_lshl_b32 s64, s63, 14
    buffer_load_dwordx4 v14, s[28:31], s64 offen lds
    v_mfma_f32_32x32x16_bf16 v[160:175], v[76:79], v[200:203], v[160:175]
    ds_read_b64_tr_b16 v[94:95], v3 offset:9216
    buffer_load_dwordx4 v15, s[28:31], s64 offen offset:1024 lds
    s_waitcnt vmcnt(14)
    s_waitcnt lgkmcnt(6)
    v_mfma_f32_32x32x16_bf16 v[128:143], v[80:83], v[208:211], v[128:143]
    ds_read_b64_tr_b16 v[64:65], v4 offset:0
    v_readlane_b32 s65, v13, 26
    s_lshl_b32 s66, s65, 10
    buffer_load_dwordx4 v[200:203], v6, s[16:19], s66 offen sc1
    v_mfma_f32_32x32x16_bf16 v[144:159], v[80:83], v[212:215], v[144:159]
    ds_read_b64_tr_b16 v[66:67], v4 offset:1024
    buffer_load_dwordx4 v[204:207], v7, s[16:19], s66 offen sc1
    s_waitcnt lgkmcnt(6)
    v_mfma_f32_32x32x16_bf16 v[176:191], v[84:87], v[212:215], v[176:191]
    ds_read_b64_tr_b16 v[68:69], v5 offset:0
    v_readlane_b32 s63, v13, 29
    s_add_u32 m0, s62, 0xa000
    s_lshl_b32 s64, s63, 14
    buffer_load_dwordx4 v14, s[28:31], s64 offen lds
    v_mfma_f32_32x32x16_bf16 v[160:175], v[84:87], v[208:211], v[160:175]
    ds_read_b64_tr_b16 v[70:71], v5 offset:1024
    buffer_load_dwordx4 v15, s[28:31], s64 offen offset:1024 lds
    s_waitcnt vmcnt(14)
    s_waitcnt lgkmcnt(6)
    v_mfma_f32_32x32x16_bf16 v[128:143], v[88:91], v[216:219], v[128:143]
    ds_read_b64_tr_b16 v[72:73], v4 offset:8192
    v_readlane_b32 s65, v13, 27
    s_lshl_b32 s66, s65, 10
    buffer_load_dwordx4 v[208:211], v6, s[16:19], s66 offen sc1
    v_mfma_f32_32x32x16_bf16 v[144:159], v[88:91], v[220:223], v[144:159]
    ds_read_b64_tr_b16 v[74:75], v4 offset:9216
    buffer_load_dwordx4 v[212:215], v7, s[16:19], s66 offen sc1
    s_waitcnt lgkmcnt(6)
    v_mfma_f32_32x32x16_bf16 v[176:191], v[92:95], v[220:223], v[176:191]
    ds_read_b64_tr_b16 v[76:77], v5 offset:8192
    v_readlane_b32 s63, v13, 30
    s_add_u32 m0, s72, 0x0
    s_lshl_b32 s64, s63, 14
    buffer_load_dwordx4 v14, s[28:31], s64 offen lds
    v_mfma_f32_32x32x16_bf16 v[160:175], v[92:95], v[216:219], v[160:175]
    ds_read_b64_tr_b16 v[78:79], v5 offset:9216
    buffer_load_dwordx4 v15, s[28:31], s64 offen offset:1024 lds
    s_waitcnt lgkmcnt(0)
    s_min_u32 s83, s68, s69
    s_min_u32 s83, s83, s70
    s_min_u32 s83, s83, s71
    s_cmp_ge_u32 s83, 1
    s_cbranch_scc1 L_f3m_done
    s_mov_b32 s84, 0x8000
L_f3m_spin:
    s_load_dwordx4 s[68:71], s[58:59], s67 offset:8 glc
    s_waitcnt lgkmcnt(0)
    s_min_u32 s83, s68, s69
    s_min_u32 s83, s83, s70
    s_min_u32 s83, s83, s71
    s_cmp_ge_u32 s83, 1
    s_cbranch_scc1 L_f3m_done
    s_sleep 2
    s_sub_u32 s84, s84, 1
    s_cbranch_scc0 L_f3m_spin
L_f3m_done:
    v_and_b32 v32, 31, v0
    v_lshlrev_b32 v32, 2, v32
    s_and_b32 s84, s81, 1
    s_lshl1_add_u32 s84, s97, s84
    s_lshl_b32 s84, s84, 8
    s_lshl_b32 s83, s81, 15
    s_add_u32 s83, s83, s84
    s_add_u32 s83, s83, 0x40000
    s_xor_b32 s84, s83, 0x100
    buffer_load_dword v244, v32, s[16:19], s83 offen offset:0 sc1
    buffer_load_dword v245, v32, s[16:19], s84 offen offset:0 sc1
    buffer_load_dword v246, v32, s[16:19], s83 offen offset:128 sc1
    buffer_load_dword v247, v32, s[16:19], s84 offen offset:128 sc1
    s_waitcnt vmcnt(18)
    v_mfma_f32_32x32x16_bf16 v[128:143], v[64:67], v[224:227], v[128:143]
    ds_read_b64_tr_b16 v[80:81], v4 offset:16384
    v_readlane_b32 s65, v13, 28
    s_lshl_b32 s66, s65, 10
    buffer_load_dwordx4 v[216:219], v6, s[16:19], s66 offen sc1
    v_mfma_f32_32x32x16_bf16 v[144:159], v[64:67], v[228:231], v[144:159]
    ds_read_b64_tr_b16 v[82:83], v4 offset:17408
    buffer_load_dwordx4 v[220:223], v7, s[16:19], s66 offen sc1
    v_mfma_f32_32x32x16_bf16 v[176:191], v[68:71], v[228:231], v[176:191]
    ds_read_b64_tr_b16 v[84:85], v5 offset:16384
    v_readlane_b32 s63, v13, 31
    s_add_u32 m0, s72, 0x2000
    s_lshl_b32 s64, s63, 14
    buffer_load_dwordx4 v14, s[28:31], s64 offen lds
    v_mfma_f32_32x32x16_bf16 v[160:175], v[68:71], v[224:227], v[160:175]
    ds_read_b64_tr_b16 v[86:87], v5 offset:17408
    buffer_load_dwordx4 v15, s[28:31], s64 offen offset:1024 lds
    s_waitcnt vmcnt(18)
    v_mfma_f32_32x32x16_bf16 v[128:143], v[72:75], v[192:195], v[128:143]
    ds_read_b64_tr_b16 v[88:89], v4 offset:24576
    v_readlane_b32 s65, v13, 29
    s_lshl_b32 s66, s65, 10
    buffer_load_dwordx4 v[224:227], v6, s[16:19], s66 offen sc1
    v_mfma_f32_32x32x16_bf16 v[144:159], v[72:75], v[196:199], v[144:159]
    ds_read_b64_tr_b16 v[90:91], v4 offset:25600
    buffer_load_dwordx4 v[228:231], v7, s[16:19], s66 offen sc1
    v_mfma_f32_32x32x16_bf16 v[176:191], v[76:79], v[196:199], v[176:191]
    ds_read_b64_tr_b16 v[92:93], v5 offset:24576
    v_readlane_b32 s63, v13, 32
    s_add_u32 m0, s62, 0x0
    s_lshl_b32 s64, s63, 14
    buffer_load_dwordx4 v14, s[28:31], s64 offen lds
    v_mfma_f32_32x32x16_bf16 v[160:175], v[76:79], v[192:195], v[160:175]
    ds_read_b64_tr_b16 v[94:95], v5 offset:25600
    buffer_load_dwordx4 v15, s[28:31], s64 offen offset:1024 lds
    s_waitcnt vmcnt(18)
    s_waitcnt lgkmcnt(6)
    v_mfma_f32_32x32x16_bf16 v[128:143], v[80:83], v[200:203], v[128:143]
    ds_read_b64_tr_b16 v[64:65], v4 offset:32768
    v_readlane_b32 s65, v13, 30
    s_lshl_b32 s66, s65, 10
    buffer_load_dwordx4 v[192:195], v6, s[16:19], s66 offen sc1
    v_mfma_f32_32x32x16_bf16 v[144:159], v[80:83], v[204:207], v[144:159]
    ds_read_b64_tr_b16 v[66:67], v4 offset:33792
    buffer_load_dwordx4 v[196:199], v7, s[16:19], s66 offen sc1
    s_waitcnt lgkmcnt(6)
    v_mfma_f32_32x32x16_bf16 v[176:191], v[84:87], v[204:207], v[176:191]
    ds_read_b64_tr_b16 v[68:69], v5 offset:32768
    v_readlane_b32 s63, v13, 33
    s_add_u32 m0, s62, 0x2000
    s_lshl_b32 s64, s63, 14
    buffer_load_dwordx4 v14, s[28:31], s64 offen lds
    v_mfma_f32_32x32x16_bf16 v[160:175], v[84:87], v[200:203], v[160:175]
    ds_read_b64_tr_b16 v[70:71], v5 offset:33792
    buffer_load_dwordx4 v15, s[28:31], s64 offen offset:1024 lds
    s_waitcnt vmcnt(18)
    s_waitcnt lgkmcnt(6)
    v_mfma_f32_32x32x16_bf16 v[128:143], v[88:91], v[208:211], v[128:143]
    ds_read_b64_tr_b16 v[72:73], v4 offset:40960
    v_readlane_b32 s65, v13, 31
    s_lshl_b32 s66, s65, 10
    buffer_load_dwordx4 v[200:203], v6, s[16:19], s66 offen sc1
    v_mfma_f32_32x32x16_bf16 v[144:159], v[88:91], v[212:215], v[144:159]
    ds_read_b64_tr_b16 v[74:75], v4 offset:41984
    buffer_load_dwordx4 v[204:207], v7, s[16:19], s66 offen sc1
    s_waitcnt lgkmcnt(6)
    v_mfma_f32_32x32x16_bf16 v[176:191], v[92:95], v[212:215], v[176:191]
    ds_read_b64_tr_b16 v[76:77], v5 offset:40960
    v_readlane_b32 s63, v13, 34
    s_add_u32 m0, s62, 0x4000
    s_lshl_b32 s64, s63, 14
    buffer_load_dwordx4 v14, s[28:31], s64 offen lds
    v_mfma_f32_32x32x16_bf16 v[160:175], v[92:95], v[208:211], v[160:175]
    ds_read_b64_tr_b16 v[78:79], v5 offset:41984
    buffer_load_dwordx4 v15, s[28:31], s64 offen offset:1024 lds
    s_waitcnt vmcnt(16)
    s_waitcnt vmcnt(14)
    s_waitcnt lgkmcnt(6)
    v_mfma_f32_32x32x16_bf16 v[16:31], v[64:67], v[216:219], 0
    ds_read_b64_tr_b16 v[80:81], v2 offset:0
    v_readlane_b32 s65, v13, 32
    s_lshl_b32 s66, s65, 10
    buffer_load_dwordx4 v[208:211], v6, s[16:19], s66 offen sc1
    v_mul_f32 v176, v245, v176
    v_mul_f32 v177, v245, v177
    v_mul_f32 v178, v245, v178
    v_mul_f32 v179, v245, v179
    v_mfma_f32_32x32x16_bf16 v[96:111], v[64:67], v[220:223], 0
    ds_read_b64_tr_b16 v[82:83], v2 offset:1024
    buffer_load_dwordx4 v[212:215], v7, s[16:19], s66 offen sc1
    v_mul_f32 v180, v245, v180
    v_mul_f32 v181, v245, v181
    v_mul_f32 v182, v245, v182
    v_mul_f32 v183, v245, v183
    s_waitcnt lgkmcnt(6)
    v_mfma_f32_32x32x16_bf16 v[48:63], v[68:71], v[220:223], 0
    ds_read_b64_tr_b16 v[84:85], v3 offset:0
    v_readlane_b32 s63, v13, 35
    s_add_u32 m0, s62, 0x6000
    s_lshl_b32 s64, s63, 14
    buffer_load_dwordx4 v14, s[28:31], s64 offen lds
    v_mul_f32 v184, v245, v184
    v_mul_f32 v185, v245, v185
    v_mul_f32 v186, v245, v186
    v_mul_f32 v187, v245, v187
    v_mfma_f32_32x32x16_bf16 v[112:127], v[68:71], v[216:219], 0
    ds_read_b64_tr_b16 v[86:87], v3 offset:1024
    buffer_load_dwordx4 v15, s[28:31], s64 offen offset:1024 lds
    v_mul_f32 v188, v245, v188
    v_mul_f32 v189, v245, v189
    v_mul_f32 v190, v245, v190
    v_mul_f32 v191, v245, v191
    s_waitcnt vmcnt(14)
    s_waitcnt lgkmcnt(6)
    v_mfma_f32_32x32x16_bf16 v[16:31], v[72:75], v[224:227], v[16:31]
    ds_read_b64_tr_b16 v[88:89], v2 offset:8192
    v_readlane_b32 s65, v13, 33
    s_lshl_b32 s66, s65, 10
    buffer_load_dwordx4 v[216:219], v6, s[16:19], s66 offen sc1
    v_mul_f32 v160, v244, v160
    v_mul_f32 v161, v244, v161
    v_mul_f32 v162, v244, v162
    v_mul_f32 v163, v244, v163
    v_mfma_f32_32x32x16_bf16 v[96:111], v[72:75], v[228:231], v[96:111]
    ds_read_b64_tr_b16 v[90:91], v2 offset:9216
    buffer_load_dwordx4 v[220:223], v7, s[16:19], s66 offen sc1
    v_mul_f32 v164, v244, v164
    v_mul_f32 v165, v244, v165
    v_mul_f32 v166, v244, v166
    v_mul_f32 v167, v244, v167
    s_waitcnt lgkmcnt(6)
    v_mfma_f32_32x32x16_bf16 v[48:63], v[76:79], v[228:231], v[48:63]
    ds_read_b64_tr_b16 v[92:93], v3 offset:8192
    v_mul_f32 v168, v244, v168
    v_mul_f32 v169, v244, v169
    v_mul_f32 v170, v244, v170
    v_mul_f32 v171, v244, v171
    v_mfma_f32_32x32x16_bf16 v[112:127], v[76:79], v[224:227], v[112:127]
    ds_read_b64_tr_b16 v[94:95], v3 offset:9216
    v_mul_f32 v172, v244, v172
    v_mul_f32 v173, v244, v173
    v_mul_f32 v174, v244, v174
    v_mul_f32 v175, v244, v175
    s_waitcnt vmcnt(12)
    s_waitcnt lgkmcnt(6)
    v_mfma_f32_32x32x16_bf16 v[16:31], v[80:83], v[192:195], v[16:31]
    ds_read_b64_tr_b16 v[64:65], v4 offset:0
    v_readlane_b32 s65, v13, 34
    s_lshl_b32 s66, s65, 10
    buffer_load_dwordx4 v[224:227], v6, s[16:19], s66 offen sc1
    v_mul_f32 v144, v245, v144
    v_mul_f32 v145, v245, v145
    v_mul_f32 v146, v245, v146
    v_mul_f32 v147, v245, v147
    v_mfma_f32_32x32x16_bf16 v[96:111], v[80:83], v[196:199], v[96:111]
    ds_read_b64_tr_b16 v[66:67], v4 offset:1024
    buffer_load_dwordx4 v[228:231], v7, s[16:19], s66 offen sc1
    v_mul_f32 v148, v245, v148
    v_mul_f32 v149, v245, v149
    v_mul_f32 v150, v245, v150
    v_mul_f32 v151, v245, v151
    s_waitcnt lgkmcnt(6)
    v_mfma_f32_32x32x16_bf16 v[48:63], v[84:87], v[196:199], v[48:63]
    ds_read_b64_tr_b16 v[68:69], v5 offset:0
    v_mul_f32 v152, v245, v152
    v_mul_f32 v153, v245, v153
    v_mul_f32 v154, v245, v154
    v_mul_f32 v155, v245, v155
    v_mfma_f32_32x32x16_bf16 v[112:127], v[84:87], v[192:195], v[112:127]
    ds_read_b64_tr_b16 v[70:71], v5 offset:1024
    v_mul_f32 v156, v245, v156
    v_mul_f32 v157, v245, v157
    v_mul_f32 v158, v245, v158
    v_mul_f32 v159, v245, v159
    s_waitcnt vmcnt(10)
    s_waitcnt lgkmcnt(6)
    v_mfma_f32_32x32x16_bf16 v[16:31], v[88:91], v[200:203], v[16:31]
    ds_read_b64_tr_b16 v[72:73], v4 offset:8192
    v_readlane_b32 s65, v13, 35
    s_lshl_b32 s66, s65, 10
    buffer_load_dwordx4 v[192:195], v6, s[16:19], s66 offen sc1
    v_mul_f32 v128, v244, v128
    v_mul_f32 v129, v244, v129
    v_mul_f32 v130, v244, v130
    v_mul_f32 v131, v244, v131
    v_mfma_f32_32x32x16_bf16 v[96:111], v[88:91], v[204:207], v[96:111]
    ds_read_b64_tr_b16 v[74:75], v4 offset:9216
    buffer_load_dwordx4 v[196:199], v7, s[16:19], s66 offen sc1
    v_mul_f32 v132, v244, v132
    v_mul_f32 v133, v244, v133
    v_mul_f32 v134, v244, v134
    v_mul_f32 v135, v244, v135
    s_waitcnt lgkmcnt(6)
    v_mfma_f32_32x32x16_bf16 v[48:63], v[92:95], v[204:207], v[48:63]
    ds_read_b64_tr_b16 v[76:77], v5 offset:8192
    v_mul_f32 v136, v244, v136
    v_mul_f32 v137, v244, v137
    v_mul_f32 v138, v244, v138
    v_mul_f32 v139, v244, v139
    v_mfma_f32_32x32x16_bf16 v[112:127], v[92:95], v[200:203], v[112:127]
    ds_read_b64_tr_b16 v[78:79], v5 offset:9216
    v_mul_f32 v140, v244, v140
    v_mul_f32 v141, v244, v141
    v_mul_f32 v142, v244, v142
    v_mul_f32 v143, v244, v143
    v_mov_b32 v34, 0x24c0c
    ds_read_b32 v35, v34
    s_waitcnt vmcnt(8)
    s_waitcnt lgkmcnt(7)
    v_mfma_f32_32x32x16_bf16 v[16:31], v[64:67], v[208:211], v[16:31]
    ds_read_b64_tr_b16 v[80:81], v4 offset:16384
    v_mfma_f32_32x32x16_bf16 v[96:111], v[64:67], v[212:215], v[96:111]
    ds_read_b64_tr_b16 v[82:83], v4 offset:17408
    s_waitcnt lgkmcnt(7)
    v_mfma_f32_32x32x16_bf16 v[48:63], v[68:71], v[212:215], v[48:63]
    ds_read_b64_tr_b16 v[84:85], v5 offset:16384
    v_mfma_f32_32x32x16_bf16 v[112:127], v[68:71], v[208:211], v[112:127]
    ds_read_b64_tr_b16 v[86:87], v5 offset:17408
    s_waitcnt vmcnt(4)
    s_waitcnt lgkmcnt(7)
    v_mfma_f32_32x32x16_bf16 v[16:31], v[72:75], v[216:219], v[16:31]
    ds_read_b64_tr_b16 v[88:89], v4 offset:24576
    v_mfma_f32_32x32x16_bf16 v[96:111], v[72:75], v[220:223], v[96:111]
    ds_read_b64_tr_b16 v[90:91], v4 offset:25600
    s_waitcnt lgkmcnt(7)
    v_mfma_f32_32x32x16_bf16 v[48:63], v[76:79], v[220:223], v[48:63]
    ds_read_b64_tr_b16 v[92:93], v5 offset:24576
    v_mfma_f32_32x32x16_bf16 v[112:127], v[76:79], v[216:219], v[112:127]
    ds_read_b64_tr_b16 v[94:95], v5 offset:25600
    s_waitcnt lgkmcnt(8)
    v_readfirstlane_b32 s83, v35
    s_cmp_ge_u32 s83, 4
    s_cbranch_scc1 L_qdm_done
    v_mov_b32 v34, 0x24c0c
    s_mov_b32 s84, 0x80000
L_qdm_spin:
    ds_read_b32 v35, v34
    s_waitcnt lgkmcnt(0)
    v_readfirstlane_b32 s83, v35
    s_cmp_ge_u32 s83, 4
    s_cbranch_scc1 L_qdm_done
    s_sub_u32 s84, s84, 1
    s_cbranch_scc0 L_qdm_spin
L_qdm_done:
    s_xor_b32 s83, s81, 1
    s_mul_i32 s83, s83, 0x3000
    s_add_u32 s83, s83, s73
    s_add_u32 s83, s83, 0x0
    v_add_u32 v37, s83, v11
    s_xor_b32 s83, s81, 2
    s_mul_i32 s83, s83, 0x3000
    s_add_u32 s83, s83, s73
    s_add_u32 s83, s83, 0x1000
    v_add_u32 v38, s83, v11
    s_xor_b32 s83, s81, 3
    s_mul_i32 s83, s83, 0x3000
    s_add_u32 s83, s83, s73
    s_add_u32 s83, s83, 0x2000
    v_add_u32 v39, s83, v11
    s_mul_i32 s83, s81, 0x3000
    s_add_u32 s83, s83, s73
    v_add_u32 v36, s83, v11
    s_waitcnt vmcnt(2) lgkmcnt(4)
    v_mfma_f32_32x32x16_bf16 v[48:63], v[84:87], v[228:231], v[48:63]
    s_waitcnt vmcnt(0) lgkmcnt(0)
    v_mfma_f32_32x32x16_bf16 v[48:63], v[92:95], v[196:199], v[48:63]
    v_mfma_f32_32x32x16_bf16 v[112:127], v[84:87], v[224:227], v[112:127]
    s_mov_b32 s32, s54
    s_mov_b32 s33, s55
    s_mov_b32 s34, 0x200000
    s_mov_b32 s35, 0x20000
    v_and_b32 v32, 31, v0
    v_lshrrev_b32 v33, 5, v0
    v_lshlrev_b32 v32, 10, v32
    v_mfma_f32_32x32x16_bf16 v[112:127], v[92:95], v[192:195], v[112:127]
    v_lshl_add_u32 v32, v33, 4, v32
    s_and_b32 s84, s81, 1
    s_lshl1_add_u32 s83, s97, s84
    s_lshl_b32 s83, s83, 15
    s_lshr_b32 s84, s81, 1
    s_lshl1_add_u32 s84, s98, s84
    s_lshl_b32 s84, s84, 6
    s_add_u32 s83, s83, s84
    v_fmac_f32 v176, v247, v48
    v_fmac_f32 v177, v247, v49
    v_fmac_f32 v178, v247, v50
    v_fmac_f32 v179, v247, v51
    ds_write_b128 v39, v[176:179] offset:0
    v_fmac_f32 v180, v247, v52
    v_fmac_f32 v181, v247, v53
    v_fmac_f32 v182, v247, v54
    v_fmac_f32 v183, v247, v55
    ds_write_b128 v39, v[180:183] offset:1024
    v_fmac_f32 v184, v247, v56
    v_fmac_f32 v185, v247, v57
    v_fmac_f32 v186, v247, v58
    v_fmac_f32 v187, v247, v59
    ds_write_b128 v39, v[184:187] offset:2048
    v_fmac_f32 v188, v247, v60
    v_fmac_f32 v189, v247, v61
    v_fmac_f32 v190, v247, v62
    v_fmac_f32 v191, v247, v63
    ds_write_b128 v39, v[188:191] offset:3072
    v_mfma_f32_32x32x16_bf16 v[96:111], v[80:83], v[228:231], v[96:111]
    v_mfma_f32_32x32x16_bf16 v[96:111], v[88:91], v[196:199], v[96:111]
    v_mfma_f32_32x32x16_bf16 v[16:31], v[80:83], v[224:227], v[16:31]
    v_fmac_f32 v160, v246, v112
    v_fmac_f32 v161, v246, v113
    v_fmac_f32 v162, v246, v114
    v_fmac_f32 v163, v246, v115
    ds_write_b128 v38, v[160:163] offset:0
    v_fmac_f32 v164, v246, v116
    v_fmac_f32 v165, v246, v117
    v_fmac_f32 v166, v246, v118
    v_fmac_f32 v167, v246, v119
    ds_write_b128 v38, v[164:167] offset:1024
    v_fmac_f32 v168, v246, v120
    v_fmac_f32 v169, v246, v121
    v_fmac_f32 v170, v246, v122
    v_fmac_f32 v171, v246, v123
    ds_write_b128 v38, v[168:171] offset:2048
    v_fmac_f32 v172, v246, v124
    v_fmac_f32 v173, v246, v125
    v_fmac_f32 v174, v246, v126
    v_fmac_f32 v175, v246, v127
    ds_write_b128 v38, v[172:175] offset:3072
    v_mfma_f32_32x32x16_bf16 v[16:31], v[88:91], v[192:195], v[16:31]
    v_fmac_f32 v144, v247, v96
    v_fmac_f32 v145, v247, v97
    v_fmac_f32 v146, v247, v98
    v_fmac_f32 v147, v247, v99
    ds_write_b128 v37, v[144:147] offset:0
    v_fmac_f32 v148, v247, v100
    v_fmac_f32 v149, v247, v101
    v_fmac_f32 v150, v247, v102
    v_fmac_f32 v151, v247, v103
    ds_write_b128 v37, v[148:151] offset:1024
    v_fmac_f32 v152, v247, v104
    v_fmac_f32 v153, v247, v105
    v_fmac_f32 v154, v247, v106
    v_fmac_f32 v155, v247, v107
    ds_write_b128 v37, v[152:155] offset:2048
    v_fmac_f32 v156, v247, v108
    v_fmac_f32 v157, v247, v109
    v_fmac_f32 v158, v247, v110
    v_fmac_f32 v159, v247, v111
    ds_write_b128 v37, v[156:159] offset:3072
    v_fmac_f32 v128, v246, v16
    v_fmac_f32 v129, v246, v17
    v_fmac_f32 v130, v246, v18
    v_fmac_f32 v131, v246, v19
    v_fmac_f32 v132, v246, v20
    v_fmac_f32 v133, v246, v21
    v_fmac_f32 v134, v246, v22
    v_fmac_f32 v135, v246, v23
    v_fmac_f32 v136, v246, v24
    v_fmac_f32 v137, v246, v25
    v_fmac_f32 v138, v246, v26
    v_fmac_f32 v139, v246, v27
    v_fmac_f32 v140, v246, v28
    v_fmac_f32 v141, v246, v29
    v_fmac_f32 v142, v246, v30
    v_fmac_f32 v143, v246, v31
    s_waitcnt lgkmcnt(0)
    s_barrier
    ds_read_b128 v[192:195], v36 offset:0
    ds_read_b128 v[208:211], v36 offset:4096
    ds_read_b128 v[224:227], v36 offset:8192
    ds_read_b128 v[196:199], v36 offset:1024
    ds_read_b128 v[212:215], v36 offset:5120
    ds_read_b128 v[228:231], v36 offset:9216
    ds_read_b128 v[200:203], v36 offset:2048
    ds_read_b128 v[216:219], v36 offset:6144
    ds_read_b128 v[232:235], v36 offset:10240
    ds_read_b128 v[204:207], v36 offset:3072
    ds_read_b128 v[220:223], v36 offset:7168
    ds_read_b128 v[236:239], v36 offset:11264
    s_waitcnt lgkmcnt(11)
    v_pk_add_f32 v[128:129], v[128:129], v[192:193]
    v_pk_add_f32 v[130:131], v[130:131], v[194:195]
    s_waitcnt lgkmcnt(9)
    v_pk_add_f32 v[208:209], v[208:209], v[224:225]
    v_pk_add_f32 v[210:211], v[210:211], v[226:227]
    v_pk_add_f32 v[128:129], v[128:129], v[208:209]
    v_pk_add_f32 v[130:131], v[130:131], v[210:211]
    v_cvt_pk_bf16_f32 v144, v128, v129
    v_cvt_pk_bf16_f32 v145, v130, v131
    s_waitcnt lgkmcnt(8)
    v_pk_add_f32 v[132:133], v[132:133], v[196:197]
    v_pk_add_f32 v[134:135], v[134:135], v[198:199]
    s_waitcnt lgkmcnt(6)
    v_pk_add_f32 v[212:213], v[212:213], v[228:229]
    v_pk_add_f32 v[214:215], v[214:215], v[230:231]
    v_pk_add_f32 v[132:133], v[132:133], v[212:213]
    v_pk_add_f32 v[134:135], v[134:135], v[214:215]
    v_cvt_pk_bf16_f32 v146, v132, v133
    v_cvt_pk_bf16_f32 v147, v134, v135
    s_nop 0
    v_permlane32_swap_b32 v144, v146
    v_permlane32_swap_b32 v145, v147
    buffer_store_dwordx4 v[144:147], v32, s[32:35], s83 offen offset:0
    s_waitcnt lgkmcnt(5)
    v_pk_add_f32 v[136:137], v[136:137], v[200:201]
    v_pk_add_f32 v[138:139], v[138:139], v[202:203]
    s_waitcnt lgkmcnt(3)
    v_pk_add_f32 v[216:217], v[216:217], v[232:233]
    v_pk_add_f32 v[218:219], v[218:219], v[234:235]
    v_pk_add_f32 v[136:137], v[136:137], v[216:217]
    v_pk_add_f32 v[138:139], v[138:139], v[218:219]
    v_cvt_pk_bf16_f32 v148, v136, v137
    v_cvt_pk_bf16_f32 v149, v138, v139
    s_waitcnt lgkmcnt(2)
    v_pk_add_f32 v[140:141], v[140:141], v[204:205]
    v_pk_add_f32 v[142:143], v[142:143], v[206:207]
    s_waitcnt lgkmcnt(0)
    v_pk_add_f32 v[220:221], v[220:221], v[236:237]
    v_pk_add_f32 v[222:223], v[222:223], v[238:239]
    v_pk_add_f32 v[140:141], v[140:141], v[220:221]
    v_pk_add_f32 v[142:143], v[142:143], v[222:223]
    v_cvt_pk_bf16_f32 v150, v140, v141
    v_cvt_pk_bf16_f32 v151, v142, v143
    s_nop 0
    v_permlane32_swap_b32 v148, v150
    v_permlane32_swap_b32 v149, v151
    buffer_store_dwordx4 v[148:151], v32, s[32:35], s83 offen offset:32
L_fin:
L_end:
    s_endpgm
L_pad:
.fill ((49152 + 256 - (L_pad - gated_mix__linear_kernel_hedgehog__dense_activation_mish__prompt_kernel)) / 4) * (((L_pad - gated_mix__linear_kernel_hedgehog__dense_activation_mish__prompt_kernel) - (49152 + 256)) >> 63 & 1), 4, 0xbf800000
.section .rodata,"a"
.p2align 6
.amdhsa_kernel gated_mix__linear_kernel_hedgehog__dense_activation_mish__prompt_kernel
  .amdhsa_next_free_vgpr 256
  .amdhsa_next_free_sgpr 102
  .amdhsa_accum_offset 256
  .amdhsa_group_segment_fixed_size 0
  .amdhsa_kernarg_size 96
  .amdhsa_user_sgpr_count 2
  .amdhsa_user_sgpr_kernarg_segment_ptr 1
  .amdhsa_system_sgpr_workgroup_id_x 1
  .amdhsa_float_denorm_mode_32 3
.end_amdhsa_kernel
```
